```python
import torch

def _softmax(x, axis=-1):
    return torch.softmax(x, dim=axis)

def _gelu(x):
    return torch.nn.functional.gelu(x, approximate='tanh')

def _silu(x):
    return torch.nn.functional.silu(x)

def _sigmoid(x):
    return torch.sigmoid(x)

def _layernorm(x, axis=-1, eps=1e-05):
    m = x.mean(dim=axis, keepdim=True)
    v = x.var(dim=axis, keepdim=True, unbiased=False)
    return (x - m) / torch.sqrt(v + eps)

def _scatter_add(tgt, idx, src, axis=0):
    return tgt.clone().index_add_(axis, idx, src)

def _segment_sum(src, seg, n):
    out = torch.zeros((n,) + src.shape[1:], dtype=src.dtype)
    return out.index_add_(0, seg, src)

def _pad(x, pw):
    flat = tuple((v for pair in reversed(pw) for v in pair))
    return torch.nn.functional.pad(x, flat)
kernel_name = 'adaLN_cond__mha_block__dense_activation_silu__prompt'

def setup_inputs():

    _w = lambda a: (lambda t: t.to(torch.bfloat16) if t.is_floating_point() else t)(torch.as_tensor(a))

    def _A_setup():
        B, S, D, H = (1, 2048, 576, 32)
        return {'x': _w((lambda *s: torch.randn(*s, dtype=torch.bfloat16) * 0.05)(B, S, D)), 'wqkv': _w((lambda *s: torch.randn(*s, dtype=torch.bfloat16) * 0.05)(D, 3 * D)), 'wo': _w((lambda *s: torch.randn(*s, dtype=torch.bfloat16) * 0.05)(D, D))}
    _A_in = _A_setup()

    def _B_setup():
        B, S, D, F = (1, 2048, 576, 4608)
        return {'x': _w((lambda *s: torch.randn(*s, dtype=torch.bfloat16) * 0.05)(B, S, D)), 'w1': _w((lambda *s: torch.randn(*s, dtype=torch.bfloat16) * 3.2)(D, F) * D ** (-0.5)), 'w2': _w((lambda *s: torch.randn(*s, dtype=torch.bfloat16) * 0.4)(F, D) * F ** (-0.5))}
    _B_in = _B_setup()
    return {'A_x': _A_in['x'], 'A_wqkv': _A_in['wqkv'], 'A_wo': _A_in['wo'], 'B_x': _B_in['x'], 'B_w1': _B_in['w1'], 'B_w2': _B_in['w2'], 'c': _w((lambda *s: torch.randn(*s, dtype=torch.bfloat16) * 0.1)(1, 576) * 8.0), 'w_mod': _w((lambda *s: torch.randn(*s, dtype=torch.bfloat16) * 0.1)(576, 6 * 576) * 576 ** (-0.5) * 8.0)}

def reference(A_x, A_wqkv, A_wo, B_x, B_w1, B_w2, c, w_mod):

    def _A_ref(x, wqkv, wo):
        B, S, D = x.shape
        H = 32
        Dh = D // H
        qkv = (lambda x, *d: x.permute(*d))((x @ wqkv).reshape(B, S, 3, H, Dh), 2, 0, 3, 1, 4)
        q, k, v = (qkv[0], qkv[1], qkv[2])
        scores = torch.einsum('bhqd,bhkd->bhqk', q, k) * Dh ** (-0.5)
        p = _softmax(scores, axis=-1)
        o = torch.einsum('bhqk,bhkd->bhqd', p, v)
        return (lambda x, *d: x.permute(*d))(o, 0, 2, 1, 3).reshape(B, S, D) @ wo

    def _B_ref(x, w1, w2):
        h = torch.einsum('bsd,df->bsf', x, w1)
        h = _silu(h)
        out = torch.einsum('bsf,fd->bsd', h, w2)
        return out
    x = A_x
    mod = (_silu(c) @ w_mod).reshape(c.shape[0], 6, 1, -1)
    sa, ca, ga, sb, cb, gb = (mod[:, 0].clone(), mod[:, 1].clone(), mod[:, 2].clone(), mod[:, 3].clone(), mod[:, 4].clone(), mod[:, 5].clone())
    h = _layernorm(x, axis=-1) * (1 + ca) + sa
    x = x + ga * _A_ref(h, A_wqkv, A_wo)
    h = _layernorm(x, axis=-1) * (1 + cb) + sb
    x = x + gb * _B_ref(h, B_w1, B_w2)
    return x
```

```asm
; @launch kernel=k0_kernel grid=(488,1,1) block=(256,1,1) lds=6144
; @launch kernel=k1_kernel grid=(193,1,1) block=(768,1,1) lds=145920
; @launch kernel=k2_kernel grid=(256,1,1) block=(1024,1,1) lds=163840
; @launch kernel=k34_kernel grid=(256,1,1) block=(768,1,1) lds=152640
.amdgcn_target "amdgcn-amd-amdhsa--gfx950"
.text
.globl k0_kernel
.p2align 8
.type k0_kernel,@function
k0_kernel:
    s_cmp_ge_u32 s2, 488
    s_cbranch_scc1 K0_END
    s_load_dwordx2 s[4:5], s[0:1], 80
    s_mov_b32 s32, s2
    s_cmp_lt_u32 s2, 72
    s_cbranch_scc1 K0_G
    s_cmp_lt_u32 s2, 200
    s_cbranch_scc1 K0_LN
    s_cmp_lt_u32 s2, 344
    s_cbranch_scc1 K0_W
    s_sub_u32 s32, s2, 272
K0_G:
    s_load_dwordx2 s[8:9], s[0:1], 48
    s_load_dwordx2 s[10:11], s[0:1], 56
    s_lshr_b32 s33, s32, 1
    s_and_b32 s34, s32, 1
    v_and_b32 v1, 3, v0
    v_lshrrev_b32 v2, 2, v0
    s_movk_i32 s24, 6912
    v_mul_lo_u32 v3, v2, s24
    v_lshl_add_u32 v3, v1, 4, v3
    v_lshlrev_b32 v4, 1, v2
    s_lshl_b32 s35, s33, 6
    s_mul_i32 s36, s34, 1990656
    s_add_u32 s35, s35, s36
    s_mul_i32 s37, s34, 576
    v_cmp_gt_u32 vcc, 32, v2
    v_mov_b32 v5, 0x7f000000
    s_nop 0
    v_cndmask_b32 v8, v5, v3, vcc
    v_cndmask_b32 v9, v5, v4, vcc
    s_waitcnt lgkmcnt(0)
    s_mov_b32 s12, s10
    s_mov_b32 s13, s11
    s_mov_b32 s14, 3981312
    s_mov_b32 s15, 0x00020000
    s_mov_b32 s16, s8
    s_mov_b32 s17, s9
    s_mov_b32 s18, 1152
    s_mov_b32 s19, 0x00020000
    buffer_load_ushort v10, v4, s[16:19], s37 offen offset:0
    buffer_load_ushort v11, v4, s[16:19], s37 offen offset:128
    buffer_load_ushort v12, v4, s[16:19], s37 offen offset:256
    buffer_load_ushort v13, v4, s[16:19], s37 offen offset:384
    buffer_load_ushort v14, v9, s[16:19], s37 offen offset:512
    buffer_load_dwordx4 v[20:23], v3, s[12:15], s35 offen
    s_add_u32 s35, s35, 442368
    buffer_load_dwordx4 v[24:27], v3, s[12:15], s35 offen
    s_add_u32 s35, s35, 442368
    buffer_load_dwordx4 v[28:31], v3, s[12:15], s35 offen
    s_add_u32 s35, s35, 442368
    buffer_load_dwordx4 v[32:35], v3, s[12:15], s35 offen
    s_add_u32 s35, s35, 442368
    buffer_load_dwordx4 v[36:39], v8, s[12:15], s35 offen
    s_waitcnt vmcnt(5)
    v_lshlrev_b32 v10, 16, v10
    v_mul_f32 v5, 0xbfb8aa3b, v10
    v_exp_f32 v5, v5
    s_nop 0
    v_add_f32 v5, 1.0, v5
    v_rcp_f32 v5, v5
    s_nop 0
    v_mul_f32 v10, v10, v5
    v_cvt_pk_bf16_f32 v10, v10, v10
    v_lshlrev_b32 v10, 16, v10
    v_lshlrev_b32 v11, 16, v11
    v_mul_f32 v5, 0xbfb8aa3b, v11
    v_exp_f32 v5, v5
    s_nop 0
    v_add_f32 v5, 1.0, v5
    v_rcp_f32 v5, v5
    s_nop 0
    v_mul_f32 v11, v11, v5
    v_cvt_pk_bf16_f32 v11, v11, v11
    v_lshlrev_b32 v11, 16, v11
    v_lshlrev_b32 v12, 16, v12
    v_mul_f32 v5, 0xbfb8aa3b, v12
    v_exp_f32 v5, v5
    s_nop 0
    v_add_f32 v5, 1.0, v5
    v_rcp_f32 v5, v5
    s_nop 0
    v_mul_f32 v12, v12, v5
    v_cvt_pk_bf16_f32 v12, v12, v12
    v_lshlrev_b32 v12, 16, v12
    v_lshlrev_b32 v13, 16, v13
    v_mul_f32 v5, 0xbfb8aa3b, v13
    v_exp_f32 v5, v5
    s_nop 0
    v_add_f32 v5, 1.0, v5
    v_rcp_f32 v5, v5
    s_nop 0
    v_mul_f32 v13, v13, v5
    v_cvt_pk_bf16_f32 v13, v13, v13
    v_lshlrev_b32 v13, 16, v13
    v_lshlrev_b32 v14, 16, v14
    v_mul_f32 v5, 0xbfb8aa3b, v14
    v_exp_f32 v5, v5
    s_nop 0
    v_add_f32 v5, 1.0, v5
    v_rcp_f32 v5, v5
    s_nop 0
    v_mul_f32 v14, v14, v5
    v_cvt_pk_bf16_f32 v14, v14, v14
    v_lshlrev_b32 v14, 16, v14
    v_mov_b32 v40, 0
    v_mov_b32 v41, 0
    v_mov_b32 v42, 0
    v_mov_b32 v43, 0
    v_mov_b32 v44, 0
    v_mov_b32 v45, 0
    v_mov_b32 v46, 0
    v_mov_b32 v47, 0
    s_waitcnt vmcnt(4)
    v_lshlrev_b32 v5, 16, v20
    v_and_b32 v6, 0xffff0000, v20
    v_fmac_f32 v40, v10, v5
    v_fmac_f32 v41, v10, v6
    v_lshlrev_b32 v5, 16, v21
    v_and_b32 v6, 0xffff0000, v21
    v_fmac_f32 v42, v10, v5
    v_fmac_f32 v43, v10, v6
    v_lshlrev_b32 v5, 16, v22
    v_and_b32 v6, 0xffff0000, v22
    v_fmac_f32 v44, v10, v5
    v_fmac_f32 v45, v10, v6
    v_lshlrev_b32 v5, 16, v23
    v_and_b32 v6, 0xffff0000, v23
    v_fmac_f32 v46, v10, v5
    v_fmac_f32 v47, v10, v6
    s_waitcnt vmcnt(3)
    v_lshlrev_b32 v5, 16, v24
    v_and_b32 v6, 0xffff0000, v24
    v_fmac_f32 v40, v11, v5
    v_fmac_f32 v41, v11, v6
    v_lshlrev_b32 v5, 16, v25
    v_and_b32 v6, 0xffff0000, v25
    v_fmac_f32 v42, v11, v5
    v_fmac_f32 v43, v11, v6
    v_lshlrev_b32 v5, 16, v26
    v_and_b32 v6, 0xffff0000, v26
    v_fmac_f32 v44, v11, v5
    v_fmac_f32 v45, v11, v6
    v_lshlrev_b32 v5, 16, v27
    v_and_b32 v6, 0xffff0000, v27
    v_fmac_f32 v46, v11, v5
    v_fmac_f32 v47, v11, v6
    s_waitcnt vmcnt(2)
    v_lshlrev_b32 v5, 16, v28
    v_and_b32 v6, 0xffff0000, v28
    v_fmac_f32 v40, v12, v5
    v_fmac_f32 v41, v12, v6
    v_lshlrev_b32 v5, 16, v29
    v_and_b32 v6, 0xffff0000, v29
    v_fmac_f32 v42, v12, v5
    v_fmac_f32 v43, v12, v6
    v_lshlrev_b32 v5, 16, v30
    v_and_b32 v6, 0xffff0000, v30
    v_fmac_f32 v44, v12, v5
    v_fmac_f32 v45, v12, v6
    v_lshlrev_b32 v5, 16, v31
    v_and_b32 v6, 0xffff0000, v31
    v_fmac_f32 v46, v12, v5
    v_fmac_f32 v47, v12, v6
    s_waitcnt vmcnt(1)
    v_lshlrev_b32 v5, 16, v32
    v_and_b32 v6, 0xffff0000, v32
    v_fmac_f32 v40, v13, v5
    v_fmac_f32 v41, v13, v6
    v_lshlrev_b32 v5, 16, v33
    v_and_b32 v6, 0xffff0000, v33
    v_fmac_f32 v42, v13, v5
    v_fmac_f32 v43, v13, v6
    v_lshlrev_b32 v5, 16, v34
    v_and_b32 v6, 0xffff0000, v34
    v_fmac_f32 v44, v13, v5
    v_fmac_f32 v45, v13, v6
    v_lshlrev_b32 v5, 16, v35
    v_and_b32 v6, 0xffff0000, v35
    v_fmac_f32 v46, v13, v5
    v_fmac_f32 v47, v13, v6
    s_waitcnt vmcnt(0)
    v_lshlrev_b32 v5, 16, v36
    v_and_b32 v6, 0xffff0000, v36
    v_fmac_f32 v40, v14, v5
    v_fmac_f32 v41, v14, v6
    v_lshlrev_b32 v5, 16, v37
    v_and_b32 v6, 0xffff0000, v37
    v_fmac_f32 v42, v14, v5
    v_fmac_f32 v43, v14, v6
    v_lshlrev_b32 v5, 16, v38
    v_and_b32 v6, 0xffff0000, v38
    v_fmac_f32 v44, v14, v5
    v_fmac_f32 v45, v14, v6
    v_lshlrev_b32 v5, 16, v39
    v_and_b32 v6, 0xffff0000, v39
    v_fmac_f32 v46, v14, v5
    v_fmac_f32 v47, v14, v6
    v_add_f32_dpp v40, v40, v40 row_ror:4 row_mask:0xf bank_mask:0xf
    v_add_f32_dpp v41, v41, v41 row_ror:4 row_mask:0xf bank_mask:0xf
    v_add_f32_dpp v42, v42, v42 row_ror:4 row_mask:0xf bank_mask:0xf
    v_add_f32_dpp v43, v43, v43 row_ror:4 row_mask:0xf bank_mask:0xf
    v_add_f32_dpp v44, v44, v44 row_ror:4 row_mask:0xf bank_mask:0xf
    v_add_f32_dpp v45, v45, v45 row_ror:4 row_mask:0xf bank_mask:0xf
    v_add_f32_dpp v46, v46, v46 row_ror:4 row_mask:0xf bank_mask:0xf
    v_add_f32_dpp v47, v47, v47 row_ror:4 row_mask:0xf bank_mask:0xf
    v_add_f32_dpp v40, v40, v40 row_ror:8 row_mask:0xf bank_mask:0xf
    v_add_f32_dpp v41, v41, v41 row_ror:8 row_mask:0xf bank_mask:0xf
    v_add_f32_dpp v42, v42, v42 row_ror:8 row_mask:0xf bank_mask:0xf
    v_add_f32_dpp v43, v43, v43 row_ror:8 row_mask:0xf bank_mask:0xf
    v_add_f32_dpp v44, v44, v44 row_ror:8 row_mask:0xf bank_mask:0xf
    v_add_f32_dpp v45, v45, v45 row_ror:8 row_mask:0xf bank_mask:0xf
    v_add_f32_dpp v46, v46, v46 row_ror:8 row_mask:0xf bank_mask:0xf
    v_add_f32_dpp v47, v47, v47 row_ror:8 row_mask:0xf bank_mask:0xf
    v_mov_b32 v50, v40
    v_mov_b32 v51, v41
    v_mov_b32 v52, v42
    v_mov_b32 v53, v43
    v_mov_b32 v54, v44
    v_mov_b32 v55, v45
    v_mov_b32 v56, v46
    v_mov_b32 v57, v47
    v_permlane16_swap_b32 v40, v50
    v_permlane16_swap_b32 v41, v51
    v_permlane16_swap_b32 v42, v52
    v_permlane16_swap_b32 v43, v53
    v_permlane16_swap_b32 v44, v54
    v_permlane16_swap_b32 v45, v55
    v_permlane16_swap_b32 v46, v56
    v_permlane16_swap_b32 v47, v57
    v_add_f32 v40, v40, v50
    v_add_f32 v41, v41, v51
    v_add_f32 v42, v42, v52
    v_add_f32 v43, v43, v53
    v_add_f32 v44, v44, v54
    v_add_f32 v45, v45, v55
    v_add_f32 v46, v46, v56
    v_add_f32 v47, v47, v57
    v_mov_b32 v50, v40
    v_mov_b32 v51, v41
    v_mov_b32 v52, v42
    v_mov_b32 v53, v43
    v_mov_b32 v54, v44
    v_mov_b32 v55, v45
    v_mov_b32 v56, v46
    v_mov_b32 v57, v47
    v_permlane32_swap_b32 v40, v50
    v_permlane32_swap_b32 v41, v51
    v_permlane32_swap_b32 v42, v52
    v_permlane32_swap_b32 v43, v53
    v_permlane32_swap_b32 v44, v54
    v_permlane32_swap_b32 v45, v55
    v_permlane32_swap_b32 v46, v56
    v_permlane32_swap_b32 v47, v57
    v_add_f32 v40, v40, v50
    v_add_f32 v41, v41, v51
    v_add_f32 v42, v42, v52
    v_add_f32 v43, v43, v53
    v_add_f32 v44, v44, v54
    v_add_f32 v45, v45, v55
    v_add_f32 v46, v46, v56
    v_add_f32 v47, v47, v57
    v_lshrrev_b32 v7, 6, v0
    v_lshlrev_b32 v7, 7, v7
    v_lshl_add_u32 v7, v1, 5, v7
    v_and_b32 v8, 63, v0
    v_cmp_gt_u32 vcc, 4, v8
    s_nop 0
    s_and_saveexec_b64 s[28:29], vcc
    ds_write_b128 v7, v[40:43]
    ds_write_b128 v7, v[44:47] offset:16
    s_mov_b64 exec, s[28:29]
    s_waitcnt lgkmcnt(0)
    s_barrier
    v_cmp_gt_u32 vcc, 32, v0
    s_nop 0
    s_and_saveexec_b64 s[28:29], vcc
    s_cbranch_execz K0_END
    v_lshlrev_b32 v8, 2, v0
    ds_read_b32 v20, v8 offset:0
    ds_read_b32 v21, v8 offset:128
    ds_read_b32 v22, v8 offset:256
    ds_read_b32 v23, v8 offset:384
    s_waitcnt lgkmcnt(0)
    v_add_f32 v20, v20, v21
    v_add_f32 v22, v22, v23
    v_add_f32 v20, v20, v22
    s_mov_b32 s12, s4
    s_mov_b32 s13, s5
    s_mov_b32 s14, 27648
    s_mov_b32 s15, 0x00020000
    s_lshl_b32 s25, s33, 7
    s_mul_i32 s26, s34, 13824
    s_add_u32 s25, s25, s26
    buffer_store_dword v20, v8, s[12:15], s25 offen
    s_endpgm
K0_LN:
    s_load_dwordx2 s[6:7], s[0:1], 0
    s_sub_u32 s24, s2, 72
    s_lshl_b32 s24, s24, 4
    v_lshrrev_b32 v1, 4, v0
    v_add_u32 v1, s24, v1
    v_and_b32 v2, 15, v0
    s_movk_i32 s25, 1152
    v_mul_lo_u32 v3, v1, s25
    v_lshl_add_u32 v3, v2, 4, v3
    v_cmp_gt_u32 vcc, 8, v2
    v_mov_b32 v5, 0x7f000000
    s_nop 0
    v_cndmask_b32 v10, v5, v3, vcc
    s_waitcnt lgkmcnt(0)
    s_mov_b32 s12, s6
    s_mov_b32 s13, s7
    s_mov_b32 s14, 2359296
    s_mov_b32 s15, 0x00020000
    buffer_load_dwordx4 v[20:23], v3, s[12:15], 0 offen offset:0
    buffer_load_dwordx4 v[24:27], v3, s[12:15], 0 offen offset:256
    buffer_load_dwordx4 v[28:31], v3, s[12:15], 0 offen offset:512
    buffer_load_dwordx4 v[32:35], v3, s[12:15], 0 offen offset:768
    buffer_load_dwordx4 v[36:39], v10, s[12:15], 0 offen offset:1024
    s_add_u32 s16, s4, 57344
    s_addc_u32 s17, s5, 0
    s_mov_b32 s18, 2359296
    s_mov_b32 s19, 0x00020000
    s_add_u32 s20, s4, 2416640
    s_addc_u32 s21, s5, 0
    s_mov_b32 s22, 2359296
    s_mov_b32 s23, 0x00020000
    v_lshrrev_b32 v4, 4, v1
    v_mul_u32_u24 v4, 18, v4
    v_lshrrev_b32 v5, 2, v2
    v_add_u32 v4, v4, v5
    v_lshlrev_b32 v4, 6, v4
    v_and_b32 v5, 1, v2
    v_lshl_add_u32 v4, v5, 5, v4
    v_and_b32 v5, 15, v1
    v_add_u32 v4, v4, v5
    v_lshlrev_b32 v4, 4, v4
    v_bfe_u32 v5, v2, 1, 1
    v_lshl_add_u32 v4, v5, 3, v4
    v_cmp_gt_u32 vcc, 8, v2
    v_mov_b32 v5, 0x7f000000
    s_nop 0
    v_cndmask_b32 v11, v5, v4, vcc
    v_mov_b32 v6, 0
    v_mov_b32 v7, 0
    s_mov_b32 s26, 0
    s_waitcnt vmcnt(4)
    buffer_store_dwordx2 v[20:21], v4, s[20:23], s26 offen
    buffer_store_dwordx2 v[22:23], v4, s[20:23], s26 offen offset:256
    s_add_u32 s26, s26, 4096
    v_lshlrev_b32 v44, 16, v20
    v_and_b32 v45, 0xffff0000, v20
    v_add_f32 v6, v6, v44
    v_fmac_f32 v7, v44, v44
    v_add_f32 v6, v6, v45
    v_fmac_f32 v7, v45, v45
    v_lshlrev_b32 v46, 16, v21
    v_and_b32 v47, 0xffff0000, v21
    v_add_f32 v6, v6, v46
    v_fmac_f32 v7, v46, v46
    v_add_f32 v6, v6, v47
    v_fmac_f32 v7, v47, v47
    v_lshlrev_b32 v48, 16, v22
    v_and_b32 v49, 0xffff0000, v22
    v_add_f32 v6, v6, v48
    v_fmac_f32 v7, v48, v48
    v_add_f32 v6, v6, v49
    v_fmac_f32 v7, v49, v49
    v_lshlrev_b32 v50, 16, v23
    v_and_b32 v51, 0xffff0000, v23
    v_add_f32 v6, v6, v50
    v_fmac_f32 v7, v50, v50
    v_add_f32 v6, v6, v51
    v_fmac_f32 v7, v51, v51
    s_waitcnt vmcnt(5)
    buffer_store_dwordx2 v[24:25], v4, s[20:23], s26 offen
    buffer_store_dwordx2 v[26:27], v4, s[20:23], s26 offen offset:256
    s_add_u32 s26, s26, 4096
    v_lshlrev_b32 v52, 16, v24
    v_and_b32 v53, 0xffff0000, v24
    v_add_f32 v6, v6, v52
    v_fmac_f32 v7, v52, v52
    v_add_f32 v6, v6, v53
    v_fmac_f32 v7, v53, v53
    v_lshlrev_b32 v54, 16, v25
    v_and_b32 v55, 0xffff0000, v25
    v_add_f32 v6, v6, v54
    v_fmac_f32 v7, v54, v54
    v_add_f32 v6, v6, v55
    v_fmac_f32 v7, v55, v55
    v_lshlrev_b32 v56, 16, v26
    v_and_b32 v57, 0xffff0000, v26
    v_add_f32 v6, v6, v56
    v_fmac_f32 v7, v56, v56
    v_add_f32 v6, v6, v57
    v_fmac_f32 v7, v57, v57
    v_lshlrev_b32 v58, 16, v27
    v_and_b32 v59, 0xffff0000, v27
    v_add_f32 v6, v6, v58
    v_fmac_f32 v7, v58, v58
    v_add_f32 v6, v6, v59
    v_fmac_f32 v7, v59, v59
    s_waitcnt vmcnt(6)
    buffer_store_dwordx2 v[28:29], v4, s[20:23], s26 offen
    buffer_store_dwordx2 v[30:31], v4, s[20:23], s26 offen offset:256
    s_add_u32 s26, s26, 4096
    v_lshlrev_b32 v60, 16, v28
    v_and_b32 v61, 0xffff0000, v28
    v_add_f32 v6, v6, v60
    v_fmac_f32 v7, v60, v60
    v_add_f32 v6, v6, v61
    v_fmac_f32 v7, v61, v61
    v_lshlrev_b32 v62, 16, v29
    v_and_b32 v63, 0xffff0000, v29
    v_add_f32 v6, v6, v62
    v_fmac_f32 v7, v62, v62
    v_add_f32 v6, v6, v63
    v_fmac_f32 v7, v63, v63
    v_lshlrev_b32 v64, 16, v30
    v_and_b32 v65, 0xffff0000, v30
    v_add_f32 v6, v6, v64
    v_fmac_f32 v7, v64, v64
    v_add_f32 v6, v6, v65
    v_fmac_f32 v7, v65, v65
    v_lshlrev_b32 v66, 16, v31
    v_and_b32 v67, 0xffff0000, v31
    v_add_f32 v6, v6, v66
    v_fmac_f32 v7, v66, v66
    v_add_f32 v6, v6, v67
    v_fmac_f32 v7, v67, v67
    s_waitcnt vmcnt(7)
    buffer_store_dwordx2 v[32:33], v4, s[20:23], s26 offen
    buffer_store_dwordx2 v[34:35], v4, s[20:23], s26 offen offset:256
    s_add_u32 s26, s26, 4096
    v_lshlrev_b32 v68, 16, v32
    v_and_b32 v69, 0xffff0000, v32
    v_add_f32 v6, v6, v68
    v_fmac_f32 v7, v68, v68
    v_add_f32 v6, v6, v69
    v_fmac_f32 v7, v69, v69
    v_lshlrev_b32 v70, 16, v33
    v_and_b32 v71, 0xffff0000, v33
    v_add_f32 v6, v6, v70
    v_fmac_f32 v7, v70, v70
    v_add_f32 v6, v6, v71
    v_fmac_f32 v7, v71, v71
    v_lshlrev_b32 v72, 16, v34
    v_and_b32 v73, 0xffff0000, v34
    v_add_f32 v6, v6, v72
    v_fmac_f32 v7, v72, v72
    v_add_f32 v6, v6, v73
    v_fmac_f32 v7, v73, v73
    v_lshlrev_b32 v74, 16, v35
    v_and_b32 v75, 0xffff0000, v35
    v_add_f32 v6, v6, v74
    v_fmac_f32 v7, v74, v74
    v_add_f32 v6, v6, v75
    v_fmac_f32 v7, v75, v75
    s_waitcnt vmcnt(8)
    buffer_store_dwordx2 v[36:37], v11, s[20:23], s26 offen
    buffer_store_dwordx2 v[38:39], v11, s[20:23], s26 offen offset:256
    v_lshlrev_b32 v76, 16, v36
    v_and_b32 v77, 0xffff0000, v36
    v_add_f32 v6, v6, v76
    v_fmac_f32 v7, v76, v76
    v_add_f32 v6, v6, v77
    v_fmac_f32 v7, v77, v77
    v_lshlrev_b32 v78, 16, v37
    v_and_b32 v79, 0xffff0000, v37
    v_add_f32 v6, v6, v78
    v_fmac_f32 v7, v78, v78
    v_add_f32 v6, v6, v79
    v_fmac_f32 v7, v79, v79
    v_lshlrev_b32 v80, 16, v38
    v_and_b32 v81, 0xffff0000, v38
    v_add_f32 v6, v6, v80
    v_fmac_f32 v7, v80, v80
    v_add_f32 v6, v6, v81
    v_fmac_f32 v7, v81, v81
    v_lshlrev_b32 v82, 16, v39
    v_and_b32 v83, 0xffff0000, v39
    v_add_f32 v6, v6, v82
    v_fmac_f32 v7, v82, v82
    v_add_f32 v6, v6, v83
    v_fmac_f32 v7, v83, v83
    s_nop 0
    v_add_f32_dpp v6, v6, v6 quad_perm:[1,0,3,2] row_mask:0xf bank_mask:0xf
    v_add_f32_dpp v7, v7, v7 quad_perm:[1,0,3,2] row_mask:0xf bank_mask:0xf
    s_nop 0
    v_add_f32_dpp v6, v6, v6 quad_perm:[2,3,0,1] row_mask:0xf bank_mask:0xf
    v_add_f32_dpp v7, v7, v7 quad_perm:[2,3,0,1] row_mask:0xf bank_mask:0xf
    s_nop 0
    v_add_f32_dpp v6, v6, v6 row_half_mirror row_mask:0xf bank_mask:0xf
    v_add_f32_dpp v7, v7, v7 row_half_mirror row_mask:0xf bank_mask:0xf
    s_nop 0
    v_add_f32_dpp v6, v6, v6 row_mirror row_mask:0xf bank_mask:0xf
    v_add_f32_dpp v7, v7, v7 row_mirror row_mask:0xf bank_mask:0xf
    v_mul_f32 v6, 0x3ae38e39, v6
    v_mul_f32 v7, 0x3ae38e39, v7
    v_fma_f32 v7, -v6, v6, v7
    v_max_f32 v7, 0, v7
    v_add_f32 v7, 0x3727c5ac, v7
    v_rsq_f32 v7, v7
    s_nop 0
    v_mul_f32 v6, v6, v7
    v_sub_f32 v6, 0, v6
    v_fma_f32 v44, v44, v7, v6
    v_fma_f32 v45, v45, v7, v6
    v_fma_f32 v46, v46, v7, v6
    v_fma_f32 v47, v47, v7, v6
    v_fma_f32 v48, v48, v7, v6
    v_fma_f32 v49, v49, v7, v6
    v_fma_f32 v50, v50, v7, v6
    v_fma_f32 v51, v51, v7, v6
    v_fma_f32 v52, v52, v7, v6
    v_fma_f32 v53, v53, v7, v6
    v_fma_f32 v54, v54, v7, v6
    v_fma_f32 v55, v55, v7, v6
    v_fma_f32 v56, v56, v7, v6
    v_fma_f32 v57, v57, v7, v6
    v_fma_f32 v58, v58, v7, v6
    v_fma_f32 v59, v59, v7, v6
    v_fma_f32 v60, v60, v7, v6
    v_fma_f32 v61, v61, v7, v6
    v_fma_f32 v62, v62, v7, v6
    v_fma_f32 v63, v63, v7, v6
    v_fma_f32 v64, v64, v7, v6
    v_fma_f32 v65, v65, v7, v6
    v_fma_f32 v66, v66, v7, v6
    v_fma_f32 v67, v67, v7, v6
    v_fma_f32 v68, v68, v7, v6
    v_fma_f32 v69, v69, v7, v6
    v_fma_f32 v70, v70, v7, v6
    v_fma_f32 v71, v71, v7, v6
    v_fma_f32 v72, v72, v7, v6
    v_fma_f32 v73, v73, v7, v6
    v_fma_f32 v74, v74, v7, v6
    v_fma_f32 v75, v75, v7, v6
    v_fma_f32 v76, v76, v7, v6
    v_fma_f32 v77, v77, v7, v6
    v_fma_f32 v78, v78, v7, v6
    v_fma_f32 v79, v79, v7, v6
    v_fma_f32 v80, v80, v7, v6
    v_fma_f32 v81, v81, v7, v6
    v_fma_f32 v82, v82, v7, v6
    v_fma_f32 v83, v83, v7, v6
    s_mov_b32 s26, 0
    v_cvt_pk_bf16_f32 v84, v44, v45
    v_cvt_pk_bf16_f32 v85, v46, v47
    v_cvt_pk_bf16_f32 v86, v48, v49
    v_cvt_pk_bf16_f32 v87, v50, v51
    buffer_store_dwordx2 v[84:85], v4, s[16:19], s26 offen
    buffer_store_dwordx2 v[86:87], v4, s[16:19], s26 offen offset:256
    s_add_u32 s26, s26, 4096
    v_cvt_pk_bf16_f32 v88, v52, v53
    v_cvt_pk_bf16_f32 v89, v54, v55
    v_cvt_pk_bf16_f32 v90, v56, v57
    v_cvt_pk_bf16_f32 v91, v58, v59
    buffer_store_dwordx2 v[88:89], v4, s[16:19], s26 offen
    buffer_store_dwordx2 v[90:91], v4, s[16:19], s26 offen offset:256
    s_add_u32 s26, s26, 4096
    v_cvt_pk_bf16_f32 v84, v60, v61
    v_cvt_pk_bf16_f32 v85, v62, v63
    v_cvt_pk_bf16_f32 v86, v64, v65
    v_cvt_pk_bf16_f32 v87, v66, v67
    buffer_store_dwordx2 v[84:85], v4, s[16:19], s26 offen
    buffer_store_dwordx2 v[86:87], v4, s[16:19], s26 offen offset:256
    s_add_u32 s26, s26, 4096
    v_cvt_pk_bf16_f32 v88, v68, v69
    v_cvt_pk_bf16_f32 v89, v70, v71
    v_cvt_pk_bf16_f32 v90, v72, v73
    v_cvt_pk_bf16_f32 v91, v74, v75
    buffer_store_dwordx2 v[88:89], v4, s[16:19], s26 offen
    buffer_store_dwordx2 v[90:91], v4, s[16:19], s26 offen offset:256
    s_add_u32 s26, s26, 4096
    v_cvt_pk_bf16_f32 v84, v76, v77
    v_cvt_pk_bf16_f32 v85, v78, v79
    v_cvt_pk_bf16_f32 v86, v80, v81
    v_cvt_pk_bf16_f32 v87, v82, v83
    buffer_store_dwordx2 v[84:85], v11, s[16:19], s26 offen
    buffer_store_dwordx2 v[86:87], v11, s[16:19], s26 offen offset:256
    s_endpgm
K0_W:
    s_load_dwordx2 s[30:31], s[0:1], 8
    s_cmp_ge_u32 s2, 208
    s_cbranch_scc1 K0_NCP
    v_readfirstlane_b32 s75, v0
    s_nop 0
    s_lshr_b32 s75, s75, 6
    s_cmp_ge_u32 s75, 4
    s_cbranch_scc1 CPF_K0_E
    s_getpc_b64 s[72:73]
CPF_K0_PC:
    s_add_u32 s72, s72, k1_kernel-CPF_K0_PC
    s_addc_u32 s73, s73, 0
    s_lshl_b32 s74, s75, 13
    s_add_u32 s72, s72, s74
    s_addc_u32 s73, s73, 0
    v_and_b32 v60, 63, v0
    v_lshlrev_b32 v60, 7, v60
    v_mov_b32 v61, s73
    v_add_co_u32 v60, vcc, s72, v60
    s_nop 1
    v_addc_co_u32 v61, vcc, 0, v61, vcc
    global_load_dword v62, v[60:61], off
CPF_K0_E:
K0_NCP:
    s_sub_u32 s33, s2, 200
    s_and_b32 s37, s33, 1
    s_bfe_u32 s35, s33, 0x20001
    s_lshr_b32 s36, s33, 3
    s_mul_i32 s25, s35, 216
    v_add_u32 v1, s25, v0
    v_lshlrev_b32 v1, 1, v1
    v_min_u32 v1, 1726, v1
    v_lshlrev_b32 v13, 1, v1
    s_mul_i32 s27, s36, 110592
    s_mul_i32 s28, s37, 27648
    s_add_u32 s27, s27, s28
    s_waitcnt lgkmcnt(0)
    s_mov_b32 s12, s30
    s_mov_b32 s13, s31
    s_mov_b32 s14, 1990656
    s_mov_b32 s15, 0x00020000
    s_movk_i32 s61, 216
    v_cmp_gt_u32 vcc, s61, v0
    s_nop 0
    s_and_saveexec_b64 s[62:63], vcc
    s_cbranch_execz K0_END
    s_add_u32 s38, s27, 0
    buffer_load_dword v20, v13, s[12:15], s38 offen
    s_add_u32 s38, s27, 3456
    buffer_load_dword v21, v13, s[12:15], s38 offen
    s_add_u32 s38, s27, 6912
    buffer_load_dword v22, v13, s[12:15], s38 offen
    s_add_u32 s38, s27, 10368
    buffer_load_dword v23, v13, s[12:15], s38 offen
    s_add_u32 s38, s27, 55296
    buffer_load_dword v24, v13, s[12:15], s38 offen
    s_add_u32 s38, s27, 58752
    buffer_load_dword v25, v13, s[12:15], s38 offen
    s_add_u32 s38, s27, 62208
    buffer_load_dword v26, v13, s[12:15], s38 offen
    s_add_u32 s38, s27, 65664
    buffer_load_dword v27, v13, s[12:15], s38 offen
    s_add_u32 s38, s27, 13824
    buffer_load_dword v28, v13, s[12:15], s38 offen
    s_add_u32 s38, s27, 17280
    buffer_load_dword v29, v13, s[12:15], s38 offen
    s_add_u32 s38, s27, 20736
    buffer_load_dword v30, v13, s[12:15], s38 offen
    s_add_u32 s38, s27, 24192
    buffer_load_dword v31, v13, s[12:15], s38 offen
    s_add_u32 s38, s27, 69120
    buffer_load_dword v32, v13, s[12:15], s38 offen
    s_add_u32 s38, s27, 72576
    buffer_load_dword v33, v13, s[12:15], s38 offen
    s_add_u32 s38, s27, 76032
    buffer_load_dword v34, v13, s[12:15], s38 offen
    s_add_u32 s38, s27, 79488
    buffer_load_dword v35, v13, s[12:15], s38 offen
    s_mov_b32 s60, 1821
    v_mul_u32_u24 v3, s60, v1
    v_lshrrev_b32 v3, 20, v3
    v_mul_u32_u24 v4, 576, v3
    v_sub_u32 v4, v1, v4
    s_mov_b32 s60, 911
    v_mul_u32_u24 v5, s60, v4
    v_lshrrev_b32 v5, 14, v5
    v_mul_u32_u24 v6, 18, v5
    v_sub_u32 v6, v4, v6
    v_lshrrev_b32 v7, 3, v5
    v_lshl_add_u32 v7, v3, 2, v7
    v_and_b32 v8, 7, v5
    v_and_b32 v9, 6, v8
    v_bfe_u32 v10, v6, 2, 1
    v_add_u32 v9, v9, v10
    v_and_b32 v10, 1, v8
    v_lshlrev_b32 v10, 3, v10
    v_bfe_u32 v11, v6, 3, 1
    v_lshl_add_u32 v10, v11, 2, v10
    v_and_b32 v11, 3, v6
    v_add_u32 v10, v10, v11
    v_cmp_eq_u32 vcc, 2, v3
    s_nop 1
    v_cndmask_b32 v9, v9, v8, vcc
    v_cndmask_b32 v10, v10, v6, vcc
    v_lshlrev_b32 v11, 1, v8
    v_add_u32 v11, v11, v6
    v_subrev_u32 v11, 16, v11
    v_cmp_le_u32 vcc, 16, v6
    v_mov_b32 v12, 8
    s_nop 0
    v_cndmask_b32 v9, v9, v12, vcc
    v_cndmask_b32 v10, v10, v11, vcc
    v_mul_u32_u24 v7, 162, v7
    v_add_u32 v7, v7, v9
    v_lshlrev_b32 v2, 10, v7
    v_lshl_add_u32 v2, v10, 4, v2
    s_add_u32 s16, s4, 4775936
    s_addc_u32 s17, s5, 0
    s_mov_b32 s18, 1990656
    s_mov_b32 s19, 0x00020000
    s_mul_i32 s28, s36, 9216
    s_lshl_b32 s29, s37, 9
    s_add_u32 s28, s28, s29
    s_mov_b32 s65, 0x05040100
    s_mov_b32 s66, 0x07060302
    s_waitcnt vmcnt(8)
    v_perm_b32 v40, v21, v20, s65
    v_perm_b32 v44, v21, v20, s66
    v_perm_b32 v41, v23, v22, s65
    v_perm_b32 v45, v23, v22, s66
    v_perm_b32 v42, v25, v24, s65
    v_perm_b32 v46, v25, v24, s66
    v_perm_b32 v43, v27, v26, s65
    v_perm_b32 v47, v27, v26, s66
    buffer_store_dwordx4 v[40:43], v2, s[16:19], s28 offen offset:0
    buffer_store_dwordx4 v[44:47], v2, s[16:19], s28 offen offset:16
    s_waitcnt vmcnt(2)
    v_perm_b32 v48, v29, v28, s65
    v_perm_b32 v52, v29, v28, s66
    v_perm_b32 v49, v31, v30, s65
    v_perm_b32 v53, v31, v30, s66
    v_perm_b32 v50, v33, v32, s65
    v_perm_b32 v54, v33, v32, s66
    v_perm_b32 v51, v35, v34, s65
    v_perm_b32 v55, v35, v34, s66
    buffer_store_dwordx4 v[48:51], v2, s[16:19], s28 offen offset:256
    buffer_store_dwordx4 v[52:55], v2, s[16:19], s28 offen offset:272
K0_END:
    s_endpgm

.text
.globl k1_kernel
.p2align 8
.type k1_kernel,@function
k1_kernel:
    s_cmp_ge_u32 s2, 193
    s_cbranch_scc1 K1_END
    s_load_dwordx2 s[4:5], s[0:1], 80
    s_cmp_ge_u32 s2, 192
    s_cbranch_scc1 K1_PREP
    v_lshrrev_b32 v1, 6, v0
    s_nop 0
    v_readfirstlane_b32 s20, v1
    v_and_b32 v1, 63, v0
    v_lshlrev_b32 v2, 4, v1
    s_and_b32 s33, s20, 3
    s_mul_i32 s23, s33, 4608
    v_add_u32 v3, s23, v2
    v_mov_b32 v6, v2
    v_add_u32 v7, 55296, v2
    v_lshrrev_b32 v8, 4, v1
    v_lshlrev_b32 v8, 6, v8
    v_add_u32 v8, 141312, v8
    s_lshl_b32 s26, s33, 11
    s_add_u32 s26, s26, 92160
    v_add_u32 v9, s26, v2
    v_add_u32 v10, 1024, v9
    s_and_b32 s26, s2, 7
    s_lshr_b32 s27, s2, 3
    s_lshr_b32 s21, s26, 1
    s_lshl_b32 s21, s21, 2
    s_and_b32 s28, s27, 3
    s_add_u32 s21, s21, s28
    s_and_b32 s22, s26, 1
    s_mul_i32 s22, s22, 6
    s_lshr_b32 s28, s27, 2
    s_add_u32 s22, s22, s28
    s_lshl_b32 s26, s21, 3
    s_lshl_b32 s27, s33, 1
    s_add_u32 s29, s26, s27
    s_lshl_b32 s34, s21, 2
    s_add_u32 s34, s34, s33
    s_cmp_lt_u32 s20, 4
    s_cbranch_scc1 K1_CONS
    s_waitcnt lgkmcnt(0)
    s_cmp_lt_u32 s20, 8
    s_cbranch_scc1 K1_PROD
    s_mul_i32 s26, s22, 165888
    s_add_u32 s8, s4, s26
    s_addc_u32 s9, s5, 0
    s_add_u32 s8, s8, 4775936
    s_addc_u32 s9, s9, 0
    s_mov_b32 s10, 165888
    s_mov_b32 s11, 0x00020000
    s_add_u32 m0, s23, 0
    s_mov_b32 s24, 0
    s_mov_b32 exec_hi, 0
    buffer_load_dwordx4 v3, s[8:11], s24 offen lds
    s_mov_b32 exec_hi, -1
    buffer_load_dwordx4 v3, s[8:11], s24 offen offset:512 lds
    buffer_load_dwordx4 v3, s[8:11], s24 offen offset:1536 lds
    buffer_load_dwordx4 v3, s[8:11], s24 offen offset:2560 lds
    buffer_load_dwordx4 v3, s[8:11], s24 offen offset:3584 lds
    s_add_u32 m0, s23, 18432
    s_mov_b32 s24, 18432
    s_mov_b32 exec_hi, 0
    buffer_load_dwordx4 v3, s[8:11], s24 offen lds
    s_mov_b32 exec_hi, -1
    buffer_load_dwordx4 v3, s[8:11], s24 offen offset:512 lds
    buffer_load_dwordx4 v3, s[8:11], s24 offen offset:1536 lds
    buffer_load_dwordx4 v3, s[8:11], s24 offen offset:2560 lds
    buffer_load_dwordx4 v3, s[8:11], s24 offen offset:3584 lds
    s_add_u32 m0, s23, 36864
    s_mov_b32 s24, 36864
    s_mov_b32 exec_hi, 0
    buffer_load_dwordx4 v3, s[8:11], s24 offen lds
    s_mov_b32 exec_hi, -1
    buffer_load_dwordx4 v3, s[8:11], s24 offen offset:512 lds
    buffer_load_dwordx4 v3, s[8:11], s24 offen offset:1536 lds
    buffer_load_dwordx4 v3, s[8:11], s24 offen offset:2560 lds
    buffer_load_dwordx4 v3, s[8:11], s24 offen offset:3584 lds
    s_barrier
    s_waitcnt vmcnt(10)
    s_barrier
    s_add_u32 m0, s23, 55296
    s_mov_b32 s24, 55296
    s_mov_b32 exec_hi, 0
    buffer_load_dwordx4 v3, s[8:11], s24 offen lds
    s_mov_b32 exec_hi, -1
    buffer_load_dwordx4 v3, s[8:11], s24 offen offset:512 lds
    buffer_load_dwordx4 v3, s[8:11], s24 offen offset:1536 lds
    buffer_load_dwordx4 v3, s[8:11], s24 offen offset:2560 lds
    buffer_load_dwordx4 v3, s[8:11], s24 offen offset:3584 lds
    s_waitcnt vmcnt(10)
    s_barrier
    s_add_u32 m0, s23, 73728
    s_mov_b32 s24, 73728
    s_mov_b32 exec_hi, 0
    buffer_load_dwordx4 v3, s[8:11], s24 offen lds
    s_mov_b32 exec_hi, -1
    buffer_load_dwordx4 v3, s[8:11], s24 offen offset:512 lds
    buffer_load_dwordx4 v3, s[8:11], s24 offen offset:1536 lds
    buffer_load_dwordx4 v3, s[8:11], s24 offen offset:2560 lds
    buffer_load_dwordx4 v3, s[8:11], s24 offen offset:3584 lds
    s_waitcnt vmcnt(10)
    s_barrier
    s_add_u32 m0, s23, 0
    s_mov_b32 s24, 92160
    s_mov_b32 exec_hi, 0
    buffer_load_dwordx4 v3, s[8:11], s24 offen lds
    s_mov_b32 exec_hi, -1
    buffer_load_dwordx4 v3, s[8:11], s24 offen offset:512 lds
    buffer_load_dwordx4 v3, s[8:11], s24 offen offset:1536 lds
    buffer_load_dwordx4 v3, s[8:11], s24 offen offset:2560 lds
    buffer_load_dwordx4 v3, s[8:11], s24 offen offset:3584 lds
    s_waitcnt vmcnt(10)
    s_barrier
    s_add_u32 m0, s23, 18432
    s_mov_b32 s24, 110592
    s_mov_b32 exec_hi, 0
    buffer_load_dwordx4 v3, s[8:11], s24 offen lds
    s_mov_b32 exec_hi, -1
    buffer_load_dwordx4 v3, s[8:11], s24 offen offset:512 lds
    buffer_load_dwordx4 v3, s[8:11], s24 offen offset:1536 lds
    buffer_load_dwordx4 v3, s[8:11], s24 offen offset:2560 lds
    buffer_load_dwordx4 v3, s[8:11], s24 offen offset:3584 lds
    s_waitcnt vmcnt(10)
    s_barrier
    s_add_u32 m0, s23, 36864
    s_mov_b32 s24, 129024
    s_mov_b32 exec_hi, 0
    buffer_load_dwordx4 v3, s[8:11], s24 offen lds
    s_mov_b32 exec_hi, -1
    buffer_load_dwordx4 v3, s[8:11], s24 offen offset:512 lds
    buffer_load_dwordx4 v3, s[8:11], s24 offen offset:1536 lds
    buffer_load_dwordx4 v3, s[8:11], s24 offen offset:2560 lds
    buffer_load_dwordx4 v3, s[8:11], s24 offen offset:3584 lds
    s_waitcnt vmcnt(10)
    s_barrier
    s_add_u32 m0, s23, 55296
    s_mov_b32 s24, 147456
    s_mov_b32 exec_hi, 0
    buffer_load_dwordx4 v3, s[8:11], s24 offen lds
    s_mov_b32 exec_hi, -1
    buffer_load_dwordx4 v3, s[8:11], s24 offen offset:512 lds
    buffer_load_dwordx4 v3, s[8:11], s24 offen offset:1536 lds
    buffer_load_dwordx4 v3, s[8:11], s24 offen offset:2560 lds
    buffer_load_dwordx4 v3, s[8:11], s24 offen offset:3584 lds
    s_waitcnt vmcnt(10)
    s_barrier
    s_waitcnt vmcnt(5)
    s_barrier
    s_waitcnt vmcnt(0)
    s_barrier
    s_barrier
    s_endpgm
K1_PROD:
    s_add_u32 s12, s4, 57344
    s_addc_u32 s13, s5, 0
    s_mov_b32 s14, 2359296
    s_mov_b32 s15, 0x00020000
    s_and_b32 s36, s20, 1
    s_bfe_u32 s37, s20, 0x10001
    s_lshl_b32 s26, s21, 3
    s_lshl_b32 s27, s37, 2
    s_add_u32 s26, s26, s27
    s_mul_i32 s27, s26, 18432
    s_lshl_b32 s28, s36, 10
    s_add_u32 s27, s27, s28
    v_add_u32 v4, s27, v2
    s_lshl_b32 s28, s36, 8
    v_add_u32 v8, s28, v8
    s_lshl_b32 s27, s37, 12
    s_lshl_b32 s28, s36, 13
    s_add_u32 s27, s27, s28
    s_add_u32 s27, s27, 92160
    v_add_u32 v9, s27, v2
    s_mov_b32 s31, 1.0
    s_cmp_lt_u32 s22, 4
    s_cselect_b32 s31, 0x3eae1a93, s31
    v_subrev_u32 v10, 256, v0
    s_mov_b32 s16, s4
    s_mov_b32 s17, s5
    s_mov_b32 s18, 27648
    s_mov_b32 s19, 0x00020000
    v_lshlrev_b32 v11, 2, v10
    s_mov_b32 s26, 0
    buffer_load_dword v136, v11, s[16:19], s26 offen
    s_mov_b32 s26, 13824
    buffer_load_dword v137, v11, s[16:19], s26 offen
    s_mov_b32 s26, 2304
    buffer_load_dword v138, v11, s[16:19], s26 offen
    s_mov_b32 s26, 16128
    buffer_load_dword v139, v11, s[16:19], s26 offen
    s_mov_b32 s26, 1024
    buffer_load_dword v140, v11, s[16:19], s26 offen
    s_mov_b32 s26, 14848
    buffer_load_dword v141, v11, s[16:19], s26 offen
    s_mov_b32 s26, 3328
    buffer_load_dword v142, v11, s[16:19], s26 offen
    s_mov_b32 s26, 17152
    buffer_load_dword v143, v11, s[16:19], s26 offen
    s_mov_b32 s26, 2048
    buffer_load_dword v144, v11, s[16:19], s26 offen
    s_mov_b32 s26, 15872
    buffer_load_dword v145, v11, s[16:19], s26 offen
    s_mov_b32 s26, 4352
    buffer_load_dword v146, v11, s[16:19], s26 offen
    s_mov_b32 s26, 18176
    buffer_load_dword v147, v11, s[16:19], s26 offen
    s_mov_b32 s25, 0
    buffer_load_dwordx4 v[16:19], v4, s[12:15], s25 offen
    s_mov_b32 s25, 18432
    buffer_load_dwordx4 v[20:23], v4, s[12:15], s25 offen
    s_mov_b32 s25, 36864
    buffer_load_dwordx4 v[24:27], v4, s[12:15], s25 offen
    s_mov_b32 s25, 55296
    buffer_load_dwordx4 v[28:31], v4, s[12:15], s25 offen
    s_mov_b32 s25, 2048
    buffer_load_dwordx4 v[32:35], v4, s[12:15], s25 offen
    s_mov_b32 s25, 20480
    buffer_load_dwordx4 v[36:39], v4, s[12:15], s25 offen
    s_mov_b32 s25, 38912
    buffer_load_dwordx4 v[40:43], v4, s[12:15], s25 offen
    s_mov_b32 s25, 57344
    buffer_load_dwordx4 v[44:47], v4, s[12:15], s25 offen
    s_mov_b32 s25, 4096
    buffer_load_dwordx4 v[48:51], v4, s[12:15], s25 offen
    s_mov_b32 s25, 22528
    buffer_load_dwordx4 v[52:55], v4, s[12:15], s25 offen
    s_mov_b32 s25, 40960
    buffer_load_dwordx4 v[56:59], v4, s[12:15], s25 offen
    s_mov_b32 s25, 59392
    buffer_load_dwordx4 v[60:63], v4, s[12:15], s25 offen
    s_waitcnt vmcnt(12)
    v_add_f32 v136, v136, v137
    v_cvt_pk_bf16_f32 v136, v136, v136
    v_lshlrev_b32 v136, 16, v136
    v_add_f32 v138, v138, v139
    v_cvt_pk_bf16_f32 v138, v138, v138
    v_lshlrev_b32 v138, 16, v138
    v_add_f32 v138, 1.0, v138
    v_cvt_pk_bf16_f32 v138, v138, v138
    v_lshlrev_b32 v138, 16, v138
    v_mul_f32 v136, s31, v136
    v_mul_f32 v138, s31, v138
    v_add_u32 v12, 0, v10
    v_lshrrev_b32 v13, 5, v12
    v_lshlrev_b32 v13, 2, v13
    v_bfe_u32 v14, v12, 2, 2
    v_add_u32 v13, v13, v14
    v_bfe_u32 v14, v12, 4, 1
    v_lshlrev_b32 v14, 2, v14
    v_and_b32 v15, 3, v12
    v_add_u32 v14, v14, v15
    v_lshlrev_b32 v15, 6, v13
    v_lshl_add_u32 v15, v14, 2, v15
    v_add_u32 v15, 141312, v15
    ds_write_b32 v15, v138
    ds_write_b32 v15, v136 offset:32
    v_add_f32 v140, v140, v141
    v_cvt_pk_bf16_f32 v140, v140, v140
    v_lshlrev_b32 v140, 16, v140
    v_add_f32 v142, v142, v143
    v_cvt_pk_bf16_f32 v142, v142, v142
    v_lshlrev_b32 v142, 16, v142
    v_add_f32 v142, 1.0, v142
    v_cvt_pk_bf16_f32 v142, v142, v142
    v_lshlrev_b32 v142, 16, v142
    v_mul_f32 v140, s31, v140
    v_mul_f32 v142, s31, v142
    v_add_u32 v12, 256, v10
    v_lshrrev_b32 v13, 5, v12
    v_lshlrev_b32 v13, 2, v13
    v_bfe_u32 v14, v12, 2, 2
    v_add_u32 v13, v13, v14
    v_bfe_u32 v14, v12, 4, 1
    v_lshlrev_b32 v14, 2, v14
    v_and_b32 v15, 3, v12
    v_add_u32 v14, v14, v15
    v_lshlrev_b32 v15, 6, v13
    v_lshl_add_u32 v15, v14, 2, v15
    v_add_u32 v15, 141312, v15
    ds_write_b32 v15, v142
    ds_write_b32 v15, v140 offset:32
    v_add_f32 v144, v144, v145
    v_cvt_pk_bf16_f32 v144, v144, v144
    v_lshlrev_b32 v144, 16, v144
    v_add_f32 v146, v146, v147
    v_cvt_pk_bf16_f32 v146, v146, v146
    v_lshlrev_b32 v146, 16, v146
    v_add_f32 v146, 1.0, v146
    v_cvt_pk_bf16_f32 v146, v146, v146
    v_lshlrev_b32 v146, 16, v146
    v_mul_f32 v144, s31, v144
    v_mul_f32 v146, s31, v146
    v_add_u32 v12, 512, v10
    v_lshrrev_b32 v13, 5, v12
    v_lshlrev_b32 v13, 2, v13
    v_bfe_u32 v14, v12, 2, 2
    v_add_u32 v13, v13, v14
    v_bfe_u32 v14, v12, 4, 1
    v_lshlrev_b32 v14, 2, v14
    v_and_b32 v15, 3, v12
    v_add_u32 v14, v14, v15
    v_lshlrev_b32 v15, 6, v13
    v_lshl_add_u32 v15, v14, 2, v15
    v_add_u32 v15, 141312, v15
    v_cmp_gt_u32 vcc, 64, v10
    s_nop 0
    s_and_saveexec_b64 s[36:37], vcc
    ds_write_b32 v15, v146
    ds_write_b32 v15, v144 offset:32
    s_mov_b64 exec, s[36:37]
    s_waitcnt lgkmcnt(0)
    s_barrier
    ds_read_b128 v[80:83], v8 offset:0
    ds_read_b128 v[84:87], v8 offset:16
    ds_read_b128 v[88:91], v8 offset:32
    ds_read_b128 v[92:95], v8 offset:48
    ds_read_b128 v[96:99], v8 offset:512
    ds_read_b128 v[100:103], v8 offset:528
    ds_read_b128 v[104:107], v8 offset:544
    ds_read_b128 v[108:111], v8 offset:560
    s_waitcnt vmcnt(8) lgkmcnt(4)
    v_lshlrev_b32 v112, 16, v16
    v_and_b32 v113, 0xffff0000, v16
    v_lshlrev_b32 v114, 16, v17
    v_and_b32 v115, 0xffff0000, v17
    v_lshlrev_b32 v116, 16, v18
    v_and_b32 v117, 0xffff0000, v18
    v_lshlrev_b32 v118, 16, v19
    v_and_b32 v119, 0xffff0000, v19
    v_fma_f32 v112, v112, v80, v88
    v_fma_f32 v113, v113, v81, v89
    v_fma_f32 v114, v114, v82, v90
    v_fma_f32 v115, v115, v83, v91
    v_fma_f32 v116, v116, v84, v92
    v_fma_f32 v117, v117, v85, v93
    v_fma_f32 v118, v118, v86, v94
    v_fma_f32 v119, v119, v87, v95
    v_cvt_pk_bf16_f32 v120, v112, v113
    v_cvt_pk_bf16_f32 v121, v114, v115
    v_cvt_pk_bf16_f32 v122, v116, v117
    v_cvt_pk_bf16_f32 v123, v118, v119
    ds_write_b128 v9, v[120:123] offset:0
    s_mov_b32 s25, 6144
    buffer_load_dwordx4 v[64:67], v4, s[12:15], s25 offen
    v_lshlrev_b32 v112, 16, v20
    v_and_b32 v113, 0xffff0000, v20
    v_lshlrev_b32 v114, 16, v21
    v_and_b32 v115, 0xffff0000, v21
    v_lshlrev_b32 v116, 16, v22
    v_and_b32 v117, 0xffff0000, v22
    v_lshlrev_b32 v118, 16, v23
    v_and_b32 v119, 0xffff0000, v23
    v_fma_f32 v112, v112, v80, v88
    v_fma_f32 v113, v113, v81, v89
    v_fma_f32 v114, v114, v82, v90
    v_fma_f32 v115, v115, v83, v91
    v_fma_f32 v116, v116, v84, v92
    v_fma_f32 v117, v117, v85, v93
    v_fma_f32 v118, v118, v86, v94
    v_fma_f32 v119, v119, v87, v95
    v_cvt_pk_bf16_f32 v124, v112, v113
    v_cvt_pk_bf16_f32 v125, v114, v115
    v_cvt_pk_bf16_f32 v126, v116, v117
    v_cvt_pk_bf16_f32 v127, v118, v119
    ds_write_b128 v9, v[124:127] offset:1024
    s_mov_b32 s25, 24576
    buffer_load_dwordx4 v[68:71], v4, s[12:15], s25 offen
    v_lshlrev_b32 v112, 16, v24
    v_and_b32 v113, 0xffff0000, v24
    v_lshlrev_b32 v114, 16, v25
    v_and_b32 v115, 0xffff0000, v25
    v_lshlrev_b32 v116, 16, v26
    v_and_b32 v117, 0xffff0000, v26
    v_lshlrev_b32 v118, 16, v27
    v_and_b32 v119, 0xffff0000, v27
    v_fma_f32 v112, v112, v80, v88
    v_fma_f32 v113, v113, v81, v89
    v_fma_f32 v114, v114, v82, v90
    v_fma_f32 v115, v115, v83, v91
    v_fma_f32 v116, v116, v84, v92
    v_fma_f32 v117, v117, v85, v93
    v_fma_f32 v118, v118, v86, v94
    v_fma_f32 v119, v119, v87, v95
    v_cvt_pk_bf16_f32 v120, v112, v113
    v_cvt_pk_bf16_f32 v121, v114, v115
    v_cvt_pk_bf16_f32 v122, v116, v117
    v_cvt_pk_bf16_f32 v123, v118, v119
    ds_write_b128 v9, v[120:123] offset:2048
    s_mov_b32 s25, 43008
    buffer_load_dwordx4 v[72:75], v4, s[12:15], s25 offen
    v_lshlrev_b32 v112, 16, v28
    v_and_b32 v113, 0xffff0000, v28
    v_lshlrev_b32 v114, 16, v29
    v_and_b32 v115, 0xffff0000, v29
    v_lshlrev_b32 v116, 16, v30
    v_and_b32 v117, 0xffff0000, v30
    v_lshlrev_b32 v118, 16, v31
    v_and_b32 v119, 0xffff0000, v31
    v_fma_f32 v112, v112, v80, v88
    v_fma_f32 v113, v113, v81, v89
    v_fma_f32 v114, v114, v82, v90
    v_fma_f32 v115, v115, v83, v91
    v_fma_f32 v116, v116, v84, v92
    v_fma_f32 v117, v117, v85, v93
    v_fma_f32 v118, v118, v86, v94
    v_fma_f32 v119, v119, v87, v95
    v_cvt_pk_bf16_f32 v124, v112, v113
    v_cvt_pk_bf16_f32 v125, v114, v115
    v_cvt_pk_bf16_f32 v126, v116, v117
    v_cvt_pk_bf16_f32 v127, v118, v119
    ds_write_b128 v9, v[124:127] offset:3072
    s_mov_b32 s25, 61440
    buffer_load_dwordx4 v[76:79], v4, s[12:15], s25 offen
    ds_read_b128 v[80:83], v8 offset:1024
    ds_read_b128 v[84:87], v8 offset:1040
    ds_read_b128 v[88:91], v8 offset:1056
    ds_read_b128 v[92:95], v8 offset:1072
    s_waitcnt lgkmcnt(4)
    s_barrier
    s_waitcnt vmcnt(8) lgkmcnt(8)
    v_lshlrev_b32 v112, 16, v32
    v_and_b32 v113, 0xffff0000, v32
    v_lshlrev_b32 v114, 16, v33
    v_and_b32 v115, 0xffff0000, v33
    v_lshlrev_b32 v116, 16, v34
    v_and_b32 v117, 0xffff0000, v34
    v_lshlrev_b32 v118, 16, v35
    v_and_b32 v119, 0xffff0000, v35
    v_fma_f32 v112, v112, v96, v104
    v_fma_f32 v113, v113, v97, v105
    v_fma_f32 v114, v114, v98, v106
    v_fma_f32 v115, v115, v99, v107
    v_fma_f32 v116, v116, v100, v108
    v_fma_f32 v117, v117, v101, v109
    v_fma_f32 v118, v118, v102, v110
    v_fma_f32 v119, v119, v103, v111
    v_cvt_pk_bf16_f32 v120, v112, v113
    v_cvt_pk_bf16_f32 v121, v114, v115
    v_cvt_pk_bf16_f32 v122, v116, v117
    v_cvt_pk_bf16_f32 v123, v118, v119
    ds_write_b128 v9, v[120:123] offset:16384
    s_mov_b32 s25, 8192
    buffer_load_dwordx4 v[16:19], v4, s[12:15], s25 offen
    v_lshlrev_b32 v112, 16, v36
    v_and_b32 v113, 0xffff0000, v36
    v_lshlrev_b32 v114, 16, v37
    v_and_b32 v115, 0xffff0000, v37
    v_lshlrev_b32 v116, 16, v38
    v_and_b32 v117, 0xffff0000, v38
    v_lshlrev_b32 v118, 16, v39
    v_and_b32 v119, 0xffff0000, v39
    v_fma_f32 v112, v112, v96, v104
    v_fma_f32 v113, v113, v97, v105
    v_fma_f32 v114, v114, v98, v106
    v_fma_f32 v115, v115, v99, v107
    v_fma_f32 v116, v116, v100, v108
    v_fma_f32 v117, v117, v101, v109
    v_fma_f32 v118, v118, v102, v110
    v_fma_f32 v119, v119, v103, v111
    v_cvt_pk_bf16_f32 v124, v112, v113
    v_cvt_pk_bf16_f32 v125, v114, v115
    v_cvt_pk_bf16_f32 v126, v116, v117
    v_cvt_pk_bf16_f32 v127, v118, v119
    ds_write_b128 v9, v[124:127] offset:17408
    s_mov_b32 s25, 26624
    buffer_load_dwordx4 v[20:23], v4, s[12:15], s25 offen
    v_lshlrev_b32 v112, 16, v40
    v_and_b32 v113, 0xffff0000, v40
    v_lshlrev_b32 v114, 16, v41
    v_and_b32 v115, 0xffff0000, v41
    v_lshlrev_b32 v116, 16, v42
    v_and_b32 v117, 0xffff0000, v42
    v_lshlrev_b32 v118, 16, v43
    v_and_b32 v119, 0xffff0000, v43
    v_fma_f32 v112, v112, v96, v104
    v_fma_f32 v113, v113, v97, v105
    v_fma_f32 v114, v114, v98, v106
    v_fma_f32 v115, v115, v99, v107
    v_fma_f32 v116, v116, v100, v108
    v_fma_f32 v117, v117, v101, v109
    v_fma_f32 v118, v118, v102, v110
    v_fma_f32 v119, v119, v103, v111
    v_cvt_pk_bf16_f32 v120, v112, v113
    v_cvt_pk_bf16_f32 v121, v114, v115
    v_cvt_pk_bf16_f32 v122, v116, v117
    v_cvt_pk_bf16_f32 v123, v118, v119
    ds_write_b128 v9, v[120:123] offset:18432
    s_mov_b32 s25, 45056
    buffer_load_dwordx4 v[24:27], v4, s[12:15], s25 offen
    v_lshlrev_b32 v112, 16, v44
    v_and_b32 v113, 0xffff0000, v44
    v_lshlrev_b32 v114, 16, v45
    v_and_b32 v115, 0xffff0000, v45
    v_lshlrev_b32 v116, 16, v46
    v_and_b32 v117, 0xffff0000, v46
    v_lshlrev_b32 v118, 16, v47
    v_and_b32 v119, 0xffff0000, v47
    v_fma_f32 v112, v112, v96, v104
    v_fma_f32 v113, v113, v97, v105
    v_fma_f32 v114, v114, v98, v106
    v_fma_f32 v115, v115, v99, v107
    v_fma_f32 v116, v116, v100, v108
    v_fma_f32 v117, v117, v101, v109
    v_fma_f32 v118, v118, v102, v110
    v_fma_f32 v119, v119, v103, v111
    v_cvt_pk_bf16_f32 v124, v112, v113
    v_cvt_pk_bf16_f32 v125, v114, v115
    v_cvt_pk_bf16_f32 v126, v116, v117
    v_cvt_pk_bf16_f32 v127, v118, v119
    ds_write_b128 v9, v[124:127] offset:19456
    s_mov_b32 s25, 63488
    buffer_load_dwordx4 v[28:31], v4, s[12:15], s25 offen
    ds_read_b128 v[96:99], v8 offset:1536
    ds_read_b128 v[100:103], v8 offset:1552
    ds_read_b128 v[104:107], v8 offset:1568
    ds_read_b128 v[108:111], v8 offset:1584
    s_waitcnt lgkmcnt(4)
    s_barrier
    s_waitcnt vmcnt(8) lgkmcnt(8)
    v_lshlrev_b32 v112, 16, v48
    v_and_b32 v113, 0xffff0000, v48
    v_lshlrev_b32 v114, 16, v49
    v_and_b32 v115, 0xffff0000, v49
    v_lshlrev_b32 v116, 16, v50
    v_and_b32 v117, 0xffff0000, v50
    v_lshlrev_b32 v118, 16, v51
    v_and_b32 v119, 0xffff0000, v51
    v_fma_f32 v112, v112, v80, v88
    v_fma_f32 v113, v113, v81, v89
    v_fma_f32 v114, v114, v82, v90
    v_fma_f32 v115, v115, v83, v91
    v_fma_f32 v116, v116, v84, v92
    v_fma_f32 v117, v117, v85, v93
    v_fma_f32 v118, v118, v86, v94
    v_fma_f32 v119, v119, v87, v95
    v_cvt_pk_bf16_f32 v120, v112, v113
    v_cvt_pk_bf16_f32 v121, v114, v115
    v_cvt_pk_bf16_f32 v122, v116, v117
    v_cvt_pk_bf16_f32 v123, v118, v119
    ds_write_b128 v9, v[120:123] offset:32768
    s_mov_b32 s25, 10240
    buffer_load_dwordx4 v[32:35], v4, s[12:15], s25 offen
    v_lshlrev_b32 v112, 16, v52
    v_and_b32 v113, 0xffff0000, v52
    v_lshlrev_b32 v114, 16, v53
    v_and_b32 v115, 0xffff0000, v53
    v_lshlrev_b32 v116, 16, v54
    v_and_b32 v117, 0xffff0000, v54
    v_lshlrev_b32 v118, 16, v55
    v_and_b32 v119, 0xffff0000, v55
    v_fma_f32 v112, v112, v80, v88
    v_fma_f32 v113, v113, v81, v89
    v_fma_f32 v114, v114, v82, v90
    v_fma_f32 v115, v115, v83, v91
    v_fma_f32 v116, v116, v84, v92
    v_fma_f32 v117, v117, v85, v93
    v_fma_f32 v118, v118, v86, v94
    v_fma_f32 v119, v119, v87, v95
    v_cvt_pk_bf16_f32 v124, v112, v113
    v_cvt_pk_bf16_f32 v125, v114, v115
    v_cvt_pk_bf16_f32 v126, v116, v117
    v_cvt_pk_bf16_f32 v127, v118, v119
    ds_write_b128 v9, v[124:127] offset:33792
    s_mov_b32 s25, 28672
    buffer_load_dwordx4 v[36:39], v4, s[12:15], s25 offen
    v_lshlrev_b32 v112, 16, v56
    v_and_b32 v113, 0xffff0000, v56
    v_lshlrev_b32 v114, 16, v57
    v_and_b32 v115, 0xffff0000, v57
    v_lshlrev_b32 v116, 16, v58
    v_and_b32 v117, 0xffff0000, v58
    v_lshlrev_b32 v118, 16, v59
    v_and_b32 v119, 0xffff0000, v59
    v_fma_f32 v112, v112, v80, v88
    v_fma_f32 v113, v113, v81, v89
    v_fma_f32 v114, v114, v82, v90
    v_fma_f32 v115, v115, v83, v91
    v_fma_f32 v116, v116, v84, v92
    v_fma_f32 v117, v117, v85, v93
    v_fma_f32 v118, v118, v86, v94
    v_fma_f32 v119, v119, v87, v95
    v_cvt_pk_bf16_f32 v120, v112, v113
    v_cvt_pk_bf16_f32 v121, v114, v115
    v_cvt_pk_bf16_f32 v122, v116, v117
    v_cvt_pk_bf16_f32 v123, v118, v119
    ds_write_b128 v9, v[120:123] offset:34816
    s_mov_b32 s25, 47104
    buffer_load_dwordx4 v[40:43], v4, s[12:15], s25 offen
    v_lshlrev_b32 v112, 16, v60
    v_and_b32 v113, 0xffff0000, v60
    v_lshlrev_b32 v114, 16, v61
    v_and_b32 v115, 0xffff0000, v61
    v_lshlrev_b32 v116, 16, v62
    v_and_b32 v117, 0xffff0000, v62
    v_lshlrev_b32 v118, 16, v63
    v_and_b32 v119, 0xffff0000, v63
    v_fma_f32 v112, v112, v80, v88
    v_fma_f32 v113, v113, v81, v89
    v_fma_f32 v114, v114, v82, v90
    v_fma_f32 v115, v115, v83, v91
    v_fma_f32 v116, v116, v84, v92
    v_fma_f32 v117, v117, v85, v93
    v_fma_f32 v118, v118, v86, v94
    v_fma_f32 v119, v119, v87, v95
    v_cvt_pk_bf16_f32 v124, v112, v113
    v_cvt_pk_bf16_f32 v125, v114, v115
    v_cvt_pk_bf16_f32 v126, v116, v117
    v_cvt_pk_bf16_f32 v127, v118, v119
    ds_write_b128 v9, v[124:127] offset:35840
    s_mov_b32 s25, 65536
    buffer_load_dwordx4 v[44:47], v4, s[12:15], s25 offen
    ds_read_b128 v[80:83], v8 offset:2048
    ds_read_b128 v[84:87], v8 offset:2064
    ds_read_b128 v[88:91], v8 offset:2080
    ds_read_b128 v[92:95], v8 offset:2096
    s_waitcnt lgkmcnt(4)
    s_barrier
    s_waitcnt vmcnt(8) lgkmcnt(8)
    v_lshlrev_b32 v112, 16, v64
    v_and_b32 v113, 0xffff0000, v64
    v_lshlrev_b32 v114, 16, v65
    v_and_b32 v115, 0xffff0000, v65
    v_lshlrev_b32 v116, 16, v66
    v_and_b32 v117, 0xffff0000, v66
    v_lshlrev_b32 v118, 16, v67
    v_and_b32 v119, 0xffff0000, v67
    v_fma_f32 v112, v112, v96, v104
    v_fma_f32 v113, v113, v97, v105
    v_fma_f32 v114, v114, v98, v106
    v_fma_f32 v115, v115, v99, v107
    v_fma_f32 v116, v116, v100, v108
    v_fma_f32 v117, v117, v101, v109
    v_fma_f32 v118, v118, v102, v110
    v_fma_f32 v119, v119, v103, v111
    v_cvt_pk_bf16_f32 v120, v112, v113
    v_cvt_pk_bf16_f32 v121, v114, v115
    v_cvt_pk_bf16_f32 v122, v116, v117
    v_cvt_pk_bf16_f32 v123, v118, v119
    ds_write_b128 v9, v[120:123] offset:0
    s_mov_b32 s25, 12288
    buffer_load_dwordx4 v[48:51], v4, s[12:15], s25 offen
    v_lshlrev_b32 v112, 16, v68
    v_and_b32 v113, 0xffff0000, v68
    v_lshlrev_b32 v114, 16, v69
    v_and_b32 v115, 0xffff0000, v69
    v_lshlrev_b32 v116, 16, v70
    v_and_b32 v117, 0xffff0000, v70
    v_lshlrev_b32 v118, 16, v71
    v_and_b32 v119, 0xffff0000, v71
    v_fma_f32 v112, v112, v96, v104
    v_fma_f32 v113, v113, v97, v105
    v_fma_f32 v114, v114, v98, v106
    v_fma_f32 v115, v115, v99, v107
    v_fma_f32 v116, v116, v100, v108
    v_fma_f32 v117, v117, v101, v109
    v_fma_f32 v118, v118, v102, v110
    v_fma_f32 v119, v119, v103, v111
    v_cvt_pk_bf16_f32 v124, v112, v113
    v_cvt_pk_bf16_f32 v125, v114, v115
    v_cvt_pk_bf16_f32 v126, v116, v117
    v_cvt_pk_bf16_f32 v127, v118, v119
    ds_write_b128 v9, v[124:127] offset:1024
    s_mov_b32 s25, 30720
    buffer_load_dwordx4 v[52:55], v4, s[12:15], s25 offen
    v_lshlrev_b32 v112, 16, v72
    v_and_b32 v113, 0xffff0000, v72
    v_lshlrev_b32 v114, 16, v73
    v_and_b32 v115, 0xffff0000, v73
    v_lshlrev_b32 v116, 16, v74
    v_and_b32 v117, 0xffff0000, v74
    v_lshlrev_b32 v118, 16, v75
    v_and_b32 v119, 0xffff0000, v75
    v_fma_f32 v112, v112, v96, v104
    v_fma_f32 v113, v113, v97, v105
    v_fma_f32 v114, v114, v98, v106
    v_fma_f32 v115, v115, v99, v107
    v_fma_f32 v116, v116, v100, v108
    v_fma_f32 v117, v117, v101, v109
    v_fma_f32 v118, v118, v102, v110
    v_fma_f32 v119, v119, v103, v111
    v_cvt_pk_bf16_f32 v120, v112, v113
    v_cvt_pk_bf16_f32 v121, v114, v115
    v_cvt_pk_bf16_f32 v122, v116, v117
    v_cvt_pk_bf16_f32 v123, v118, v119
    ds_write_b128 v9, v[120:123] offset:2048
    s_mov_b32 s25, 49152
    buffer_load_dwordx4 v[56:59], v4, s[12:15], s25 offen
    v_lshlrev_b32 v112, 16, v76
    v_and_b32 v113, 0xffff0000, v76
    v_lshlrev_b32 v114, 16, v77
    v_and_b32 v115, 0xffff0000, v77
    v_lshlrev_b32 v116, 16, v78
    v_and_b32 v117, 0xffff0000, v78
    v_lshlrev_b32 v118, 16, v79
    v_and_b32 v119, 0xffff0000, v79
    v_fma_f32 v112, v112, v96, v104
    v_fma_f32 v113, v113, v97, v105
    v_fma_f32 v114, v114, v98, v106
    v_fma_f32 v115, v115, v99, v107
    v_fma_f32 v116, v116, v100, v108
    v_fma_f32 v117, v117, v101, v109
    v_fma_f32 v118, v118, v102, v110
    v_fma_f32 v119, v119, v103, v111
    v_cvt_pk_bf16_f32 v124, v112, v113
    v_cvt_pk_bf16_f32 v125, v114, v115
    v_cvt_pk_bf16_f32 v126, v116, v117
    v_cvt_pk_bf16_f32 v127, v118, v119
    ds_write_b128 v9, v[124:127] offset:3072
    s_mov_b32 s25, 67584
    buffer_load_dwordx4 v[60:63], v4, s[12:15], s25 offen
    ds_read_b128 v[96:99], v8 offset:2560
    ds_read_b128 v[100:103], v8 offset:2576
    ds_read_b128 v[104:107], v8 offset:2592
    ds_read_b128 v[108:111], v8 offset:2608
    s_waitcnt lgkmcnt(4)
    s_barrier
    s_waitcnt vmcnt(8) lgkmcnt(8)
    v_lshlrev_b32 v112, 16, v16
    v_and_b32 v113, 0xffff0000, v16
    v_lshlrev_b32 v114, 16, v17
    v_and_b32 v115, 0xffff0000, v17
    v_lshlrev_b32 v116, 16, v18
    v_and_b32 v117, 0xffff0000, v18
    v_lshlrev_b32 v118, 16, v19
    v_and_b32 v119, 0xffff0000, v19
    v_fma_f32 v112, v112, v80, v88
    v_fma_f32 v113, v113, v81, v89
    v_fma_f32 v114, v114, v82, v90
    v_fma_f32 v115, v115, v83, v91
    v_fma_f32 v116, v116, v84, v92
    v_fma_f32 v117, v117, v85, v93
    v_fma_f32 v118, v118, v86, v94
    v_fma_f32 v119, v119, v87, v95
    v_cvt_pk_bf16_f32 v120, v112, v113
    v_cvt_pk_bf16_f32 v121, v114, v115
    v_cvt_pk_bf16_f32 v122, v116, v117
    v_cvt_pk_bf16_f32 v123, v118, v119
    ds_write_b128 v9, v[120:123] offset:16384
    s_mov_b32 s25, 14336
    buffer_load_dwordx4 v[64:67], v4, s[12:15], s25 offen
    v_lshlrev_b32 v112, 16, v20
    v_and_b32 v113, 0xffff0000, v20
    v_lshlrev_b32 v114, 16, v21
    v_and_b32 v115, 0xffff0000, v21
    v_lshlrev_b32 v116, 16, v22
    v_and_b32 v117, 0xffff0000, v22
    v_lshlrev_b32 v118, 16, v23
    v_and_b32 v119, 0xffff0000, v23
    v_fma_f32 v112, v112, v80, v88
    v_fma_f32 v113, v113, v81, v89
    v_fma_f32 v114, v114, v82, v90
    v_fma_f32 v115, v115, v83, v91
    v_fma_f32 v116, v116, v84, v92
    v_fma_f32 v117, v117, v85, v93
    v_fma_f32 v118, v118, v86, v94
    v_fma_f32 v119, v119, v87, v95
    v_cvt_pk_bf16_f32 v124, v112, v113
    v_cvt_pk_bf16_f32 v125, v114, v115
    v_cvt_pk_bf16_f32 v126, v116, v117
    v_cvt_pk_bf16_f32 v127, v118, v119
    ds_write_b128 v9, v[124:127] offset:17408
    s_mov_b32 s25, 32768
    buffer_load_dwordx4 v[68:71], v4, s[12:15], s25 offen
    v_lshlrev_b32 v112, 16, v24
    v_and_b32 v113, 0xffff0000, v24
    v_lshlrev_b32 v114, 16, v25
    v_and_b32 v115, 0xffff0000, v25
    v_lshlrev_b32 v116, 16, v26
    v_and_b32 v117, 0xffff0000, v26
    v_lshlrev_b32 v118, 16, v27
    v_and_b32 v119, 0xffff0000, v27
    v_fma_f32 v112, v112, v80, v88
    v_fma_f32 v113, v113, v81, v89
    v_fma_f32 v114, v114, v82, v90
    v_fma_f32 v115, v115, v83, v91
    v_fma_f32 v116, v116, v84, v92
    v_fma_f32 v117, v117, v85, v93
    v_fma_f32 v118, v118, v86, v94
    v_fma_f32 v119, v119, v87, v95
    v_cvt_pk_bf16_f32 v120, v112, v113
    v_cvt_pk_bf16_f32 v121, v114, v115
    v_cvt_pk_bf16_f32 v122, v116, v117
    v_cvt_pk_bf16_f32 v123, v118, v119
    ds_write_b128 v9, v[120:123] offset:18432
    s_mov_b32 s25, 51200
    buffer_load_dwordx4 v[72:75], v4, s[12:15], s25 offen
    v_lshlrev_b32 v112, 16, v28
    v_and_b32 v113, 0xffff0000, v28
    v_lshlrev_b32 v114, 16, v29
    v_and_b32 v115, 0xffff0000, v29
    v_lshlrev_b32 v116, 16, v30
    v_and_b32 v117, 0xffff0000, v30
    v_lshlrev_b32 v118, 16, v31
    v_and_b32 v119, 0xffff0000, v31
    v_fma_f32 v112, v112, v80, v88
    v_fma_f32 v113, v113, v81, v89
    v_fma_f32 v114, v114, v82, v90
    v_fma_f32 v115, v115, v83, v91
    v_fma_f32 v116, v116, v84, v92
    v_fma_f32 v117, v117, v85, v93
    v_fma_f32 v118, v118, v86, v94
    v_fma_f32 v119, v119, v87, v95
    v_cvt_pk_bf16_f32 v124, v112, v113
    v_cvt_pk_bf16_f32 v125, v114, v115
    v_cvt_pk_bf16_f32 v126, v116, v117
    v_cvt_pk_bf16_f32 v127, v118, v119
    ds_write_b128 v9, v[124:127] offset:19456
    s_mov_b32 s25, 69632
    buffer_load_dwordx4 v[76:79], v4, s[12:15], s25 offen
    ds_read_b128 v[80:83], v8 offset:3072
    ds_read_b128 v[84:87], v8 offset:3088
    ds_read_b128 v[88:91], v8 offset:3104
    ds_read_b128 v[92:95], v8 offset:3120
    s_waitcnt lgkmcnt(4)
    s_barrier
    s_waitcnt vmcnt(8) lgkmcnt(8)
    v_lshlrev_b32 v112, 16, v32
    v_and_b32 v113, 0xffff0000, v32
    v_lshlrev_b32 v114, 16, v33
    v_and_b32 v115, 0xffff0000, v33
    v_lshlrev_b32 v116, 16, v34
    v_and_b32 v117, 0xffff0000, v34
    v_lshlrev_b32 v118, 16, v35
    v_and_b32 v119, 0xffff0000, v35
    v_fma_f32 v112, v112, v96, v104
    v_fma_f32 v113, v113, v97, v105
    v_fma_f32 v114, v114, v98, v106
    v_fma_f32 v115, v115, v99, v107
    v_fma_f32 v116, v116, v100, v108
    v_fma_f32 v117, v117, v101, v109
    v_fma_f32 v118, v118, v102, v110
    v_fma_f32 v119, v119, v103, v111
    v_cvt_pk_bf16_f32 v120, v112, v113
    v_cvt_pk_bf16_f32 v121, v114, v115
    v_cvt_pk_bf16_f32 v122, v116, v117
    v_cvt_pk_bf16_f32 v123, v118, v119
    ds_write_b128 v9, v[120:123] offset:32768
    s_mov_b32 s25, 16384
    buffer_load_dwordx4 v[16:19], v4, s[12:15], s25 offen
    v_lshlrev_b32 v112, 16, v36
    v_and_b32 v113, 0xffff0000, v36
    v_lshlrev_b32 v114, 16, v37
    v_and_b32 v115, 0xffff0000, v37
    v_lshlrev_b32 v116, 16, v38
    v_and_b32 v117, 0xffff0000, v38
    v_lshlrev_b32 v118, 16, v39
    v_and_b32 v119, 0xffff0000, v39
    v_fma_f32 v112, v112, v96, v104
    v_fma_f32 v113, v113, v97, v105
    v_fma_f32 v114, v114, v98, v106
    v_fma_f32 v115, v115, v99, v107
    v_fma_f32 v116, v116, v100, v108
    v_fma_f32 v117, v117, v101, v109
    v_fma_f32 v118, v118, v102, v110
    v_fma_f32 v119, v119, v103, v111
    v_cvt_pk_bf16_f32 v124, v112, v113
    v_cvt_pk_bf16_f32 v125, v114, v115
    v_cvt_pk_bf16_f32 v126, v116, v117
    v_cvt_pk_bf16_f32 v127, v118, v119
    ds_write_b128 v9, v[124:127] offset:33792
    s_mov_b32 s25, 34816
    buffer_load_dwordx4 v[20:23], v4, s[12:15], s25 offen
    v_lshlrev_b32 v112, 16, v40
    v_and_b32 v113, 0xffff0000, v40
    v_lshlrev_b32 v114, 16, v41
    v_and_b32 v115, 0xffff0000, v41
    v_lshlrev_b32 v116, 16, v42
    v_and_b32 v117, 0xffff0000, v42
    v_lshlrev_b32 v118, 16, v43
    v_and_b32 v119, 0xffff0000, v43
    v_fma_f32 v112, v112, v96, v104
    v_fma_f32 v113, v113, v97, v105
    v_fma_f32 v114, v114, v98, v106
    v_fma_f32 v115, v115, v99, v107
    v_fma_f32 v116, v116, v100, v108
    v_fma_f32 v117, v117, v101, v109
    v_fma_f32 v118, v118, v102, v110
    v_fma_f32 v119, v119, v103, v111
    v_cvt_pk_bf16_f32 v120, v112, v113
    v_cvt_pk_bf16_f32 v121, v114, v115
    v_cvt_pk_bf16_f32 v122, v116, v117
    v_cvt_pk_bf16_f32 v123, v118, v119
    ds_write_b128 v9, v[120:123] offset:34816
    s_mov_b32 s25, 53248
    buffer_load_dwordx4 v[24:27], v4, s[12:15], s25 offen
    v_lshlrev_b32 v112, 16, v44
    v_and_b32 v113, 0xffff0000, v44
    v_lshlrev_b32 v114, 16, v45
    v_and_b32 v115, 0xffff0000, v45
    v_lshlrev_b32 v116, 16, v46
    v_and_b32 v117, 0xffff0000, v46
    v_lshlrev_b32 v118, 16, v47
    v_and_b32 v119, 0xffff0000, v47
    v_fma_f32 v112, v112, v96, v104
    v_fma_f32 v113, v113, v97, v105
    v_fma_f32 v114, v114, v98, v106
    v_fma_f32 v115, v115, v99, v107
    v_fma_f32 v116, v116, v100, v108
    v_fma_f32 v117, v117, v101, v109
    v_fma_f32 v118, v118, v102, v110
    v_fma_f32 v119, v119, v103, v111
    v_cvt_pk_bf16_f32 v124, v112, v113
    v_cvt_pk_bf16_f32 v125, v114, v115
    v_cvt_pk_bf16_f32 v126, v116, v117
    v_cvt_pk_bf16_f32 v127, v118, v119
    ds_write_b128 v9, v[124:127] offset:35840
    s_mov_b32 s25, 71680
    buffer_load_dwordx4 v[28:31], v4, s[12:15], s25 offen
    ds_read_b128 v[96:99], v8 offset:3584
    ds_read_b128 v[100:103], v8 offset:3600
    ds_read_b128 v[104:107], v8 offset:3616
    ds_read_b128 v[108:111], v8 offset:3632
    s_waitcnt lgkmcnt(4)
    s_barrier
    s_waitcnt vmcnt(8) lgkmcnt(8)
    v_lshlrev_b32 v112, 16, v48
    v_and_b32 v113, 0xffff0000, v48
    v_lshlrev_b32 v114, 16, v49
    v_and_b32 v115, 0xffff0000, v49
    v_lshlrev_b32 v116, 16, v50
    v_and_b32 v117, 0xffff0000, v50
    v_lshlrev_b32 v118, 16, v51
    v_and_b32 v119, 0xffff0000, v51
    v_fma_f32 v112, v112, v80, v88
    v_fma_f32 v113, v113, v81, v89
    v_fma_f32 v114, v114, v82, v90
    v_fma_f32 v115, v115, v83, v91
    v_fma_f32 v116, v116, v84, v92
    v_fma_f32 v117, v117, v85, v93
    v_fma_f32 v118, v118, v86, v94
    v_fma_f32 v119, v119, v87, v95
    v_cvt_pk_bf16_f32 v120, v112, v113
    v_cvt_pk_bf16_f32 v121, v114, v115
    v_cvt_pk_bf16_f32 v122, v116, v117
    v_cvt_pk_bf16_f32 v123, v118, v119
    ds_write_b128 v9, v[120:123] offset:0
    v_lshlrev_b32 v112, 16, v52
    v_and_b32 v113, 0xffff0000, v52
    v_lshlrev_b32 v114, 16, v53
    v_and_b32 v115, 0xffff0000, v53
    v_lshlrev_b32 v116, 16, v54
    v_and_b32 v117, 0xffff0000, v54
    v_lshlrev_b32 v118, 16, v55
    v_and_b32 v119, 0xffff0000, v55
    v_fma_f32 v112, v112, v80, v88
    v_fma_f32 v113, v113, v81, v89
    v_fma_f32 v114, v114, v82, v90
    v_fma_f32 v115, v115, v83, v91
    v_fma_f32 v116, v116, v84, v92
    v_fma_f32 v117, v117, v85, v93
    v_fma_f32 v118, v118, v86, v94
    v_fma_f32 v119, v119, v87, v95
    v_cvt_pk_bf16_f32 v124, v112, v113
    v_cvt_pk_bf16_f32 v125, v114, v115
    v_cvt_pk_bf16_f32 v126, v116, v117
    v_cvt_pk_bf16_f32 v127, v118, v119
    ds_write_b128 v9, v[124:127] offset:1024
    v_lshlrev_b32 v112, 16, v56
    v_and_b32 v113, 0xffff0000, v56
    v_lshlrev_b32 v114, 16, v57
    v_and_b32 v115, 0xffff0000, v57
    v_lshlrev_b32 v116, 16, v58
    v_and_b32 v117, 0xffff0000, v58
    v_lshlrev_b32 v118, 16, v59
    v_and_b32 v119, 0xffff0000, v59
    v_fma_f32 v112, v112, v80, v88
    v_fma_f32 v113, v113, v81, v89
    v_fma_f32 v114, v114, v82, v90
    v_fma_f32 v115, v115, v83, v91
    v_fma_f32 v116, v116, v84, v92
    v_fma_f32 v117, v117, v85, v93
    v_fma_f32 v118, v118, v86, v94
    v_fma_f32 v119, v119, v87, v95
    v_cvt_pk_bf16_f32 v120, v112, v113
    v_cvt_pk_bf16_f32 v121, v114, v115
    v_cvt_pk_bf16_f32 v122, v116, v117
    v_cvt_pk_bf16_f32 v123, v118, v119
    ds_write_b128 v9, v[120:123] offset:2048
    v_lshlrev_b32 v112, 16, v60
    v_and_b32 v113, 0xffff0000, v60
    v_lshlrev_b32 v114, 16, v61
    v_and_b32 v115, 0xffff0000, v61
    v_lshlrev_b32 v116, 16, v62
    v_and_b32 v117, 0xffff0000, v62
    v_lshlrev_b32 v118, 16, v63
    v_and_b32 v119, 0xffff0000, v63
    v_fma_f32 v112, v112, v80, v88
    v_fma_f32 v113, v113, v81, v89
    v_fma_f32 v114, v114, v82, v90
    v_fma_f32 v115, v115, v83, v91
    v_fma_f32 v116, v116, v84, v92
    v_fma_f32 v117, v117, v85, v93
    v_fma_f32 v118, v118, v86, v94
    v_fma_f32 v119, v119, v87, v95
    v_cvt_pk_bf16_f32 v124, v112, v113
    v_cvt_pk_bf16_f32 v125, v114, v115
    v_cvt_pk_bf16_f32 v126, v116, v117
    v_cvt_pk_bf16_f32 v127, v118, v119
    ds_write_b128 v9, v[124:127] offset:3072
    ds_read_b128 v[80:83], v8 offset:4096
    ds_read_b128 v[84:87], v8 offset:4112
    ds_read_b128 v[88:91], v8 offset:4128
    ds_read_b128 v[92:95], v8 offset:4144
    s_waitcnt lgkmcnt(4)
    s_barrier
    s_waitcnt vmcnt(4) lgkmcnt(8)
    v_lshlrev_b32 v112, 16, v64
    v_and_b32 v113, 0xffff0000, v64
    v_lshlrev_b32 v114, 16, v65
    v_and_b32 v115, 0xffff0000, v65
    v_lshlrev_b32 v116, 16, v66
    v_and_b32 v117, 0xffff0000, v66
    v_lshlrev_b32 v118, 16, v67
    v_and_b32 v119, 0xffff0000, v67
    v_fma_f32 v112, v112, v96, v104
    v_fma_f32 v113, v113, v97, v105
    v_fma_f32 v114, v114, v98, v106
    v_fma_f32 v115, v115, v99, v107
    v_fma_f32 v116, v116, v100, v108
    v_fma_f32 v117, v117, v101, v109
    v_fma_f32 v118, v118, v102, v110
    v_fma_f32 v119, v119, v103, v111
    v_cvt_pk_bf16_f32 v120, v112, v113
    v_cvt_pk_bf16_f32 v121, v114, v115
    v_cvt_pk_bf16_f32 v122, v116, v117
    v_cvt_pk_bf16_f32 v123, v118, v119
    ds_write_b128 v9, v[120:123] offset:16384
    v_lshlrev_b32 v112, 16, v68
    v_and_b32 v113, 0xffff0000, v68
    v_lshlrev_b32 v114, 16, v69
    v_and_b32 v115, 0xffff0000, v69
    v_lshlrev_b32 v116, 16, v70
    v_and_b32 v117, 0xffff0000, v70
    v_lshlrev_b32 v118, 16, v71
    v_and_b32 v119, 0xffff0000, v71
    v_fma_f32 v112, v112, v96, v104
    v_fma_f32 v113, v113, v97, v105
    v_fma_f32 v114, v114, v98, v106
    v_fma_f32 v115, v115, v99, v107
    v_fma_f32 v116, v116, v100, v108
    v_fma_f32 v117, v117, v101, v109
    v_fma_f32 v118, v118, v102, v110
    v_fma_f32 v119, v119, v103, v111
    v_cvt_pk_bf16_f32 v124, v112, v113
    v_cvt_pk_bf16_f32 v125, v114, v115
    v_cvt_pk_bf16_f32 v126, v116, v117
    v_cvt_pk_bf16_f32 v127, v118, v119
    ds_write_b128 v9, v[124:127] offset:17408
    v_lshlrev_b32 v112, 16, v72
    v_and_b32 v113, 0xffff0000, v72
    v_lshlrev_b32 v114, 16, v73
    v_and_b32 v115, 0xffff0000, v73
    v_lshlrev_b32 v116, 16, v74
    v_and_b32 v117, 0xffff0000, v74
    v_lshlrev_b32 v118, 16, v75
    v_and_b32 v119, 0xffff0000, v75
    v_fma_f32 v112, v112, v96, v104
    v_fma_f32 v113, v113, v97, v105
    v_fma_f32 v114, v114, v98, v106
    v_fma_f32 v115, v115, v99, v107
    v_fma_f32 v116, v116, v100, v108
    v_fma_f32 v117, v117, v101, v109
    v_fma_f32 v118, v118, v102, v110
    v_fma_f32 v119, v119, v103, v111
    v_cvt_pk_bf16_f32 v120, v112, v113
    v_cvt_pk_bf16_f32 v121, v114, v115
    v_cvt_pk_bf16_f32 v122, v116, v117
    v_cvt_pk_bf16_f32 v123, v118, v119
    ds_write_b128 v9, v[120:123] offset:18432
    v_lshlrev_b32 v112, 16, v76
    v_and_b32 v113, 0xffff0000, v76
    v_lshlrev_b32 v114, 16, v77
    v_and_b32 v115, 0xffff0000, v77
    v_lshlrev_b32 v116, 16, v78
    v_and_b32 v117, 0xffff0000, v78
    v_lshlrev_b32 v118, 16, v79
    v_and_b32 v119, 0xffff0000, v79
    v_fma_f32 v112, v112, v96, v104
    v_fma_f32 v113, v113, v97, v105
    v_fma_f32 v114, v114, v98, v106
    v_fma_f32 v115, v115, v99, v107
    v_fma_f32 v116, v116, v100, v108
    v_fma_f32 v117, v117, v101, v109
    v_fma_f32 v118, v118, v102, v110
    v_fma_f32 v119, v119, v103, v111
    v_cvt_pk_bf16_f32 v124, v112, v113
    v_cvt_pk_bf16_f32 v125, v114, v115
    v_cvt_pk_bf16_f32 v126, v116, v117
    v_cvt_pk_bf16_f32 v127, v118, v119
    ds_write_b128 v9, v[124:127] offset:19456
    s_waitcnt lgkmcnt(0)
    s_barrier
    s_waitcnt vmcnt(0) lgkmcnt(4)
    v_lshlrev_b32 v112, 16, v16
    v_and_b32 v113, 0xffff0000, v16
    v_lshlrev_b32 v114, 16, v17
    v_and_b32 v115, 0xffff0000, v17
    v_lshlrev_b32 v116, 16, v18
    v_and_b32 v117, 0xffff0000, v18
    v_lshlrev_b32 v118, 16, v19
    v_and_b32 v119, 0xffff0000, v19
    v_fma_f32 v112, v112, v80, v88
    v_fma_f32 v113, v113, v81, v89
    v_fma_f32 v114, v114, v82, v90
    v_fma_f32 v115, v115, v83, v91
    v_fma_f32 v116, v116, v84, v92
    v_fma_f32 v117, v117, v85, v93
    v_fma_f32 v118, v118, v86, v94
    v_fma_f32 v119, v119, v87, v95
    v_cvt_pk_bf16_f32 v120, v112, v113
    v_cvt_pk_bf16_f32 v121, v114, v115
    v_cvt_pk_bf16_f32 v122, v116, v117
    v_cvt_pk_bf16_f32 v123, v118, v119
    ds_write_b128 v9, v[120:123] offset:32768
    v_lshlrev_b32 v112, 16, v20
    v_and_b32 v113, 0xffff0000, v20
    v_lshlrev_b32 v114, 16, v21
    v_and_b32 v115, 0xffff0000, v21
    v_lshlrev_b32 v116, 16, v22
    v_and_b32 v117, 0xffff0000, v22
    v_lshlrev_b32 v118, 16, v23
    v_and_b32 v119, 0xffff0000, v23
    v_fma_f32 v112, v112, v80, v88
    v_fma_f32 v113, v113, v81, v89
    v_fma_f32 v114, v114, v82, v90
    v_fma_f32 v115, v115, v83, v91
    v_fma_f32 v116, v116, v84, v92
    v_fma_f32 v117, v117, v85, v93
    v_fma_f32 v118, v118, v86, v94
    v_fma_f32 v119, v119, v87, v95
    v_cvt_pk_bf16_f32 v124, v112, v113
    v_cvt_pk_bf16_f32 v125, v114, v115
    v_cvt_pk_bf16_f32 v126, v116, v117
    v_cvt_pk_bf16_f32 v127, v118, v119
    ds_write_b128 v9, v[124:127] offset:33792
    v_lshlrev_b32 v112, 16, v24
    v_and_b32 v113, 0xffff0000, v24
    v_lshlrev_b32 v114, 16, v25
    v_and_b32 v115, 0xffff0000, v25
    v_lshlrev_b32 v116, 16, v26
    v_and_b32 v117, 0xffff0000, v26
    v_lshlrev_b32 v118, 16, v27
    v_and_b32 v119, 0xffff0000, v27
    v_fma_f32 v112, v112, v80, v88
    v_fma_f32 v113, v113, v81, v89
    v_fma_f32 v114, v114, v82, v90
    v_fma_f32 v115, v115, v83, v91
    v_fma_f32 v116, v116, v84, v92
    v_fma_f32 v117, v117, v85, v93
    v_fma_f32 v118, v118, v86, v94
    v_fma_f32 v119, v119, v87, v95
    v_cvt_pk_bf16_f32 v120, v112, v113
    v_cvt_pk_bf16_f32 v121, v114, v115
    v_cvt_pk_bf16_f32 v122, v116, v117
    v_cvt_pk_bf16_f32 v123, v118, v119
    ds_write_b128 v9, v[120:123] offset:34816
    v_lshlrev_b32 v112, 16, v28
    v_and_b32 v113, 0xffff0000, v28
    v_lshlrev_b32 v114, 16, v29
    v_and_b32 v115, 0xffff0000, v29
    v_lshlrev_b32 v116, 16, v30
    v_and_b32 v117, 0xffff0000, v30
    v_lshlrev_b32 v118, 16, v31
    v_and_b32 v119, 0xffff0000, v31
    v_fma_f32 v112, v112, v80, v88
    v_fma_f32 v113, v113, v81, v89
    v_fma_f32 v114, v114, v82, v90
    v_fma_f32 v115, v115, v83, v91
    v_fma_f32 v116, v116, v84, v92
    v_fma_f32 v117, v117, v85, v93
    v_fma_f32 v118, v118, v86, v94
    v_fma_f32 v119, v119, v87, v95
    v_cvt_pk_bf16_f32 v124, v112, v113
    v_cvt_pk_bf16_f32 v125, v114, v115
    v_cvt_pk_bf16_f32 v126, v116, v117
    v_cvt_pk_bf16_f32 v127, v118, v119
    ds_write_b128 v9, v[124:127] offset:35840
    s_waitcnt lgkmcnt(0)
    s_barrier
    s_barrier
    s_endpgm
K1_CONS:
    s_waitcnt lgkmcnt(0)
    s_barrier
    s_cmp_ge_u32 s22, 8
    s_cbranch_scc1 K1_V
    s_barrier
    ds_read_b128 v[136:139], v9 offset:0
    ds_read_b128 v[140:143], v10 offset:0
    ds_read_b128 v[88:91], v6 offset:0
    ds_read_b128 v[92:95], v6 offset:1024
    ds_read_b128 v[96:99], v6 offset:2048
    ds_read_b128 v[100:103], v6 offset:3072
    ds_read_b128 v[104:107], v6 offset:4096
    ds_read_b128 v[108:111], v6 offset:5120
    ds_read_b128 v[112:115], v6 offset:6144
    ds_read_b128 v[116:119], v6 offset:7168
    ds_read_b128 v[120:123], v6 offset:8192
    ds_read_b128 v[144:147], v9 offset:8192
    ds_read_b128 v[148:151], v10 offset:8192
    s_waitcnt lgkmcnt(8)
    v_mfma_f32_16x16x32_bf16 v[16:19], v[88:91], v[136:139], 0
    v_mfma_f32_16x16x32_bf16 v[20:23], v[88:91], v[140:143], 0
    ds_read_b128 v[124:127], v6 offset:9216
    v_mfma_f32_16x16x32_bf16 v[24:27], v[92:95], v[136:139], 0
    v_mfma_f32_16x16x32_bf16 v[28:31], v[92:95], v[140:143], 0
    ds_read_b128 v[128:131], v6 offset:10240
    v_mfma_f32_16x16x32_bf16 v[32:35], v[96:99], v[136:139], 0
    v_mfma_f32_16x16x32_bf16 v[36:39], v[96:99], v[140:143], 0
    ds_read_b128 v[132:135], v6 offset:11264
    s_waitcnt lgkmcnt(8)
    v_mfma_f32_16x16x32_bf16 v[40:43], v[100:103], v[136:139], 0
    v_mfma_f32_16x16x32_bf16 v[44:47], v[100:103], v[140:143], 0
    ds_read_b128 v[88:91], v6 offset:12288
    v_mfma_f32_16x16x32_bf16 v[48:51], v[104:107], v[136:139], 0
    v_mfma_f32_16x16x32_bf16 v[52:55], v[104:107], v[140:143], 0
    ds_read_b128 v[92:95], v6 offset:13312
    v_mfma_f32_16x16x32_bf16 v[56:59], v[108:111], v[136:139], 0
    v_mfma_f32_16x16x32_bf16 v[60:63], v[108:111], v[140:143], 0
    ds_read_b128 v[96:99], v6 offset:14336
    s_waitcnt lgkmcnt(8)
    v_mfma_f32_16x16x32_bf16 v[64:67], v[112:115], v[136:139], 0
    v_mfma_f32_16x16x32_bf16 v[68:71], v[112:115], v[140:143], 0
    ds_read_b128 v[100:103], v6 offset:15360
    v_mfma_f32_16x16x32_bf16 v[72:75], v[116:119], v[136:139], 0
    v_mfma_f32_16x16x32_bf16 v[76:79], v[116:119], v[140:143], 0
    ds_read_b128 v[104:107], v6 offset:16384
    v_mfma_f32_16x16x32_bf16 v[80:83], v[120:123], v[136:139], 0
    v_mfma_f32_16x16x32_bf16 v[84:87], v[120:123], v[140:143], 0
    ds_read_b128 v[108:111], v6 offset:17408
    s_barrier
    ds_read_b128 v[136:139], v9 offset:16384
    ds_read_b128 v[140:143], v10 offset:16384
    s_waitcnt lgkmcnt(8)
    v_mfma_f32_16x16x32_bf16 v[16:19], v[124:127], v[144:147], v[16:19]
    v_mfma_f32_16x16x32_bf16 v[20:23], v[124:127], v[148:151], v[20:23]
    ds_read_b128 v[112:115], v6 offset:18432
    v_mfma_f32_16x16x32_bf16 v[24:27], v[128:131], v[144:147], v[24:27]
    v_mfma_f32_16x16x32_bf16 v[28:31], v[128:131], v[148:151], v[28:31]
    ds_read_b128 v[116:119], v6 offset:19456
    v_mfma_f32_16x16x32_bf16 v[32:35], v[132:135], v[144:147], v[32:35]
    v_mfma_f32_16x16x32_bf16 v[36:39], v[132:135], v[148:151], v[36:39]
    ds_read_b128 v[120:123], v6 offset:20480
    s_waitcnt lgkmcnt(8)
    v_mfma_f32_16x16x32_bf16 v[40:43], v[88:91], v[144:147], v[40:43]
    v_mfma_f32_16x16x32_bf16 v[44:47], v[88:91], v[148:151], v[44:47]
    ds_read_b128 v[124:127], v6 offset:21504
    v_mfma_f32_16x16x32_bf16 v[48:51], v[92:95], v[144:147], v[48:51]
    v_mfma_f32_16x16x32_bf16 v[52:55], v[92:95], v[148:151], v[52:55]
    ds_read_b128 v[128:131], v6 offset:22528
    v_mfma_f32_16x16x32_bf16 v[56:59], v[96:99], v[144:147], v[56:59]
    v_mfma_f32_16x16x32_bf16 v[60:63], v[96:99], v[148:151], v[60:63]
    ds_read_b128 v[132:135], v6 offset:23552
    s_waitcnt lgkmcnt(8)
    v_mfma_f32_16x16x32_bf16 v[64:67], v[100:103], v[144:147], v[64:67]
    v_mfma_f32_16x16x32_bf16 v[68:71], v[100:103], v[148:151], v[68:71]
    ds_read_b128 v[88:91], v6 offset:24576
    v_mfma_f32_16x16x32_bf16 v[72:75], v[104:107], v[144:147], v[72:75]
    v_mfma_f32_16x16x32_bf16 v[76:79], v[104:107], v[148:151], v[76:79]
    ds_read_b128 v[92:95], v6 offset:25600
    v_mfma_f32_16x16x32_bf16 v[80:83], v[108:111], v[144:147], v[80:83]
    v_mfma_f32_16x16x32_bf16 v[84:87], v[108:111], v[148:151], v[84:87]
    ds_read_b128 v[96:99], v6 offset:26624
    ds_read_b128 v[144:147], v9 offset:24576
    ds_read_b128 v[148:151], v10 offset:24576
    s_waitcnt lgkmcnt(8)
    v_mfma_f32_16x16x32_bf16 v[16:19], v[112:115], v[136:139], v[16:19]
    v_mfma_f32_16x16x32_bf16 v[20:23], v[112:115], v[140:143], v[20:23]
    ds_read_b128 v[100:103], v6 offset:27648
    v_mfma_f32_16x16x32_bf16 v[24:27], v[116:119], v[136:139], v[24:27]
    v_mfma_f32_16x16x32_bf16 v[28:31], v[116:119], v[140:143], v[28:31]
    ds_read_b128 v[104:107], v6 offset:28672
    v_mfma_f32_16x16x32_bf16 v[32:35], v[120:123], v[136:139], v[32:35]
    v_mfma_f32_16x16x32_bf16 v[36:39], v[120:123], v[140:143], v[36:39]
    ds_read_b128 v[108:111], v6 offset:29696
    s_waitcnt lgkmcnt(8)
    v_mfma_f32_16x16x32_bf16 v[40:43], v[124:127], v[136:139], v[40:43]
    v_mfma_f32_16x16x32_bf16 v[44:47], v[124:127], v[140:143], v[44:47]
    ds_read_b128 v[112:115], v6 offset:30720
    v_mfma_f32_16x16x32_bf16 v[48:51], v[128:131], v[136:139], v[48:51]
    v_mfma_f32_16x16x32_bf16 v[52:55], v[128:131], v[140:143], v[52:55]
    ds_read_b128 v[116:119], v6 offset:31744
    v_mfma_f32_16x16x32_bf16 v[56:59], v[132:135], v[136:139], v[56:59]
    v_mfma_f32_16x16x32_bf16 v[60:63], v[132:135], v[140:143], v[60:63]
    ds_read_b128 v[120:123], v6 offset:32768
    s_waitcnt lgkmcnt(8)
    v_mfma_f32_16x16x32_bf16 v[64:67], v[88:91], v[136:139], v[64:67]
    v_mfma_f32_16x16x32_bf16 v[68:71], v[88:91], v[140:143], v[68:71]
    ds_read_b128 v[124:127], v6 offset:33792
    v_mfma_f32_16x16x32_bf16 v[72:75], v[92:95], v[136:139], v[72:75]
    v_mfma_f32_16x16x32_bf16 v[76:79], v[92:95], v[140:143], v[76:79]
    ds_read_b128 v[128:131], v6 offset:34816
    v_mfma_f32_16x16x32_bf16 v[80:83], v[96:99], v[136:139], v[80:83]
    v_mfma_f32_16x16x32_bf16 v[84:87], v[96:99], v[140:143], v[84:87]
    ds_read_b128 v[132:135], v6 offset:35840
    s_barrier
    ds_read_b128 v[136:139], v9 offset:32768
    ds_read_b128 v[140:143], v10 offset:32768
    s_waitcnt lgkmcnt(8)
    v_mfma_f32_16x16x32_bf16 v[16:19], v[100:103], v[144:147], v[16:19]
    v_mfma_f32_16x16x32_bf16 v[20:23], v[100:103], v[148:151], v[20:23]
    ds_read_b128 v[88:91], v6 offset:36864
    v_mfma_f32_16x16x32_bf16 v[24:27], v[104:107], v[144:147], v[24:27]
    v_mfma_f32_16x16x32_bf16 v[28:31], v[104:107], v[148:151], v[28:31]
    ds_read_b128 v[92:95], v6 offset:37888
    v_mfma_f32_16x16x32_bf16 v[32:35], v[108:111], v[144:147], v[32:35]
    v_mfma_f32_16x16x32_bf16 v[36:39], v[108:111], v[148:151], v[36:39]
    ds_read_b128 v[96:99], v6 offset:38912
    s_waitcnt lgkmcnt(8)
    v_mfma_f32_16x16x32_bf16 v[40:43], v[112:115], v[144:147], v[40:43]
    v_mfma_f32_16x16x32_bf16 v[44:47], v[112:115], v[148:151], v[44:47]
    ds_read_b128 v[100:103], v6 offset:39936
    v_mfma_f32_16x16x32_bf16 v[48:51], v[116:119], v[144:147], v[48:51]
    v_mfma_f32_16x16x32_bf16 v[52:55], v[116:119], v[148:151], v[52:55]
    ds_read_b128 v[104:107], v6 offset:40960
    v_mfma_f32_16x16x32_bf16 v[56:59], v[120:123], v[144:147], v[56:59]
    v_mfma_f32_16x16x32_bf16 v[60:63], v[120:123], v[148:151], v[60:63]
    ds_read_b128 v[108:111], v6 offset:41984
    s_waitcnt lgkmcnt(8)
    v_mfma_f32_16x16x32_bf16 v[64:67], v[124:127], v[144:147], v[64:67]
    v_mfma_f32_16x16x32_bf16 v[68:71], v[124:127], v[148:151], v[68:71]
    ds_read_b128 v[112:115], v6 offset:43008
    v_mfma_f32_16x16x32_bf16 v[72:75], v[128:131], v[144:147], v[72:75]
    v_mfma_f32_16x16x32_bf16 v[76:79], v[128:131], v[148:151], v[76:79]
    ds_read_b128 v[116:119], v6 offset:44032
    v_mfma_f32_16x16x32_bf16 v[80:83], v[132:135], v[144:147], v[80:83]
    v_mfma_f32_16x16x32_bf16 v[84:87], v[132:135], v[148:151], v[84:87]
    ds_read_b128 v[120:123], v6 offset:45056
    ds_read_b128 v[144:147], v9 offset:40960
    ds_read_b128 v[148:151], v10 offset:40960
    s_waitcnt lgkmcnt(8)
    v_mfma_f32_16x16x32_bf16 v[16:19], v[88:91], v[136:139], v[16:19]
    v_mfma_f32_16x16x32_bf16 v[20:23], v[88:91], v[140:143], v[20:23]
    ds_read_b128 v[124:127], v6 offset:46080
    v_mfma_f32_16x16x32_bf16 v[24:27], v[92:95], v[136:139], v[24:27]
    v_mfma_f32_16x16x32_bf16 v[28:31], v[92:95], v[140:143], v[28:31]
    ds_read_b128 v[128:131], v6 offset:47104
    v_mfma_f32_16x16x32_bf16 v[32:35], v[96:99], v[136:139], v[32:35]
    v_mfma_f32_16x16x32_bf16 v[36:39], v[96:99], v[140:143], v[36:39]
    ds_read_b128 v[132:135], v6 offset:48128
    s_waitcnt lgkmcnt(8)
    v_mfma_f32_16x16x32_bf16 v[40:43], v[100:103], v[136:139], v[40:43]
    v_mfma_f32_16x16x32_bf16 v[44:47], v[100:103], v[140:143], v[44:47]
    ds_read_b128 v[88:91], v6 offset:49152
    v_mfma_f32_16x16x32_bf16 v[48:51], v[104:107], v[136:139], v[48:51]
    v_mfma_f32_16x16x32_bf16 v[52:55], v[104:107], v[140:143], v[52:55]
    ds_read_b128 v[92:95], v6 offset:50176
    v_mfma_f32_16x16x32_bf16 v[56:59], v[108:111], v[136:139], v[56:59]
    v_mfma_f32_16x16x32_bf16 v[60:63], v[108:111], v[140:143], v[60:63]
    ds_read_b128 v[96:99], v6 offset:51200
    s_waitcnt lgkmcnt(8)
    v_mfma_f32_16x16x32_bf16 v[64:67], v[112:115], v[136:139], v[64:67]
    v_mfma_f32_16x16x32_bf16 v[68:71], v[112:115], v[140:143], v[68:71]
    ds_read_b128 v[100:103], v6 offset:52224
    v_mfma_f32_16x16x32_bf16 v[72:75], v[116:119], v[136:139], v[72:75]
    v_mfma_f32_16x16x32_bf16 v[76:79], v[116:119], v[140:143], v[76:79]
    ds_read_b128 v[104:107], v6 offset:53248
    v_mfma_f32_16x16x32_bf16 v[80:83], v[120:123], v[136:139], v[80:83]
    v_mfma_f32_16x16x32_bf16 v[84:87], v[120:123], v[140:143], v[84:87]
    ds_read_b128 v[108:111], v6 offset:54272
    s_barrier
    ds_read_b128 v[136:139], v9 offset:0
    ds_read_b128 v[140:143], v10 offset:0
    s_waitcnt lgkmcnt(8)
    v_mfma_f32_16x16x32_bf16 v[16:19], v[124:127], v[144:147], v[16:19]
    v_mfma_f32_16x16x32_bf16 v[20:23], v[124:127], v[148:151], v[20:23]
    ds_read_b128 v[112:115], v7 offset:0
    v_mfma_f32_16x16x32_bf16 v[24:27], v[128:131], v[144:147], v[24:27]
    v_mfma_f32_16x16x32_bf16 v[28:31], v[128:131], v[148:151], v[28:31]
    ds_read_b128 v[116:119], v7 offset:1024
    v_mfma_f32_16x16x32_bf16 v[32:35], v[132:135], v[144:147], v[32:35]
    v_mfma_f32_16x16x32_bf16 v[36:39], v[132:135], v[148:151], v[36:39]
    ds_read_b128 v[120:123], v7 offset:2048
    s_waitcnt lgkmcnt(8)
    v_mfma_f32_16x16x32_bf16 v[40:43], v[88:91], v[144:147], v[40:43]
    v_mfma_f32_16x16x32_bf16 v[44:47], v[88:91], v[148:151], v[44:47]
    ds_read_b128 v[124:127], v7 offset:3072
    v_mfma_f32_16x16x32_bf16 v[48:51], v[92:95], v[144:147], v[48:51]
    v_mfma_f32_16x16x32_bf16 v[52:55], v[92:95], v[148:151], v[52:55]
    ds_read_b128 v[128:131], v7 offset:4096
    v_mfma_f32_16x16x32_bf16 v[56:59], v[96:99], v[144:147], v[56:59]
    v_mfma_f32_16x16x32_bf16 v[60:63], v[96:99], v[148:151], v[60:63]
    ds_read_b128 v[132:135], v7 offset:5120
    s_waitcnt lgkmcnt(8)
    v_mfma_f32_16x16x32_bf16 v[64:67], v[100:103], v[144:147], v[64:67]
    v_mfma_f32_16x16x32_bf16 v[68:71], v[100:103], v[148:151], v[68:71]
    ds_read_b128 v[88:91], v7 offset:6144
    v_mfma_f32_16x16x32_bf16 v[72:75], v[104:107], v[144:147], v[72:75]
    v_mfma_f32_16x16x32_bf16 v[76:79], v[104:107], v[148:151], v[76:79]
    ds_read_b128 v[92:95], v7 offset:7168
    v_mfma_f32_16x16x32_bf16 v[80:83], v[108:111], v[144:147], v[80:83]
    v_mfma_f32_16x16x32_bf16 v[84:87], v[108:111], v[148:151], v[84:87]
    ds_read_b128 v[96:99], v7 offset:8192
    ds_read_b128 v[144:147], v9 offset:8192
    ds_read_b128 v[148:151], v10 offset:8192
    s_waitcnt lgkmcnt(8)
    v_mfma_f32_16x16x32_bf16 v[16:19], v[112:115], v[136:139], v[16:19]
    v_mfma_f32_16x16x32_bf16 v[20:23], v[112:115], v[140:143], v[20:23]
    ds_read_b128 v[100:103], v7 offset:9216
    v_mfma_f32_16x16x32_bf16 v[24:27], v[116:119], v[136:139], v[24:27]
    v_mfma_f32_16x16x32_bf16 v[28:31], v[116:119], v[140:143], v[28:31]
    ds_read_b128 v[104:107], v7 offset:10240
    v_mfma_f32_16x16x32_bf16 v[32:35], v[120:123], v[136:139], v[32:35]
    v_mfma_f32_16x16x32_bf16 v[36:39], v[120:123], v[140:143], v[36:39]
    ds_read_b128 v[108:111], v7 offset:11264
    s_waitcnt lgkmcnt(8)
    v_mfma_f32_16x16x32_bf16 v[40:43], v[124:127], v[136:139], v[40:43]
    v_mfma_f32_16x16x32_bf16 v[44:47], v[124:127], v[140:143], v[44:47]
    ds_read_b128 v[112:115], v7 offset:12288
    v_mfma_f32_16x16x32_bf16 v[48:51], v[128:131], v[136:139], v[48:51]
    v_mfma_f32_16x16x32_bf16 v[52:55], v[128:131], v[140:143], v[52:55]
    ds_read_b128 v[116:119], v7 offset:13312
    v_mfma_f32_16x16x32_bf16 v[56:59], v[132:135], v[136:139], v[56:59]
    v_mfma_f32_16x16x32_bf16 v[60:63], v[132:135], v[140:143], v[60:63]
    ds_read_b128 v[120:123], v7 offset:14336
    s_waitcnt lgkmcnt(8)
    v_mfma_f32_16x16x32_bf16 v[64:67], v[88:91], v[136:139], v[64:67]
    v_mfma_f32_16x16x32_bf16 v[68:71], v[88:91], v[140:143], v[68:71]
    ds_read_b128 v[124:127], v7 offset:15360
    v_mfma_f32_16x16x32_bf16 v[72:75], v[92:95], v[136:139], v[72:75]
    v_mfma_f32_16x16x32_bf16 v[76:79], v[92:95], v[140:143], v[76:79]
    ds_read_b128 v[128:131], v7 offset:16384
    v_mfma_f32_16x16x32_bf16 v[80:83], v[96:99], v[136:139], v[80:83]
    v_mfma_f32_16x16x32_bf16 v[84:87], v[96:99], v[140:143], v[84:87]
    ds_read_b128 v[132:135], v7 offset:17408
    s_barrier
    ds_read_b128 v[136:139], v9 offset:16384
    ds_read_b128 v[140:143], v10 offset:16384
    s_waitcnt lgkmcnt(8)
    v_mfma_f32_16x16x32_bf16 v[16:19], v[100:103], v[144:147], v[16:19]
    v_mfma_f32_16x16x32_bf16 v[20:23], v[100:103], v[148:151], v[20:23]
    ds_read_b128 v[88:91], v7 offset:18432
    v_mfma_f32_16x16x32_bf16 v[24:27], v[104:107], v[144:147], v[24:27]
    v_mfma_f32_16x16x32_bf16 v[28:31], v[104:107], v[148:151], v[28:31]
    ds_read_b128 v[92:95], v7 offset:19456
    v_mfma_f32_16x16x32_bf16 v[32:35], v[108:111], v[144:147], v[32:35]
    v_mfma_f32_16x16x32_bf16 v[36:39], v[108:111], v[148:151], v[36:39]
    ds_read_b128 v[96:99], v7 offset:20480
    s_waitcnt lgkmcnt(8)
    v_mfma_f32_16x16x32_bf16 v[40:43], v[112:115], v[144:147], v[40:43]
    v_mfma_f32_16x16x32_bf16 v[44:47], v[112:115], v[148:151], v[44:47]
    ds_read_b128 v[100:103], v7 offset:21504
    v_mfma_f32_16x16x32_bf16 v[48:51], v[116:119], v[144:147], v[48:51]
    v_mfma_f32_16x16x32_bf16 v[52:55], v[116:119], v[148:151], v[52:55]
    ds_read_b128 v[104:107], v7 offset:22528
    v_mfma_f32_16x16x32_bf16 v[56:59], v[120:123], v[144:147], v[56:59]
    v_mfma_f32_16x16x32_bf16 v[60:63], v[120:123], v[148:151], v[60:63]
    ds_read_b128 v[108:111], v7 offset:23552
    s_waitcnt lgkmcnt(8)
    v_mfma_f32_16x16x32_bf16 v[64:67], v[124:127], v[144:147], v[64:67]
    v_mfma_f32_16x16x32_bf16 v[68:71], v[124:127], v[148:151], v[68:71]
    ds_read_b128 v[112:115], v7 offset:24576
    v_mfma_f32_16x16x32_bf16 v[72:75], v[128:131], v[144:147], v[72:75]
    v_mfma_f32_16x16x32_bf16 v[76:79], v[128:131], v[148:151], v[76:79]
    ds_read_b128 v[116:119], v7 offset:25600
    v_mfma_f32_16x16x32_bf16 v[80:83], v[132:135], v[144:147], v[80:83]
    v_mfma_f32_16x16x32_bf16 v[84:87], v[132:135], v[148:151], v[84:87]
    ds_read_b128 v[120:123], v7 offset:26624
    ds_read_b128 v[144:147], v9 offset:24576
    ds_read_b128 v[148:151], v10 offset:24576
    s_waitcnt lgkmcnt(8)
    v_mfma_f32_16x16x32_bf16 v[16:19], v[88:91], v[136:139], v[16:19]
    v_mfma_f32_16x16x32_bf16 v[20:23], v[88:91], v[140:143], v[20:23]
    ds_read_b128 v[124:127], v7 offset:27648
    v_mfma_f32_16x16x32_bf16 v[24:27], v[92:95], v[136:139], v[24:27]
    v_mfma_f32_16x16x32_bf16 v[28:31], v[92:95], v[140:143], v[28:31]
    ds_read_b128 v[128:131], v7 offset:28672
    v_mfma_f32_16x16x32_bf16 v[32:35], v[96:99], v[136:139], v[32:35]
    v_mfma_f32_16x16x32_bf16 v[36:39], v[96:99], v[140:143], v[36:39]
    ds_read_b128 v[132:135], v7 offset:29696
    s_waitcnt lgkmcnt(8)
    v_mfma_f32_16x16x32_bf16 v[40:43], v[100:103], v[136:139], v[40:43]
    v_mfma_f32_16x16x32_bf16 v[44:47], v[100:103], v[140:143], v[44:47]
    ds_read_b128 v[88:91], v7 offset:30720
    v_mfma_f32_16x16x32_bf16 v[48:51], v[104:107], v[136:139], v[48:51]
    v_mfma_f32_16x16x32_bf16 v[52:55], v[104:107], v[140:143], v[52:55]
    ds_read_b128 v[92:95], v7 offset:31744
    v_mfma_f32_16x16x32_bf16 v[56:59], v[108:111], v[136:139], v[56:59]
    v_mfma_f32_16x16x32_bf16 v[60:63], v[108:111], v[140:143], v[60:63]
    ds_read_b128 v[96:99], v7 offset:32768
    s_waitcnt lgkmcnt(8)
    v_mfma_f32_16x16x32_bf16 v[64:67], v[112:115], v[136:139], v[64:67]
    v_mfma_f32_16x16x32_bf16 v[68:71], v[112:115], v[140:143], v[68:71]
    ds_read_b128 v[100:103], v7 offset:33792
    v_mfma_f32_16x16x32_bf16 v[72:75], v[116:119], v[136:139], v[72:75]
    v_mfma_f32_16x16x32_bf16 v[76:79], v[116:119], v[140:143], v[76:79]
    ds_read_b128 v[104:107], v7 offset:34816
    v_mfma_f32_16x16x32_bf16 v[80:83], v[120:123], v[136:139], v[80:83]
    v_mfma_f32_16x16x32_bf16 v[84:87], v[120:123], v[140:143], v[84:87]
    ds_read_b128 v[108:111], v7 offset:35840
    s_barrier
    ds_read_b128 v[136:139], v9 offset:32768
    ds_read_b128 v[140:143], v10 offset:32768
    s_waitcnt lgkmcnt(8)
    v_mfma_f32_16x16x32_bf16 v[16:19], v[124:127], v[144:147], v[16:19]
    v_mfma_f32_16x16x32_bf16 v[20:23], v[124:127], v[148:151], v[20:23]
    ds_read_b128 v[112:115], v6 offset:0
    v_mfma_f32_16x16x32_bf16 v[24:27], v[128:131], v[144:147], v[24:27]
    v_mfma_f32_16x16x32_bf16 v[28:31], v[128:131], v[148:151], v[28:31]
    ds_read_b128 v[116:119], v6 offset:1024
    v_mfma_f32_16x16x32_bf16 v[32:35], v[132:135], v[144:147], v[32:35]
    v_mfma_f32_16x16x32_bf16 v[36:39], v[132:135], v[148:151], v[36:39]
    ds_read_b128 v[120:123], v6 offset:2048
    s_waitcnt lgkmcnt(8)
    v_mfma_f32_16x16x32_bf16 v[40:43], v[88:91], v[144:147], v[40:43]
    v_mfma_f32_16x16x32_bf16 v[44:47], v[88:91], v[148:151], v[44:47]
    ds_read_b128 v[124:127], v6 offset:3072
    v_mfma_f32_16x16x32_bf16 v[48:51], v[92:95], v[144:147], v[48:51]
    v_mfma_f32_16x16x32_bf16 v[52:55], v[92:95], v[148:151], v[52:55]
    ds_read_b128 v[128:131], v6 offset:4096
    v_mfma_f32_16x16x32_bf16 v[56:59], v[96:99], v[144:147], v[56:59]
    v_mfma_f32_16x16x32_bf16 v[60:63], v[96:99], v[148:151], v[60:63]
    ds_read_b128 v[132:135], v6 offset:5120
    s_waitcnt lgkmcnt(8)
    v_mfma_f32_16x16x32_bf16 v[64:67], v[100:103], v[144:147], v[64:67]
    v_mfma_f32_16x16x32_bf16 v[68:71], v[100:103], v[148:151], v[68:71]
    ds_read_b128 v[88:91], v6 offset:6144
    v_mfma_f32_16x16x32_bf16 v[72:75], v[104:107], v[144:147], v[72:75]
    v_mfma_f32_16x16x32_bf16 v[76:79], v[104:107], v[148:151], v[76:79]
    ds_read_b128 v[92:95], v6 offset:7168
    v_mfma_f32_16x16x32_bf16 v[80:83], v[108:111], v[144:147], v[80:83]
    v_mfma_f32_16x16x32_bf16 v[84:87], v[108:111], v[148:151], v[84:87]
    ds_read_b128 v[96:99], v6 offset:8192
    ds_read_b128 v[144:147], v9 offset:40960
    ds_read_b128 v[148:151], v10 offset:40960
    s_waitcnt lgkmcnt(8)
    v_mfma_f32_16x16x32_bf16 v[16:19], v[112:115], v[136:139], v[16:19]
    v_mfma_f32_16x16x32_bf16 v[20:23], v[112:115], v[140:143], v[20:23]
    ds_read_b128 v[100:103], v6 offset:9216
    v_mfma_f32_16x16x32_bf16 v[24:27], v[116:119], v[136:139], v[24:27]
    v_mfma_f32_16x16x32_bf16 v[28:31], v[116:119], v[140:143], v[28:31]
    ds_read_b128 v[104:107], v6 offset:10240
    v_mfma_f32_16x16x32_bf16 v[32:35], v[120:123], v[136:139], v[32:35]
    v_mfma_f32_16x16x32_bf16 v[36:39], v[120:123], v[140:143], v[36:39]
    ds_read_b128 v[108:111], v6 offset:11264
    s_waitcnt lgkmcnt(8)
    v_mfma_f32_16x16x32_bf16 v[40:43], v[124:127], v[136:139], v[40:43]
    v_mfma_f32_16x16x32_bf16 v[44:47], v[124:127], v[140:143], v[44:47]
    ds_read_b128 v[112:115], v6 offset:12288
    v_mfma_f32_16x16x32_bf16 v[48:51], v[128:131], v[136:139], v[48:51]
    v_mfma_f32_16x16x32_bf16 v[52:55], v[128:131], v[140:143], v[52:55]
    ds_read_b128 v[116:119], v6 offset:13312
    v_mfma_f32_16x16x32_bf16 v[56:59], v[132:135], v[136:139], v[56:59]
    v_mfma_f32_16x16x32_bf16 v[60:63], v[132:135], v[140:143], v[60:63]
    ds_read_b128 v[120:123], v6 offset:14336
    s_waitcnt lgkmcnt(8)
    v_mfma_f32_16x16x32_bf16 v[64:67], v[88:91], v[136:139], v[64:67]
    v_mfma_f32_16x16x32_bf16 v[68:71], v[88:91], v[140:143], v[68:71]
    ds_read_b128 v[124:127], v6 offset:15360
    v_mfma_f32_16x16x32_bf16 v[72:75], v[92:95], v[136:139], v[72:75]
    v_mfma_f32_16x16x32_bf16 v[76:79], v[92:95], v[140:143], v[76:79]
    ds_read_b128 v[128:131], v6 offset:16384
    v_mfma_f32_16x16x32_bf16 v[80:83], v[96:99], v[136:139], v[80:83]
    v_mfma_f32_16x16x32_bf16 v[84:87], v[96:99], v[140:143], v[84:87]
    ds_read_b128 v[132:135], v6 offset:17408
    s_barrier
    ds_read_b128 v[136:139], v9 offset:0
    ds_read_b128 v[140:143], v10 offset:0
    s_waitcnt lgkmcnt(8)
    v_mfma_f32_16x16x32_bf16 v[16:19], v[100:103], v[144:147], v[16:19]
    v_mfma_f32_16x16x32_bf16 v[20:23], v[100:103], v[148:151], v[20:23]
    ds_read_b128 v[88:91], v6 offset:18432
    v_mfma_f32_16x16x32_bf16 v[24:27], v[104:107], v[144:147], v[24:27]
    v_mfma_f32_16x16x32_bf16 v[28:31], v[104:107], v[148:151], v[28:31]
    ds_read_b128 v[92:95], v6 offset:19456
    v_mfma_f32_16x16x32_bf16 v[32:35], v[108:111], v[144:147], v[32:35]
    v_mfma_f32_16x16x32_bf16 v[36:39], v[108:111], v[148:151], v[36:39]
    ds_read_b128 v[96:99], v6 offset:20480
    s_waitcnt lgkmcnt(8)
    v_mfma_f32_16x16x32_bf16 v[40:43], v[112:115], v[144:147], v[40:43]
    v_mfma_f32_16x16x32_bf16 v[44:47], v[112:115], v[148:151], v[44:47]
    ds_read_b128 v[100:103], v6 offset:21504
    v_mfma_f32_16x16x32_bf16 v[48:51], v[116:119], v[144:147], v[48:51]
    v_mfma_f32_16x16x32_bf16 v[52:55], v[116:119], v[148:151], v[52:55]
    ds_read_b128 v[104:107], v6 offset:22528
    v_mfma_f32_16x16x32_bf16 v[56:59], v[120:123], v[144:147], v[56:59]
    v_mfma_f32_16x16x32_bf16 v[60:63], v[120:123], v[148:151], v[60:63]
    ds_read_b128 v[108:111], v6 offset:23552
    s_waitcnt lgkmcnt(8)
    v_mfma_f32_16x16x32_bf16 v[64:67], v[124:127], v[144:147], v[64:67]
    v_mfma_f32_16x16x32_bf16 v[68:71], v[124:127], v[148:151], v[68:71]
    ds_read_b128 v[112:115], v6 offset:24576
    v_mfma_f32_16x16x32_bf16 v[72:75], v[128:131], v[144:147], v[72:75]
    v_mfma_f32_16x16x32_bf16 v[76:79], v[128:131], v[148:151], v[76:79]
    ds_read_b128 v[116:119], v6 offset:25600
    v_mfma_f32_16x16x32_bf16 v[80:83], v[132:135], v[144:147], v[80:83]
    v_mfma_f32_16x16x32_bf16 v[84:87], v[132:135], v[148:151], v[84:87]
    ds_read_b128 v[120:123], v6 offset:26624
    ds_read_b128 v[144:147], v9 offset:8192
    ds_read_b128 v[148:151], v10 offset:8192
    s_waitcnt lgkmcnt(8)
    v_mfma_f32_16x16x32_bf16 v[16:19], v[88:91], v[136:139], v[16:19]
    v_mfma_f32_16x16x32_bf16 v[20:23], v[88:91], v[140:143], v[20:23]
    ds_read_b128 v[124:127], v6 offset:27648
    v_mfma_f32_16x16x32_bf16 v[24:27], v[92:95], v[136:139], v[24:27]
    v_mfma_f32_16x16x32_bf16 v[28:31], v[92:95], v[140:143], v[28:31]
    ds_read_b128 v[128:131], v6 offset:28672
    v_mfma_f32_16x16x32_bf16 v[32:35], v[96:99], v[136:139], v[32:35]
    v_mfma_f32_16x16x32_bf16 v[36:39], v[96:99], v[140:143], v[36:39]
    ds_read_b128 v[132:135], v6 offset:29696
    s_waitcnt lgkmcnt(8)
    v_mfma_f32_16x16x32_bf16 v[40:43], v[100:103], v[136:139], v[40:43]
    v_mfma_f32_16x16x32_bf16 v[44:47], v[100:103], v[140:143], v[44:47]
    ds_read_b128 v[88:91], v6 offset:30720
    v_mfma_f32_16x16x32_bf16 v[48:51], v[104:107], v[136:139], v[48:51]
    v_mfma_f32_16x16x32_bf16 v[52:55], v[104:107], v[140:143], v[52:55]
    ds_read_b128 v[92:95], v6 offset:31744
    v_mfma_f32_16x16x32_bf16 v[56:59], v[108:111], v[136:139], v[56:59]
    v_mfma_f32_16x16x32_bf16 v[60:63], v[108:111], v[140:143], v[60:63]
    ds_read_b128 v[96:99], v6 offset:32768
    s_waitcnt lgkmcnt(8)
    v_mfma_f32_16x16x32_bf16 v[64:67], v[112:115], v[136:139], v[64:67]
    v_mfma_f32_16x16x32_bf16 v[68:71], v[112:115], v[140:143], v[68:71]
    ds_read_b128 v[100:103], v6 offset:33792
    v_mfma_f32_16x16x32_bf16 v[72:75], v[116:119], v[136:139], v[72:75]
    v_mfma_f32_16x16x32_bf16 v[76:79], v[116:119], v[140:143], v[76:79]
    ds_read_b128 v[104:107], v6 offset:34816
    v_mfma_f32_16x16x32_bf16 v[80:83], v[120:123], v[136:139], v[80:83]
    v_mfma_f32_16x16x32_bf16 v[84:87], v[120:123], v[140:143], v[84:87]
    ds_read_b128 v[108:111], v6 offset:35840
    s_barrier
    ds_read_b128 v[136:139], v9 offset:16384
    ds_read_b128 v[140:143], v10 offset:16384
    s_waitcnt lgkmcnt(8)
    v_mfma_f32_16x16x32_bf16 v[16:19], v[124:127], v[144:147], v[16:19]
    v_mfma_f32_16x16x32_bf16 v[20:23], v[124:127], v[148:151], v[20:23]
    ds_read_b128 v[112:115], v6 offset:36864
    v_mfma_f32_16x16x32_bf16 v[24:27], v[128:131], v[144:147], v[24:27]
    v_mfma_f32_16x16x32_bf16 v[28:31], v[128:131], v[148:151], v[28:31]
    ds_read_b128 v[116:119], v6 offset:37888
    v_mfma_f32_16x16x32_bf16 v[32:35], v[132:135], v[144:147], v[32:35]
    v_mfma_f32_16x16x32_bf16 v[36:39], v[132:135], v[148:151], v[36:39]
    ds_read_b128 v[120:123], v6 offset:38912
    s_waitcnt lgkmcnt(8)
    v_mfma_f32_16x16x32_bf16 v[40:43], v[88:91], v[144:147], v[40:43]
    v_mfma_f32_16x16x32_bf16 v[44:47], v[88:91], v[148:151], v[44:47]
    ds_read_b128 v[124:127], v6 offset:39936
    v_mfma_f32_16x16x32_bf16 v[48:51], v[92:95], v[144:147], v[48:51]
    v_mfma_f32_16x16x32_bf16 v[52:55], v[92:95], v[148:151], v[52:55]
    ds_read_b128 v[128:131], v6 offset:40960
    v_mfma_f32_16x16x32_bf16 v[56:59], v[96:99], v[144:147], v[56:59]
    v_mfma_f32_16x16x32_bf16 v[60:63], v[96:99], v[148:151], v[60:63]
    ds_read_b128 v[132:135], v6 offset:41984
    s_waitcnt lgkmcnt(8)
    v_mfma_f32_16x16x32_bf16 v[64:67], v[100:103], v[144:147], v[64:67]
    v_mfma_f32_16x16x32_bf16 v[68:71], v[100:103], v[148:151], v[68:71]
    ds_read_b128 v[88:91], v6 offset:43008
    v_mfma_f32_16x16x32_bf16 v[72:75], v[104:107], v[144:147], v[72:75]
    v_mfma_f32_16x16x32_bf16 v[76:79], v[104:107], v[148:151], v[76:79]
    ds_read_b128 v[92:95], v6 offset:44032
    v_mfma_f32_16x16x32_bf16 v[80:83], v[108:111], v[144:147], v[80:83]
    v_mfma_f32_16x16x32_bf16 v[84:87], v[108:111], v[148:151], v[84:87]
    ds_read_b128 v[96:99], v6 offset:45056
    ds_read_b128 v[144:147], v9 offset:24576
    ds_read_b128 v[148:151], v10 offset:24576
    s_waitcnt lgkmcnt(8)
    v_mfma_f32_16x16x32_bf16 v[16:19], v[112:115], v[136:139], v[16:19]
    v_mfma_f32_16x16x32_bf16 v[20:23], v[112:115], v[140:143], v[20:23]
    ds_read_b128 v[100:103], v6 offset:46080
    v_mfma_f32_16x16x32_bf16 v[24:27], v[116:119], v[136:139], v[24:27]
    v_mfma_f32_16x16x32_bf16 v[28:31], v[116:119], v[140:143], v[28:31]
    ds_read_b128 v[104:107], v6 offset:47104
    v_mfma_f32_16x16x32_bf16 v[32:35], v[120:123], v[136:139], v[32:35]
    v_mfma_f32_16x16x32_bf16 v[36:39], v[120:123], v[140:143], v[36:39]
    ds_read_b128 v[108:111], v6 offset:48128
    s_waitcnt lgkmcnt(8)
    v_mfma_f32_16x16x32_bf16 v[40:43], v[124:127], v[136:139], v[40:43]
    v_mfma_f32_16x16x32_bf16 v[44:47], v[124:127], v[140:143], v[44:47]
    ds_read_b128 v[112:115], v6 offset:49152
    v_mfma_f32_16x16x32_bf16 v[48:51], v[128:131], v[136:139], v[48:51]
    v_mfma_f32_16x16x32_bf16 v[52:55], v[128:131], v[140:143], v[52:55]
    ds_read_b128 v[116:119], v6 offset:50176
    v_mfma_f32_16x16x32_bf16 v[56:59], v[132:135], v[136:139], v[56:59]
    v_mfma_f32_16x16x32_bf16 v[60:63], v[132:135], v[140:143], v[60:63]
    ds_read_b128 v[120:123], v6 offset:51200
    s_waitcnt lgkmcnt(8)
    v_mfma_f32_16x16x32_bf16 v[64:67], v[88:91], v[136:139], v[64:67]
    v_mfma_f32_16x16x32_bf16 v[68:71], v[88:91], v[140:143], v[68:71]
    ds_read_b128 v[124:127], v6 offset:52224
    v_mfma_f32_16x16x32_bf16 v[72:75], v[92:95], v[136:139], v[72:75]
    v_mfma_f32_16x16x32_bf16 v[76:79], v[92:95], v[140:143], v[76:79]
    ds_read_b128 v[128:131], v6 offset:53248
    v_mfma_f32_16x16x32_bf16 v[80:83], v[96:99], v[136:139], v[80:83]
    v_mfma_f32_16x16x32_bf16 v[84:87], v[96:99], v[140:143], v[84:87]
    ds_read_b128 v[132:135], v6 offset:54272
    s_barrier
    ds_read_b128 v[136:139], v9 offset:32768
    ds_read_b128 v[140:143], v10 offset:32768
    s_waitcnt lgkmcnt(8)
    v_mfma_f32_16x16x32_bf16 v[16:19], v[100:103], v[144:147], v[16:19]
    v_mfma_f32_16x16x32_bf16 v[20:23], v[100:103], v[148:151], v[20:23]
    ds_read_b128 v[88:91], v7 offset:0
    v_mfma_f32_16x16x32_bf16 v[24:27], v[104:107], v[144:147], v[24:27]
    v_mfma_f32_16x16x32_bf16 v[28:31], v[104:107], v[148:151], v[28:31]
    ds_read_b128 v[92:95], v7 offset:1024
    v_mfma_f32_16x16x32_bf16 v[32:35], v[108:111], v[144:147], v[32:35]
    v_mfma_f32_16x16x32_bf16 v[36:39], v[108:111], v[148:151], v[36:39]
    ds_read_b128 v[96:99], v7 offset:2048
    s_waitcnt lgkmcnt(8)
    v_mfma_f32_16x16x32_bf16 v[40:43], v[112:115], v[144:147], v[40:43]
    v_mfma_f32_16x16x32_bf16 v[44:47], v[112:115], v[148:151], v[44:47]
    ds_read_b128 v[100:103], v7 offset:3072
    v_mfma_f32_16x16x32_bf16 v[48:51], v[116:119], v[144:147], v[48:51]
    v_mfma_f32_16x16x32_bf16 v[52:55], v[116:119], v[148:151], v[52:55]
    ds_read_b128 v[104:107], v7 offset:4096
    v_mfma_f32_16x16x32_bf16 v[56:59], v[120:123], v[144:147], v[56:59]
    v_mfma_f32_16x16x32_bf16 v[60:63], v[120:123], v[148:151], v[60:63]
    ds_read_b128 v[108:111], v7 offset:5120
    s_waitcnt lgkmcnt(8)
    v_mfma_f32_16x16x32_bf16 v[64:67], v[124:127], v[144:147], v[64:67]
    v_mfma_f32_16x16x32_bf16 v[68:71], v[124:127], v[148:151], v[68:71]
    ds_read_b128 v[112:115], v7 offset:6144
    v_mfma_f32_16x16x32_bf16 v[72:75], v[128:131], v[144:147], v[72:75]
    v_mfma_f32_16x16x32_bf16 v[76:79], v[128:131], v[148:151], v[76:79]
    ds_read_b128 v[116:119], v7 offset:7168
    v_mfma_f32_16x16x32_bf16 v[80:83], v[132:135], v[144:147], v[80:83]
    v_mfma_f32_16x16x32_bf16 v[84:87], v[132:135], v[148:151], v[84:87]
    ds_read_b128 v[120:123], v7 offset:8192
    ds_read_b128 v[144:147], v9 offset:40960
    ds_read_b128 v[148:151], v10 offset:40960
    s_waitcnt lgkmcnt(8)
    v_mfma_f32_16x16x32_bf16 v[16:19], v[88:91], v[136:139], v[16:19]
    v_mfma_f32_16x16x32_bf16 v[20:23], v[88:91], v[140:143], v[20:23]
    ds_read_b128 v[124:127], v7 offset:9216
    v_mfma_f32_16x16x32_bf16 v[24:27], v[92:95], v[136:139], v[24:27]
    v_mfma_f32_16x16x32_bf16 v[28:31], v[92:95], v[140:143], v[28:31]
    ds_read_b128 v[128:131], v7 offset:10240
    v_mfma_f32_16x16x32_bf16 v[32:35], v[96:99], v[136:139], v[32:35]
    v_mfma_f32_16x16x32_bf16 v[36:39], v[96:99], v[140:143], v[36:39]
    ds_read_b128 v[132:135], v7 offset:11264
    s_waitcnt lgkmcnt(8)
    v_mfma_f32_16x16x32_bf16 v[40:43], v[100:103], v[136:139], v[40:43]
    v_mfma_f32_16x16x32_bf16 v[44:47], v[100:103], v[140:143], v[44:47]
    ds_read_b128 v[88:91], v7 offset:12288
    v_mfma_f32_16x16x32_bf16 v[48:51], v[104:107], v[136:139], v[48:51]
    v_mfma_f32_16x16x32_bf16 v[52:55], v[104:107], v[140:143], v[52:55]
    ds_read_b128 v[92:95], v7 offset:13312
    v_mfma_f32_16x16x32_bf16 v[56:59], v[108:111], v[136:139], v[56:59]
    v_mfma_f32_16x16x32_bf16 v[60:63], v[108:111], v[140:143], v[60:63]
    ds_read_b128 v[96:99], v7 offset:14336
    s_waitcnt lgkmcnt(8)
    v_mfma_f32_16x16x32_bf16 v[64:67], v[112:115], v[136:139], v[64:67]
    v_mfma_f32_16x16x32_bf16 v[68:71], v[112:115], v[140:143], v[68:71]
    ds_read_b128 v[100:103], v7 offset:15360
    v_mfma_f32_16x16x32_bf16 v[72:75], v[116:119], v[136:139], v[72:75]
    v_mfma_f32_16x16x32_bf16 v[76:79], v[116:119], v[140:143], v[76:79]
    ds_read_b128 v[104:107], v7 offset:16384
    v_mfma_f32_16x16x32_bf16 v[80:83], v[120:123], v[136:139], v[80:83]
    v_mfma_f32_16x16x32_bf16 v[84:87], v[120:123], v[140:143], v[84:87]
    ds_read_b128 v[108:111], v7 offset:17408
    s_waitcnt lgkmcnt(6)
    v_mfma_f32_16x16x32_bf16 v[16:19], v[124:127], v[144:147], v[16:19]
    v_mfma_f32_16x16x32_bf16 v[20:23], v[124:127], v[148:151], v[20:23]
    v_mfma_f32_16x16x32_bf16 v[24:27], v[128:131], v[144:147], v[24:27]
    v_mfma_f32_16x16x32_bf16 v[28:31], v[128:131], v[148:151], v[28:31]
    v_mfma_f32_16x16x32_bf16 v[32:35], v[132:135], v[144:147], v[32:35]
    v_mfma_f32_16x16x32_bf16 v[36:39], v[132:135], v[148:151], v[36:39]
    s_waitcnt lgkmcnt(3)
    v_mfma_f32_16x16x32_bf16 v[40:43], v[88:91], v[144:147], v[40:43]
    v_mfma_f32_16x16x32_bf16 v[44:47], v[88:91], v[148:151], v[44:47]
    v_mfma_f32_16x16x32_bf16 v[48:51], v[92:95], v[144:147], v[48:51]
    v_mfma_f32_16x16x32_bf16 v[52:55], v[92:95], v[148:151], v[52:55]
    v_mfma_f32_16x16x32_bf16 v[56:59], v[96:99], v[144:147], v[56:59]
    v_mfma_f32_16x16x32_bf16 v[60:63], v[96:99], v[148:151], v[60:63]
    s_waitcnt lgkmcnt(0)
    v_mfma_f32_16x16x32_bf16 v[64:67], v[100:103], v[144:147], v[64:67]
    v_mfma_f32_16x16x32_bf16 v[68:71], v[100:103], v[148:151], v[68:71]
    v_mfma_f32_16x16x32_bf16 v[72:75], v[104:107], v[144:147], v[72:75]
    v_mfma_f32_16x16x32_bf16 v[76:79], v[104:107], v[148:151], v[76:79]
    v_mfma_f32_16x16x32_bf16 v[80:83], v[108:111], v[144:147], v[80:83]
    v_mfma_f32_16x16x32_bf16 v[84:87], v[108:111], v[148:151], v[84:87]
    s_barrier
    v_and_b32 v10, 15, v1
    v_lshrrev_b32 v13, 4, v1
    s_mov_b32 s26, s34
    s_and_b32 s30, s22, 3
    s_lshl_b32 s30, s30, 3
    s_cmp_ge_u32 s22, 4
    s_cbranch_scc1 K1_K
    s_add_u32 s16, s4, 18083840
    s_addc_u32 s17, s5, 0
    s_mov_b32 s18, 2359296
    s_mov_b32 s19, 0x00020000
    v_lshrrev_b32 v14, 1, v13
    v_add_u32 v14, s30, v14
    v_lshlrev_b32 v14, 6, v14
    v_add_u32 v14, s26, v14
    s_movk_i32 s31, 1152
    v_mul_lo_u32 v14, v14, s31
    v_and_b32 v15, 1, v13
    v_lshl_add_u32 v14, v15, 9, v14
    v_lshl_add_u32 v14, v10, 4, v14
    v_cvt_pk_bf16_f32 v88, v16, v17
    v_cvt_pk_bf16_f32 v89, v18, v19
    v_cvt_pk_bf16_f32 v90, v24, v25
    v_cvt_pk_bf16_f32 v91, v26, v27
    s_mov_b32 s31, 0
    buffer_store_dwordx4 v[88:91], v14, s[16:19], s31 offen offset:0 sc1
    v_cvt_pk_bf16_f32 v92, v32, v33
    v_cvt_pk_bf16_f32 v93, v34, v35
    v_cvt_pk_bf16_f32 v94, v40, v41
    v_cvt_pk_bf16_f32 v95, v42, v43
    s_mov_b32 s31, 147456
    buffer_store_dwordx4 v[92:95], v14, s[16:19], s31 offen offset:0 sc1
    v_cvt_pk_bf16_f32 v96, v48, v49
    v_cvt_pk_bf16_f32 v97, v50, v51
    v_cvt_pk_bf16_f32 v98, v56, v57
    v_cvt_pk_bf16_f32 v99, v58, v59
    s_mov_b32 s31, 294912
    buffer_store_dwordx4 v[96:99], v14, s[16:19], s31 offen offset:0 sc1
    v_cvt_pk_bf16_f32 v100, v64, v65
    v_cvt_pk_bf16_f32 v101, v66, v67
    v_cvt_pk_bf16_f32 v102, v72, v73
    v_cvt_pk_bf16_f32 v103, v74, v75
    s_mov_b32 s31, 442368
    buffer_store_dwordx4 v[100:103], v14, s[16:19], s31 offen offset:0 sc1
    v_cvt_pk_bf16_f32 v104, v20, v21
    v_cvt_pk_bf16_f32 v105, v22, v23
    v_cvt_pk_bf16_f32 v106, v28, v29
    v_cvt_pk_bf16_f32 v107, v30, v31
    s_mov_b32 s31, 0
    buffer_store_dwordx4 v[104:107], v14, s[16:19], s31 offen offset:256 sc1
    v_cvt_pk_bf16_f32 v108, v36, v37
    v_cvt_pk_bf16_f32 v109, v38, v39
    v_cvt_pk_bf16_f32 v110, v44, v45
    v_cvt_pk_bf16_f32 v111, v46, v47
    s_mov_b32 s31, 147456
    buffer_store_dwordx4 v[108:111], v14, s[16:19], s31 offen offset:256 sc1
    v_cvt_pk_bf16_f32 v112, v52, v53
    v_cvt_pk_bf16_f32 v113, v54, v55
    v_cvt_pk_bf16_f32 v114, v60, v61
    v_cvt_pk_bf16_f32 v115, v62, v63
    s_mov_b32 s31, 294912
    buffer_store_dwordx4 v[112:115], v14, s[16:19], s31 offen offset:256 sc1
    v_cvt_pk_bf16_f32 v116, v68, v69
    v_cvt_pk_bf16_f32 v117, v70, v71
    v_cvt_pk_bf16_f32 v118, v76, v77
    v_cvt_pk_bf16_f32 v119, v78, v79
    s_mov_b32 s31, 442368
    buffer_store_dwordx4 v[116:119], v14, s[16:19], s31 offen offset:256 sc1
    v_lshlrev_b32 v14, 1, v13
    v_add_u32 v14, s30, v14
    v_lshlrev_b32 v14, 6, v14
    v_add_u32 v14, s26, v14
    s_movk_i32 s31, 1152
    v_mul_lo_u32 v14, v14, s31
    v_lshl_add_u32 v14, v10, 2, v14
    s_mov_b32 s31, 73728
    v_cvt_pk_bf16_f32 v120, v80, v81
    v_cvt_pk_bf16_f32 v121, v82, v83
    buffer_store_dword v120, v14, s[16:19], 0 offen offset:1024
    buffer_store_dword v121, v14, s[16:19], s31 offen offset:1024
    v_cvt_pk_bf16_f32 v122, v84, v85
    v_cvt_pk_bf16_f32 v123, v86, v87
    buffer_store_dword v122, v14, s[16:19], 0 offen offset:1088
    buffer_store_dword v123, v14, s[16:19], s31 offen offset:1088
    s_endpgm
K1_K:
    s_add_u32 s16, s4, 20443136
    s_addc_u32 s17, s5, 0
    s_mov_b32 s18, 4718592
    s_mov_b32 s19, 0x00020000
    v_lshrrev_b32 v14, 1, v13
    v_add_u32 v14, s30, v14
    v_lshlrev_b32 v14, 6, v14
    v_add_u32 v14, s26, v14
    s_movk_i32 s31, 2304
    v_mul_lo_u32 v14, v14, s31
    v_and_b32 v15, 1, v13
    v_lshl_add_u32 v14, v15, 9, v14
    v_lshl_add_u32 v14, v10, 4, v14
    v_cvt_pk_bf16_f32 v88, v16, v17
    v_cvt_pk_bf16_f32 v89, v18, v19
    v_cvt_pk_bf16_f32 v90, v24, v25
    v_cvt_pk_bf16_f32 v91, v26, v27
    s_mov_b32 s31, 0
    buffer_store_dwordx4 v[88:91], v14, s[16:19], s31 offen offset:0 sc1
    v_cvt_pk_bf16_f32 v92, v32, v33
    v_cvt_pk_bf16_f32 v93, v34, v35
    v_cvt_pk_bf16_f32 v94, v40, v41
    v_cvt_pk_bf16_f32 v95, v42, v43
    s_mov_b32 s31, 294912
    buffer_store_dwordx4 v[92:95], v14, s[16:19], s31 offen offset:0 sc1
    v_cvt_pk_bf16_f32 v96, v48, v49
    v_cvt_pk_bf16_f32 v97, v50, v51
    v_cvt_pk_bf16_f32 v98, v56, v57
    v_cvt_pk_bf16_f32 v99, v58, v59
    s_mov_b32 s31, 589824
    buffer_store_dwordx4 v[96:99], v14, s[16:19], s31 offen offset:0 sc1
    v_cvt_pk_bf16_f32 v100, v64, v65
    v_cvt_pk_bf16_f32 v101, v66, v67
    v_cvt_pk_bf16_f32 v102, v72, v73
    v_cvt_pk_bf16_f32 v103, v74, v75
    s_mov_b32 s31, 884736
    buffer_store_dwordx4 v[100:103], v14, s[16:19], s31 offen offset:0 sc1
    v_cvt_pk_bf16_f32 v104, v20, v21
    v_cvt_pk_bf16_f32 v105, v22, v23
    v_cvt_pk_bf16_f32 v106, v28, v29
    v_cvt_pk_bf16_f32 v107, v30, v31
    s_mov_b32 s31, 0
    buffer_store_dwordx4 v[104:107], v14, s[16:19], s31 offen offset:256 sc1
    v_cvt_pk_bf16_f32 v108, v36, v37
    v_cvt_pk_bf16_f32 v109, v38, v39
    v_cvt_pk_bf16_f32 v110, v44, v45
    v_cvt_pk_bf16_f32 v111, v46, v47
    s_mov_b32 s31, 294912
    buffer_store_dwordx4 v[108:111], v14, s[16:19], s31 offen offset:256 sc1
    v_cvt_pk_bf16_f32 v112, v52, v53
    v_cvt_pk_bf16_f32 v113, v54, v55
    v_cvt_pk_bf16_f32 v114, v60, v61
    v_cvt_pk_bf16_f32 v115, v62, v63
    s_mov_b32 s31, 589824
    buffer_store_dwordx4 v[112:115], v14, s[16:19], s31 offen offset:256 sc1
    v_cvt_pk_bf16_f32 v116, v68, v69
    v_cvt_pk_bf16_f32 v117, v70, v71
    v_cvt_pk_bf16_f32 v118, v76, v77
    v_cvt_pk_bf16_f32 v119, v78, v79
    s_mov_b32 s31, 884736
    buffer_store_dwordx4 v[116:119], v14, s[16:19], s31 offen offset:256 sc1
    v_lshlrev_b32 v14, 1, v13
    v_add_u32 v14, s30, v14
    v_lshlrev_b32 v14, 6, v14
    v_add_u32 v14, s26, v14
    s_movk_i32 s31, 2304
    v_mul_lo_u32 v14, v14, s31
    v_lshl_add_u32 v14, v10, 2, v14
    s_mov_b32 s31, 147456
    v_cvt_pk_bf16_f32 v120, v80, v81
    v_cvt_pk_bf16_f32 v121, v82, v83
    buffer_store_dword v120, v14, s[16:19], 0 offen offset:1024
    buffer_store_dword v121, v14, s[16:19], s31 offen offset:1024
    v_cvt_pk_bf16_f32 v122, v84, v85
    v_cvt_pk_bf16_f32 v123, v86, v87
    buffer_store_dword v122, v14, s[16:19], 0 offen offset:1088
    buffer_store_dword v123, v14, s[16:19], s31 offen offset:1088
    v_mul_f32 v88, v16, v16
    v_fmac_f32 v88, v17, v17
    v_fmac_f32 v88, v18, v18
    v_fmac_f32 v88, v19, v19
    v_fmac_f32 v88, v24, v24
    v_fmac_f32 v88, v25, v25
    v_fmac_f32 v88, v26, v26
    v_fmac_f32 v88, v27, v27
    v_mul_f32 v89, v20, v20
    v_fmac_f32 v89, v21, v21
    v_fmac_f32 v89, v22, v22
    v_fmac_f32 v89, v23, v23
    v_fmac_f32 v89, v28, v28
    v_fmac_f32 v89, v29, v29
    v_fmac_f32 v89, v30, v30
    v_fmac_f32 v89, v31, v31
    v_mul_f32 v90, v32, v32
    v_fmac_f32 v90, v33, v33
    v_fmac_f32 v90, v34, v34
    v_fmac_f32 v90, v35, v35
    v_fmac_f32 v90, v40, v40
    v_fmac_f32 v90, v41, v41
    v_fmac_f32 v90, v42, v42
    v_fmac_f32 v90, v43, v43
    v_mul_f32 v91, v36, v36
    v_fmac_f32 v91, v37, v37
    v_fmac_f32 v91, v38, v38
    v_fmac_f32 v91, v39, v39
    v_fmac_f32 v91, v44, v44
    v_fmac_f32 v91, v45, v45
    v_fmac_f32 v91, v46, v46
    v_fmac_f32 v91, v47, v47
    v_mul_f32 v92, v48, v48
    v_fmac_f32 v92, v49, v49
    v_fmac_f32 v92, v50, v50
    v_fmac_f32 v92, v51, v51
    v_fmac_f32 v92, v56, v56
    v_fmac_f32 v92, v57, v57
    v_fmac_f32 v92, v58, v58
    v_fmac_f32 v92, v59, v59
    v_mul_f32 v93, v52, v52
    v_fmac_f32 v93, v53, v53
    v_fmac_f32 v93, v54, v54
    v_fmac_f32 v93, v55, v55
    v_fmac_f32 v93, v60, v60
    v_fmac_f32 v93, v61, v61
    v_fmac_f32 v93, v62, v62
    v_fmac_f32 v93, v63, v63
    v_mul_f32 v94, v64, v64
    v_fmac_f32 v94, v65, v65
    v_fmac_f32 v94, v66, v66
    v_fmac_f32 v94, v67, v67
    v_fmac_f32 v94, v72, v72
    v_fmac_f32 v94, v73, v73
    v_fmac_f32 v94, v74, v74
    v_fmac_f32 v94, v75, v75
    v_mul_f32 v95, v68, v68
    v_fmac_f32 v95, v69, v69
    v_fmac_f32 v95, v70, v70
    v_fmac_f32 v95, v71, v71
    v_fmac_f32 v95, v76, v76
    v_fmac_f32 v95, v77, v77
    v_fmac_f32 v95, v78, v78
    v_fmac_f32 v95, v79, v79
    v_mov_b32 v9, v88
    s_nop 1
    v_permlane16_swap_b32 v88, v9
    v_add_f32 v88, v88, v9
    v_mov_b32 v9, v89
    s_nop 1
    v_permlane16_swap_b32 v89, v9
    v_add_f32 v89, v89, v9
    v_max_f32 v104, v88, v89
    v_mov_b32 v9, v90
    s_nop 1
    v_permlane16_swap_b32 v90, v9
    v_add_f32 v90, v90, v9
    v_mov_b32 v9, v91
    s_nop 1
    v_permlane16_swap_b32 v91, v9
    v_add_f32 v91, v91, v9
    v_max_f32 v105, v90, v91
    v_mov_b32 v9, v92
    s_nop 1
    v_permlane16_swap_b32 v92, v9
    v_add_f32 v92, v92, v9
    v_mov_b32 v9, v93
    s_nop 1
    v_permlane16_swap_b32 v93, v9
    v_add_f32 v93, v93, v9
    v_max_f32 v106, v92, v93
    v_mov_b32 v9, v94
    s_nop 1
    v_permlane16_swap_b32 v94, v9
    v_add_f32 v94, v94, v9
    v_mov_b32 v9, v95
    s_nop 1
    v_permlane16_swap_b32 v95, v9
    v_add_f32 v95, v95, v9
    v_max_f32 v107, v94, v95
    v_mul_f32 v112, v80, v80
    v_fmac_f32 v112, v81, v81
    v_mul_f32 v113, v84, v84
    v_fmac_f32 v113, v85, v85
    v_max_f32 v108, v112, v113
    v_mul_f32 v114, v82, v82
    v_fmac_f32 v114, v83, v83
    v_mul_f32 v115, v86, v86
    v_fmac_f32 v115, v87, v87
    v_max_f32 v109, v114, v115
    v_max_f32_dpp v104, v104, v104 quad_perm:[1,0,3,2] row_mask:0xf bank_mask:0xf
    s_nop 1
    v_max_f32_dpp v104, v104, v104 quad_perm:[2,3,0,1] row_mask:0xf bank_mask:0xf
    s_nop 1
    v_max_f32_dpp v104, v104, v104 row_half_mirror row_mask:0xf bank_mask:0xf
    s_nop 1
    v_max_f32_dpp v104, v104, v104 row_mirror row_mask:0xf bank_mask:0xf
    v_max_f32_dpp v105, v105, v105 quad_perm:[1,0,3,2] row_mask:0xf bank_mask:0xf
    s_nop 1
    v_max_f32_dpp v105, v105, v105 quad_perm:[2,3,0,1] row_mask:0xf bank_mask:0xf
    s_nop 1
    v_max_f32_dpp v105, v105, v105 row_half_mirror row_mask:0xf bank_mask:0xf
    s_nop 1
    v_max_f32_dpp v105, v105, v105 row_mirror row_mask:0xf bank_mask:0xf
    v_max_f32_dpp v106, v106, v106 quad_perm:[1,0,3,2] row_mask:0xf bank_mask:0xf
    s_nop 1
    v_max_f32_dpp v106, v106, v106 quad_perm:[2,3,0,1] row_mask:0xf bank_mask:0xf
    s_nop 1
    v_max_f32_dpp v106, v106, v106 row_half_mirror row_mask:0xf bank_mask:0xf
    s_nop 1
    v_max_f32_dpp v106, v106, v106 row_mirror row_mask:0xf bank_mask:0xf
    v_max_f32_dpp v107, v107, v107 quad_perm:[1,0,3,2] row_mask:0xf bank_mask:0xf
    s_nop 1
    v_max_f32_dpp v107, v107, v107 quad_perm:[2,3,0,1] row_mask:0xf bank_mask:0xf
    s_nop 1
    v_max_f32_dpp v107, v107, v107 row_half_mirror row_mask:0xf bank_mask:0xf
    s_nop 1
    v_max_f32_dpp v107, v107, v107 row_mirror row_mask:0xf bank_mask:0xf
    v_max_f32_dpp v108, v108, v108 quad_perm:[1,0,3,2] row_mask:0xf bank_mask:0xf
    s_nop 1
    v_max_f32_dpp v108, v108, v108 quad_perm:[2,3,0,1] row_mask:0xf bank_mask:0xf
    s_nop 1
    v_max_f32_dpp v108, v108, v108 row_half_mirror row_mask:0xf bank_mask:0xf
    s_nop 1
    v_max_f32_dpp v108, v108, v108 row_mirror row_mask:0xf bank_mask:0xf
    v_max_f32_dpp v109, v109, v109 quad_perm:[1,0,3,2] row_mask:0xf bank_mask:0xf
    s_nop 1
    v_max_f32_dpp v109, v109, v109 quad_perm:[2,3,0,1] row_mask:0xf bank_mask:0xf
    s_nop 1
    v_max_f32_dpp v109, v109, v109 row_half_mirror row_mask:0xf bank_mask:0xf
    s_nop 1
    v_max_f32_dpp v109, v109, v109 row_mirror row_mask:0xf bank_mask:0xf
    s_lshl_b32 s28, s20, 6
    v_lshrrev_b32 v9, 5, v1
    v_lshlrev_b32 v9, 3, v9
    v_add_u32 v9, s28, v9
    v_lshlrev_b32 v11, 4, v13
    v_add_u32 v11, s28, v11
    ds_write_b32 v9, v104 offset:0
    ds_write_b32 v9, v105 offset:16
    ds_write_b32 v9, v106 offset:32
    ds_write_b32 v9, v107 offset:48
    ds_write_b32 v11, v108 offset:4
    ds_write_b32 v11, v109 offset:12
    v_and_b32 v12, 7, v1
    v_lshlrev_b32 v12, 3, v12
    v_add_u32 v12, s28, v12
    ds_read_b64 v[118:119], v12
    s_waitcnt lgkmcnt(0)
    v_add_f32 v9, v118, v119
    s_add_u32 s16, s4, 25161728
    s_addc_u32 s17, s5, 0
    s_mov_b32 s18, 8192
    s_mov_b32 s19, 0x00020000
    v_and_b32 v14, 7, v1
    v_add_u32 v14, s30, v14
    v_lshlrev_b32 v14, 6, v14
    v_add_u32 v14, s26, v14
    v_lshlrev_b32 v14, 2, v14
    s_mov_b64 exec, 0xff
    buffer_store_dword v9, v14, s[16:19], 0 offen
    s_endpgm
K1_V:
    v_bfe_u32 v11, v1, 3, 1
    v_lshlrev_b32 v11, 10, v11
    v_and_b32 v12, 0x30, v1
    v_and_b32 v13, 7, v1
    v_add_u32 v12, v12, v13
    v_lshl_add_u32 v11, v12, 4, v11
    s_lshl_b32 s26, s33, 11
    s_add_u32 s26, s26, 92160
    v_add_u32 v9, s26, v11
    v_add_u32 v10, 128, v9
    s_barrier
    ds_read_b128 v[136:139], v9 offset:0
    ds_read_b128 v[140:143], v10 offset:0
    ds_read_b128 v[88:91], v6 offset:0
    ds_read_b128 v[92:95], v6 offset:1024
    ds_read_b128 v[96:99], v6 offset:2048
    ds_read_b128 v[100:103], v6 offset:3072
    ds_read_b128 v[104:107], v6 offset:4096
    ds_read_b128 v[108:111], v6 offset:5120
    ds_read_b128 v[112:115], v6 offset:6144
    ds_read_b128 v[116:119], v6 offset:7168
    ds_read_b128 v[120:123], v6 offset:8192
    ds_read_b128 v[144:147], v9 offset:8192
    ds_read_b128 v[148:151], v10 offset:8192
    s_waitcnt lgkmcnt(8)
    v_mfma_f32_16x16x32_bf16 v[16:19], v[136:139], v[88:91], 0
    v_mfma_f32_16x16x32_bf16 v[20:23], v[140:143], v[88:91], 0
    ds_read_b128 v[124:127], v6 offset:9216
    v_mfma_f32_16x16x32_bf16 v[24:27], v[136:139], v[92:95], 0
    v_mfma_f32_16x16x32_bf16 v[28:31], v[140:143], v[92:95], 0
    ds_read_b128 v[128:131], v6 offset:10240
    v_mfma_f32_16x16x32_bf16 v[32:35], v[136:139], v[96:99], 0
    v_mfma_f32_16x16x32_bf16 v[36:39], v[140:143], v[96:99], 0
    ds_read_b128 v[132:135], v6 offset:11264
    s_waitcnt lgkmcnt(8)
    v_mfma_f32_16x16x32_bf16 v[40:43], v[136:139], v[100:103], 0
    v_mfma_f32_16x16x32_bf16 v[44:47], v[140:143], v[100:103], 0
    ds_read_b128 v[88:91], v6 offset:12288
    v_mfma_f32_16x16x32_bf16 v[48:51], v[136:139], v[104:107], 0
    v_mfma_f32_16x16x32_bf16 v[52:55], v[140:143], v[104:107], 0
    ds_read_b128 v[92:95], v6 offset:13312
    v_mfma_f32_16x16x32_bf16 v[56:59], v[136:139], v[108:111], 0
    v_mfma_f32_16x16x32_bf16 v[60:63], v[140:143], v[108:111], 0
    ds_read_b128 v[96:99], v6 offset:14336
    s_waitcnt lgkmcnt(8)
    v_mfma_f32_16x16x32_bf16 v[64:67], v[136:139], v[112:115], 0
    v_mfma_f32_16x16x32_bf16 v[68:71], v[140:143], v[112:115], 0
    ds_read_b128 v[100:103], v6 offset:15360
    v_mfma_f32_16x16x32_bf16 v[72:75], v[136:139], v[116:119], 0
    v_mfma_f32_16x16x32_bf16 v[76:79], v[140:143], v[116:119], 0
    ds_read_b128 v[104:107], v6 offset:16384
    v_mfma_f32_16x16x32_bf16 v[80:83], v[136:139], v[120:123], 0
    v_mfma_f32_16x16x32_bf16 v[84:87], v[140:143], v[120:123], 0
    ds_read_b128 v[108:111], v6 offset:17408
    s_barrier
    ds_read_b128 v[136:139], v9 offset:16384
    ds_read_b128 v[140:143], v10 offset:16384
    s_waitcnt lgkmcnt(8)
    v_mfma_f32_16x16x32_bf16 v[16:19], v[144:147], v[124:127], v[16:19]
    v_mfma_f32_16x16x32_bf16 v[20:23], v[148:151], v[124:127], v[20:23]
    ds_read_b128 v[112:115], v6 offset:18432
    v_mfma_f32_16x16x32_bf16 v[24:27], v[144:147], v[128:131], v[24:27]
    v_mfma_f32_16x16x32_bf16 v[28:31], v[148:151], v[128:131], v[28:31]
    ds_read_b128 v[116:119], v6 offset:19456
    v_mfma_f32_16x16x32_bf16 v[32:35], v[144:147], v[132:135], v[32:35]
    v_mfma_f32_16x16x32_bf16 v[36:39], v[148:151], v[132:135], v[36:39]
    ds_read_b128 v[120:123], v6 offset:20480
    s_waitcnt lgkmcnt(8)
    v_mfma_f32_16x16x32_bf16 v[40:43], v[144:147], v[88:91], v[40:43]
    v_mfma_f32_16x16x32_bf16 v[44:47], v[148:151], v[88:91], v[44:47]
    ds_read_b128 v[124:127], v6 offset:21504
    v_mfma_f32_16x16x32_bf16 v[48:51], v[144:147], v[92:95], v[48:51]
    v_mfma_f32_16x16x32_bf16 v[52:55], v[148:151], v[92:95], v[52:55]
    ds_read_b128 v[128:131], v6 offset:22528
    v_mfma_f32_16x16x32_bf16 v[56:59], v[144:147], v[96:99], v[56:59]
    v_mfma_f32_16x16x32_bf16 v[60:63], v[148:151], v[96:99], v[60:63]
    ds_read_b128 v[132:135], v6 offset:23552
    s_waitcnt lgkmcnt(8)
    v_mfma_f32_16x16x32_bf16 v[64:67], v[144:147], v[100:103], v[64:67]
    v_mfma_f32_16x16x32_bf16 v[68:71], v[148:151], v[100:103], v[68:71]
    ds_read_b128 v[88:91], v6 offset:24576
    v_mfma_f32_16x16x32_bf16 v[72:75], v[144:147], v[104:107], v[72:75]
    v_mfma_f32_16x16x32_bf16 v[76:79], v[148:151], v[104:107], v[76:79]
    ds_read_b128 v[92:95], v6 offset:25600
    v_mfma_f32_16x16x32_bf16 v[80:83], v[144:147], v[108:111], v[80:83]
    v_mfma_f32_16x16x32_bf16 v[84:87], v[148:151], v[108:111], v[84:87]
    ds_read_b128 v[96:99], v6 offset:26624
    ds_read_b128 v[144:147], v9 offset:24576
    ds_read_b128 v[148:151], v10 offset:24576
    s_waitcnt lgkmcnt(8)
    v_mfma_f32_16x16x32_bf16 v[16:19], v[136:139], v[112:115], v[16:19]
    v_mfma_f32_16x16x32_bf16 v[20:23], v[140:143], v[112:115], v[20:23]
    ds_read_b128 v[100:103], v6 offset:27648
    v_mfma_f32_16x16x32_bf16 v[24:27], v[136:139], v[116:119], v[24:27]
    v_mfma_f32_16x16x32_bf16 v[28:31], v[140:143], v[116:119], v[28:31]
    ds_read_b128 v[104:107], v6 offset:28672
    v_mfma_f32_16x16x32_bf16 v[32:35], v[136:139], v[120:123], v[32:35]
    v_mfma_f32_16x16x32_bf16 v[36:39], v[140:143], v[120:123], v[36:39]
    ds_read_b128 v[108:111], v6 offset:29696
    s_waitcnt lgkmcnt(8)
    v_mfma_f32_16x16x32_bf16 v[40:43], v[136:139], v[124:127], v[40:43]
    v_mfma_f32_16x16x32_bf16 v[44:47], v[140:143], v[124:127], v[44:47]
    ds_read_b128 v[112:115], v6 offset:30720
    v_mfma_f32_16x16x32_bf16 v[48:51], v[136:139], v[128:131], v[48:51]
    v_mfma_f32_16x16x32_bf16 v[52:55], v[140:143], v[128:131], v[52:55]
    ds_read_b128 v[116:119], v6 offset:31744
    v_mfma_f32_16x16x32_bf16 v[56:59], v[136:139], v[132:135], v[56:59]
    v_mfma_f32_16x16x32_bf16 v[60:63], v[140:143], v[132:135], v[60:63]
    ds_read_b128 v[120:123], v6 offset:32768
    s_waitcnt lgkmcnt(8)
    v_mfma_f32_16x16x32_bf16 v[64:67], v[136:139], v[88:91], v[64:67]
    v_mfma_f32_16x16x32_bf16 v[68:71], v[140:143], v[88:91], v[68:71]
    ds_read_b128 v[124:127], v6 offset:33792
    v_mfma_f32_16x16x32_bf16 v[72:75], v[136:139], v[92:95], v[72:75]
    v_mfma_f32_16x16x32_bf16 v[76:79], v[140:143], v[92:95], v[76:79]
    ds_read_b128 v[128:131], v6 offset:34816
    v_mfma_f32_16x16x32_bf16 v[80:83], v[136:139], v[96:99], v[80:83]
    v_mfma_f32_16x16x32_bf16 v[84:87], v[140:143], v[96:99], v[84:87]
    ds_read_b128 v[132:135], v6 offset:35840
    s_barrier
    ds_read_b128 v[136:139], v9 offset:32768
    ds_read_b128 v[140:143], v10 offset:32768
    s_waitcnt lgkmcnt(8)
    v_mfma_f32_16x16x32_bf16 v[16:19], v[144:147], v[100:103], v[16:19]
    v_mfma_f32_16x16x32_bf16 v[20:23], v[148:151], v[100:103], v[20:23]
    ds_read_b128 v[88:91], v6 offset:36864
    v_mfma_f32_16x16x32_bf16 v[24:27], v[144:147], v[104:107], v[24:27]
    v_mfma_f32_16x16x32_bf16 v[28:31], v[148:151], v[104:107], v[28:31]
    ds_read_b128 v[92:95], v6 offset:37888
    v_mfma_f32_16x16x32_bf16 v[32:35], v[144:147], v[108:111], v[32:35]
    v_mfma_f32_16x16x32_bf16 v[36:39], v[148:151], v[108:111], v[36:39]
    ds_read_b128 v[96:99], v6 offset:38912
    s_waitcnt lgkmcnt(8)
    v_mfma_f32_16x16x32_bf16 v[40:43], v[144:147], v[112:115], v[40:43]
    v_mfma_f32_16x16x32_bf16 v[44:47], v[148:151], v[112:115], v[44:47]
    ds_read_b128 v[100:103], v6 offset:39936
    v_mfma_f32_16x16x32_bf16 v[48:51], v[144:147], v[116:119], v[48:51]
    v_mfma_f32_16x16x32_bf16 v[52:55], v[148:151], v[116:119], v[52:55]
    ds_read_b128 v[104:107], v6 offset:40960
    v_mfma_f32_16x16x32_bf16 v[56:59], v[144:147], v[120:123], v[56:59]
    v_mfma_f32_16x16x32_bf16 v[60:63], v[148:151], v[120:123], v[60:63]
    ds_read_b128 v[108:111], v6 offset:41984
    s_waitcnt lgkmcnt(8)
    v_mfma_f32_16x16x32_bf16 v[64:67], v[144:147], v[124:127], v[64:67]
    v_mfma_f32_16x16x32_bf16 v[68:71], v[148:151], v[124:127], v[68:71]
    ds_read_b128 v[112:115], v6 offset:43008
    v_mfma_f32_16x16x32_bf16 v[72:75], v[144:147], v[128:131], v[72:75]
    v_mfma_f32_16x16x32_bf16 v[76:79], v[148:151], v[128:131], v[76:79]
    ds_read_b128 v[116:119], v6 offset:44032
    v_mfma_f32_16x16x32_bf16 v[80:83], v[144:147], v[132:135], v[80:83]
    v_mfma_f32_16x16x32_bf16 v[84:87], v[148:151], v[132:135], v[84:87]
    ds_read_b128 v[120:123], v6 offset:45056
    ds_read_b128 v[144:147], v9 offset:40960
    ds_read_b128 v[148:151], v10 offset:40960
    s_waitcnt lgkmcnt(8)
    v_mfma_f32_16x16x32_bf16 v[16:19], v[136:139], v[88:91], v[16:19]
    v_mfma_f32_16x16x32_bf16 v[20:23], v[140:143], v[88:91], v[20:23]
    ds_read_b128 v[124:127], v6 offset:46080
    v_mfma_f32_16x16x32_bf16 v[24:27], v[136:139], v[92:95], v[24:27]
    v_mfma_f32_16x16x32_bf16 v[28:31], v[140:143], v[92:95], v[28:31]
    ds_read_b128 v[128:131], v6 offset:47104
    v_mfma_f32_16x16x32_bf16 v[32:35], v[136:139], v[96:99], v[32:35]
    v_mfma_f32_16x16x32_bf16 v[36:39], v[140:143], v[96:99], v[36:39]
    ds_read_b128 v[132:135], v6 offset:48128
    s_waitcnt lgkmcnt(8)
    v_mfma_f32_16x16x32_bf16 v[40:43], v[136:139], v[100:103], v[40:43]
    v_mfma_f32_16x16x32_bf16 v[44:47], v[140:143], v[100:103], v[44:47]
    ds_read_b128 v[88:91], v6 offset:49152
    v_mfma_f32_16x16x32_bf16 v[48:51], v[136:139], v[104:107], v[48:51]
    v_mfma_f32_16x16x32_bf16 v[52:55], v[140:143], v[104:107], v[52:55]
    ds_read_b128 v[92:95], v6 offset:50176
    v_mfma_f32_16x16x32_bf16 v[56:59], v[136:139], v[108:111], v[56:59]
    v_mfma_f32_16x16x32_bf16 v[60:63], v[140:143], v[108:111], v[60:63]
    ds_read_b128 v[96:99], v6 offset:51200
    s_waitcnt lgkmcnt(8)
    v_mfma_f32_16x16x32_bf16 v[64:67], v[136:139], v[112:115], v[64:67]
    v_mfma_f32_16x16x32_bf16 v[68:71], v[140:143], v[112:115], v[68:71]
    ds_read_b128 v[100:103], v6 offset:52224
    v_mfma_f32_16x16x32_bf16 v[72:75], v[136:139], v[116:119], v[72:75]
    v_mfma_f32_16x16x32_bf16 v[76:79], v[140:143], v[116:119], v[76:79]
    ds_read_b128 v[104:107], v6 offset:53248
    v_mfma_f32_16x16x32_bf16 v[80:83], v[136:139], v[120:123], v[80:83]
    v_mfma_f32_16x16x32_bf16 v[84:87], v[140:143], v[120:123], v[84:87]
    ds_read_b128 v[108:111], v6 offset:54272
    s_barrier
    ds_read_b128 v[136:139], v9 offset:0
    ds_read_b128 v[140:143], v10 offset:0
    s_waitcnt lgkmcnt(8)
    v_mfma_f32_16x16x32_bf16 v[16:19], v[144:147], v[124:127], v[16:19]
    v_mfma_f32_16x16x32_bf16 v[20:23], v[148:151], v[124:127], v[20:23]
    ds_read_b128 v[112:115], v7 offset:0
    v_mfma_f32_16x16x32_bf16 v[24:27], v[144:147], v[128:131], v[24:27]
    v_mfma_f32_16x16x32_bf16 v[28:31], v[148:151], v[128:131], v[28:31]
    ds_read_b128 v[116:119], v7 offset:1024
    v_mfma_f32_16x16x32_bf16 v[32:35], v[144:147], v[132:135], v[32:35]
    v_mfma_f32_16x16x32_bf16 v[36:39], v[148:151], v[132:135], v[36:39]
    ds_read_b128 v[120:123], v7 offset:2048
    s_waitcnt lgkmcnt(8)
    v_mfma_f32_16x16x32_bf16 v[40:43], v[144:147], v[88:91], v[40:43]
    v_mfma_f32_16x16x32_bf16 v[44:47], v[148:151], v[88:91], v[44:47]
    ds_read_b128 v[124:127], v7 offset:3072
    v_mfma_f32_16x16x32_bf16 v[48:51], v[144:147], v[92:95], v[48:51]
    v_mfma_f32_16x16x32_bf16 v[52:55], v[148:151], v[92:95], v[52:55]
    ds_read_b128 v[128:131], v7 offset:4096
    v_mfma_f32_16x16x32_bf16 v[56:59], v[144:147], v[96:99], v[56:59]
    v_mfma_f32_16x16x32_bf16 v[60:63], v[148:151], v[96:99], v[60:63]
    ds_read_b128 v[132:135], v7 offset:5120
    s_waitcnt lgkmcnt(8)
    v_mfma_f32_16x16x32_bf16 v[64:67], v[144:147], v[100:103], v[64:67]
    v_mfma_f32_16x16x32_bf16 v[68:71], v[148:151], v[100:103], v[68:71]
    ds_read_b128 v[88:91], v7 offset:6144
    v_mfma_f32_16x16x32_bf16 v[72:75], v[144:147], v[104:107], v[72:75]
    v_mfma_f32_16x16x32_bf16 v[76:79], v[148:151], v[104:107], v[76:79]
    ds_read_b128 v[92:95], v7 offset:7168
    v_mfma_f32_16x16x32_bf16 v[80:83], v[144:147], v[108:111], v[80:83]
    v_mfma_f32_16x16x32_bf16 v[84:87], v[148:151], v[108:111], v[84:87]
    ds_read_b128 v[96:99], v7 offset:8192
    ds_read_b128 v[144:147], v9 offset:8192
    ds_read_b128 v[148:151], v10 offset:8192
    s_waitcnt lgkmcnt(8)
    v_mfma_f32_16x16x32_bf16 v[16:19], v[136:139], v[112:115], v[16:19]
    v_mfma_f32_16x16x32_bf16 v[20:23], v[140:143], v[112:115], v[20:23]
    ds_read_b128 v[100:103], v7 offset:9216
    v_mfma_f32_16x16x32_bf16 v[24:27], v[136:139], v[116:119], v[24:27]
    v_mfma_f32_16x16x32_bf16 v[28:31], v[140:143], v[116:119], v[28:31]
    ds_read_b128 v[104:107], v7 offset:10240
    v_mfma_f32_16x16x32_bf16 v[32:35], v[136:139], v[120:123], v[32:35]
    v_mfma_f32_16x16x32_bf16 v[36:39], v[140:143], v[120:123], v[36:39]
    ds_read_b128 v[108:111], v7 offset:11264
    s_waitcnt lgkmcnt(8)
    v_mfma_f32_16x16x32_bf16 v[40:43], v[136:139], v[124:127], v[40:43]
    v_mfma_f32_16x16x32_bf16 v[44:47], v[140:143], v[124:127], v[44:47]
    ds_read_b128 v[112:115], v7 offset:12288
    v_mfma_f32_16x16x32_bf16 v[48:51], v[136:139], v[128:131], v[48:51]
    v_mfma_f32_16x16x32_bf16 v[52:55], v[140:143], v[128:131], v[52:55]
    ds_read_b128 v[116:119], v7 offset:13312
    v_mfma_f32_16x16x32_bf16 v[56:59], v[136:139], v[132:135], v[56:59]
    v_mfma_f32_16x16x32_bf16 v[60:63], v[140:143], v[132:135], v[60:63]
    ds_read_b128 v[120:123], v7 offset:14336
    s_waitcnt lgkmcnt(8)
    v_mfma_f32_16x16x32_bf16 v[64:67], v[136:139], v[88:91], v[64:67]
    v_mfma_f32_16x16x32_bf16 v[68:71], v[140:143], v[88:91], v[68:71]
    ds_read_b128 v[124:127], v7 offset:15360
    v_mfma_f32_16x16x32_bf16 v[72:75], v[136:139], v[92:95], v[72:75]
    v_mfma_f32_16x16x32_bf16 v[76:79], v[140:143], v[92:95], v[76:79]
    ds_read_b128 v[128:131], v7 offset:16384
    v_mfma_f32_16x16x32_bf16 v[80:83], v[136:139], v[96:99], v[80:83]
    v_mfma_f32_16x16x32_bf16 v[84:87], v[140:143], v[96:99], v[84:87]
    ds_read_b128 v[132:135], v7 offset:17408
    s_barrier
    ds_read_b128 v[136:139], v9 offset:16384
    ds_read_b128 v[140:143], v10 offset:16384
    s_waitcnt lgkmcnt(8)
    v_mfma_f32_16x16x32_bf16 v[16:19], v[144:147], v[100:103], v[16:19]
    v_mfma_f32_16x16x32_bf16 v[20:23], v[148:151], v[100:103], v[20:23]
    ds_read_b128 v[88:91], v7 offset:18432
    v_mfma_f32_16x16x32_bf16 v[24:27], v[144:147], v[104:107], v[24:27]
    v_mfma_f32_16x16x32_bf16 v[28:31], v[148:151], v[104:107], v[28:31]
    ds_read_b128 v[92:95], v7 offset:19456
    v_mfma_f32_16x16x32_bf16 v[32:35], v[144:147], v[108:111], v[32:35]
    v_mfma_f32_16x16x32_bf16 v[36:39], v[148:151], v[108:111], v[36:39]
    ds_read_b128 v[96:99], v7 offset:20480
    s_waitcnt lgkmcnt(8)
    v_mfma_f32_16x16x32_bf16 v[40:43], v[144:147], v[112:115], v[40:43]
    v_mfma_f32_16x16x32_bf16 v[44:47], v[148:151], v[112:115], v[44:47]
    ds_read_b128 v[100:103], v7 offset:21504
    v_mfma_f32_16x16x32_bf16 v[48:51], v[144:147], v[116:119], v[48:51]
    v_mfma_f32_16x16x32_bf16 v[52:55], v[148:151], v[116:119], v[52:55]
    ds_read_b128 v[104:107], v7 offset:22528
    v_mfma_f32_16x16x32_bf16 v[56:59], v[144:147], v[120:123], v[56:59]
    v_mfma_f32_16x16x32_bf16 v[60:63], v[148:151], v[120:123], v[60:63]
    ds_read_b128 v[108:111], v7 offset:23552
    s_waitcnt lgkmcnt(8)
    v_mfma_f32_16x16x32_bf16 v[64:67], v[144:147], v[124:127], v[64:67]
    v_mfma_f32_16x16x32_bf16 v[68:71], v[148:151], v[124:127], v[68:71]
    ds_read_b128 v[112:115], v7 offset:24576
    v_mfma_f32_16x16x32_bf16 v[72:75], v[144:147], v[128:131], v[72:75]
    v_mfma_f32_16x16x32_bf16 v[76:79], v[148:151], v[128:131], v[76:79]
    ds_read_b128 v[116:119], v7 offset:25600
    v_mfma_f32_16x16x32_bf16 v[80:83], v[144:147], v[132:135], v[80:83]
    v_mfma_f32_16x16x32_bf16 v[84:87], v[148:151], v[132:135], v[84:87]
    ds_read_b128 v[120:123], v7 offset:26624
    ds_read_b128 v[144:147], v9 offset:24576
    ds_read_b128 v[148:151], v10 offset:24576
    s_waitcnt lgkmcnt(8)
    v_mfma_f32_16x16x32_bf16 v[16:19], v[136:139], v[88:91], v[16:19]
    v_mfma_f32_16x16x32_bf16 v[20:23], v[140:143], v[88:91], v[20:23]
    ds_read_b128 v[124:127], v7 offset:27648
    v_mfma_f32_16x16x32_bf16 v[24:27], v[136:139], v[92:95], v[24:27]
    v_mfma_f32_16x16x32_bf16 v[28:31], v[140:143], v[92:95], v[28:31]
    ds_read_b128 v[128:131], v7 offset:28672
    v_mfma_f32_16x16x32_bf16 v[32:35], v[136:139], v[96:99], v[32:35]
    v_mfma_f32_16x16x32_bf16 v[36:39], v[140:143], v[96:99], v[36:39]
    ds_read_b128 v[132:135], v7 offset:29696
    s_waitcnt lgkmcnt(8)
    v_mfma_f32_16x16x32_bf16 v[40:43], v[136:139], v[100:103], v[40:43]
    v_mfma_f32_16x16x32_bf16 v[44:47], v[140:143], v[100:103], v[44:47]
    ds_read_b128 v[88:91], v7 offset:30720
    v_mfma_f32_16x16x32_bf16 v[48:51], v[136:139], v[104:107], v[48:51]
    v_mfma_f32_16x16x32_bf16 v[52:55], v[140:143], v[104:107], v[52:55]
    ds_read_b128 v[92:95], v7 offset:31744
    v_mfma_f32_16x16x32_bf16 v[56:59], v[136:139], v[108:111], v[56:59]
    v_mfma_f32_16x16x32_bf16 v[60:63], v[140:143], v[108:111], v[60:63]
    ds_read_b128 v[96:99], v7 offset:32768
    s_waitcnt lgkmcnt(8)
    v_mfma_f32_16x16x32_bf16 v[64:67], v[136:139], v[112:115], v[64:67]
    v_mfma_f32_16x16x32_bf16 v[68:71], v[140:143], v[112:115], v[68:71]
    ds_read_b128 v[100:103], v7 offset:33792
    v_mfma_f32_16x16x32_bf16 v[72:75], v[136:139], v[116:119], v[72:75]
    v_mfma_f32_16x16x32_bf16 v[76:79], v[140:143], v[116:119], v[76:79]
    ds_read_b128 v[104:107], v7 offset:34816
    v_mfma_f32_16x16x32_bf16 v[80:83], v[136:139], v[120:123], v[80:83]
    v_mfma_f32_16x16x32_bf16 v[84:87], v[140:143], v[120:123], v[84:87]
    ds_read_b128 v[108:111], v7 offset:35840
    s_barrier
    ds_read_b128 v[136:139], v9 offset:32768
    ds_read_b128 v[140:143], v10 offset:32768
    s_waitcnt lgkmcnt(8)
    v_mfma_f32_16x16x32_bf16 v[16:19], v[144:147], v[124:127], v[16:19]
    v_mfma_f32_16x16x32_bf16 v[20:23], v[148:151], v[124:127], v[20:23]
    ds_read_b128 v[112:115], v6 offset:0
    v_mfma_f32_16x16x32_bf16 v[24:27], v[144:147], v[128:131], v[24:27]
    v_mfma_f32_16x16x32_bf16 v[28:31], v[148:151], v[128:131], v[28:31]
    ds_read_b128 v[116:119], v6 offset:1024
    v_mfma_f32_16x16x32_bf16 v[32:35], v[144:147], v[132:135], v[32:35]
    v_mfma_f32_16x16x32_bf16 v[36:39], v[148:151], v[132:135], v[36:39]
    ds_read_b128 v[120:123], v6 offset:2048
    s_waitcnt lgkmcnt(8)
    v_mfma_f32_16x16x32_bf16 v[40:43], v[144:147], v[88:91], v[40:43]
    v_mfma_f32_16x16x32_bf16 v[44:47], v[148:151], v[88:91], v[44:47]
    ds_read_b128 v[124:127], v6 offset:3072
    v_mfma_f32_16x16x32_bf16 v[48:51], v[144:147], v[92:95], v[48:51]
    v_mfma_f32_16x16x32_bf16 v[52:55], v[148:151], v[92:95], v[52:55]
    ds_read_b128 v[128:131], v6 offset:4096
    v_mfma_f32_16x16x32_bf16 v[56:59], v[144:147], v[96:99], v[56:59]
    v_mfma_f32_16x16x32_bf16 v[60:63], v[148:151], v[96:99], v[60:63]
    ds_read_b128 v[132:135], v6 offset:5120
    s_waitcnt lgkmcnt(8)
    v_mfma_f32_16x16x32_bf16 v[64:67], v[144:147], v[100:103], v[64:67]
    v_mfma_f32_16x16x32_bf16 v[68:71], v[148:151], v[100:103], v[68:71]
    ds_read_b128 v[88:91], v6 offset:6144
    v_mfma_f32_16x16x32_bf16 v[72:75], v[144:147], v[104:107], v[72:75]
    v_mfma_f32_16x16x32_bf16 v[76:79], v[148:151], v[104:107], v[76:79]
    ds_read_b128 v[92:95], v6 offset:7168
    v_mfma_f32_16x16x32_bf16 v[80:83], v[144:147], v[108:111], v[80:83]
    v_mfma_f32_16x16x32_bf16 v[84:87], v[148:151], v[108:111], v[84:87]
    ds_read_b128 v[96:99], v6 offset:8192
    ds_read_b128 v[144:147], v9 offset:40960
    ds_read_b128 v[148:151], v10 offset:40960
    s_waitcnt lgkmcnt(8)
    v_mfma_f32_16x16x32_bf16 v[16:19], v[136:139], v[112:115], v[16:19]
    v_mfma_f32_16x16x32_bf16 v[20:23], v[140:143], v[112:115], v[20:23]
    ds_read_b128 v[100:103], v6 offset:9216
    v_mfma_f32_16x16x32_bf16 v[24:27], v[136:139], v[116:119], v[24:27]
    v_mfma_f32_16x16x32_bf16 v[28:31], v[140:143], v[116:119], v[28:31]
    ds_read_b128 v[104:107], v6 offset:10240
    v_mfma_f32_16x16x32_bf16 v[32:35], v[136:139], v[120:123], v[32:35]
    v_mfma_f32_16x16x32_bf16 v[36:39], v[140:143], v[120:123], v[36:39]
    ds_read_b128 v[108:111], v6 offset:11264
    s_waitcnt lgkmcnt(8)
    v_mfma_f32_16x16x32_bf16 v[40:43], v[136:139], v[124:127], v[40:43]
    v_mfma_f32_16x16x32_bf16 v[44:47], v[140:143], v[124:127], v[44:47]
    ds_read_b128 v[112:115], v6 offset:12288
    v_mfma_f32_16x16x32_bf16 v[48:51], v[136:139], v[128:131], v[48:51]
    v_mfma_f32_16x16x32_bf16 v[52:55], v[140:143], v[128:131], v[52:55]
    ds_read_b128 v[116:119], v6 offset:13312
    v_mfma_f32_16x16x32_bf16 v[56:59], v[136:139], v[132:135], v[56:59]
    v_mfma_f32_16x16x32_bf16 v[60:63], v[140:143], v[132:135], v[60:63]
    ds_read_b128 v[120:123], v6 offset:14336
    s_waitcnt lgkmcnt(8)
    v_mfma_f32_16x16x32_bf16 v[64:67], v[136:139], v[88:91], v[64:67]
    v_mfma_f32_16x16x32_bf16 v[68:71], v[140:143], v[88:91], v[68:71]
    ds_read_b128 v[124:127], v6 offset:15360
    v_mfma_f32_16x16x32_bf16 v[72:75], v[136:139], v[92:95], v[72:75]
    v_mfma_f32_16x16x32_bf16 v[76:79], v[140:143], v[92:95], v[76:79]
    ds_read_b128 v[128:131], v6 offset:16384
    v_mfma_f32_16x16x32_bf16 v[80:83], v[136:139], v[96:99], v[80:83]
    v_mfma_f32_16x16x32_bf16 v[84:87], v[140:143], v[96:99], v[84:87]
    ds_read_b128 v[132:135], v6 offset:17408
    s_barrier
    ds_read_b128 v[136:139], v9 offset:0
    ds_read_b128 v[140:143], v10 offset:0
    s_waitcnt lgkmcnt(8)
    v_mfma_f32_16x16x32_bf16 v[16:19], v[144:147], v[100:103], v[16:19]
    v_mfma_f32_16x16x32_bf16 v[20:23], v[148:151], v[100:103], v[20:23]
    ds_read_b128 v[88:91], v6 offset:18432
    v_mfma_f32_16x16x32_bf16 v[24:27], v[144:147], v[104:107], v[24:27]
    v_mfma_f32_16x16x32_bf16 v[28:31], v[148:151], v[104:107], v[28:31]
    ds_read_b128 v[92:95], v6 offset:19456
    v_mfma_f32_16x16x32_bf16 v[32:35], v[144:147], v[108:111], v[32:35]
    v_mfma_f32_16x16x32_bf16 v[36:39], v[148:151], v[108:111], v[36:39]
    ds_read_b128 v[96:99], v6 offset:20480
    s_waitcnt lgkmcnt(8)
    v_mfma_f32_16x16x32_bf16 v[40:43], v[144:147], v[112:115], v[40:43]
    v_mfma_f32_16x16x32_bf16 v[44:47], v[148:151], v[112:115], v[44:47]
    ds_read_b128 v[100:103], v6 offset:21504
    v_mfma_f32_16x16x32_bf16 v[48:51], v[144:147], v[116:119], v[48:51]
    v_mfma_f32_16x16x32_bf16 v[52:55], v[148:151], v[116:119], v[52:55]
    ds_read_b128 v[104:107], v6 offset:22528
    v_mfma_f32_16x16x32_bf16 v[56:59], v[144:147], v[120:123], v[56:59]
    v_mfma_f32_16x16x32_bf16 v[60:63], v[148:151], v[120:123], v[60:63]
    ds_read_b128 v[108:111], v6 offset:23552
    s_waitcnt lgkmcnt(8)
    v_mfma_f32_16x16x32_bf16 v[64:67], v[144:147], v[124:127], v[64:67]
    v_mfma_f32_16x16x32_bf16 v[68:71], v[148:151], v[124:127], v[68:71]
    ds_read_b128 v[112:115], v6 offset:24576
    v_mfma_f32_16x16x32_bf16 v[72:75], v[144:147], v[128:131], v[72:75]
    v_mfma_f32_16x16x32_bf16 v[76:79], v[148:151], v[128:131], v[76:79]
    ds_read_b128 v[116:119], v6 offset:25600
    v_mfma_f32_16x16x32_bf16 v[80:83], v[144:147], v[132:135], v[80:83]
    v_mfma_f32_16x16x32_bf16 v[84:87], v[148:151], v[132:135], v[84:87]
    ds_read_b128 v[120:123], v6 offset:26624
    ds_read_b128 v[144:147], v9 offset:8192
    ds_read_b128 v[148:151], v10 offset:8192
    s_waitcnt lgkmcnt(8)
    v_mfma_f32_16x16x32_bf16 v[16:19], v[136:139], v[88:91], v[16:19]
    v_mfma_f32_16x16x32_bf16 v[20:23], v[140:143], v[88:91], v[20:23]
    ds_read_b128 v[124:127], v6 offset:27648
    v_mfma_f32_16x16x32_bf16 v[24:27], v[136:139], v[92:95], v[24:27]
    v_mfma_f32_16x16x32_bf16 v[28:31], v[140:143], v[92:95], v[28:31]
    ds_read_b128 v[128:131], v6 offset:28672
    v_mfma_f32_16x16x32_bf16 v[32:35], v[136:139], v[96:99], v[32:35]
    v_mfma_f32_16x16x32_bf16 v[36:39], v[140:143], v[96:99], v[36:39]
    ds_read_b128 v[132:135], v6 offset:29696
    s_waitcnt lgkmcnt(8)
    v_mfma_f32_16x16x32_bf16 v[40:43], v[136:139], v[100:103], v[40:43]
    v_mfma_f32_16x16x32_bf16 v[44:47], v[140:143], v[100:103], v[44:47]
    ds_read_b128 v[88:91], v6 offset:30720
    v_mfma_f32_16x16x32_bf16 v[48:51], v[136:139], v[104:107], v[48:51]
    v_mfma_f32_16x16x32_bf16 v[52:55], v[140:143], v[104:107], v[52:55]
    ds_read_b128 v[92:95], v6 offset:31744
    v_mfma_f32_16x16x32_bf16 v[56:59], v[136:139], v[108:111], v[56:59]
    v_mfma_f32_16x16x32_bf16 v[60:63], v[140:143], v[108:111], v[60:63]
    ds_read_b128 v[96:99], v6 offset:32768
    s_waitcnt lgkmcnt(8)
    v_mfma_f32_16x16x32_bf16 v[64:67], v[136:139], v[112:115], v[64:67]
    v_mfma_f32_16x16x32_bf16 v[68:71], v[140:143], v[112:115], v[68:71]
    ds_read_b128 v[100:103], v6 offset:33792
    v_mfma_f32_16x16x32_bf16 v[72:75], v[136:139], v[116:119], v[72:75]
    v_mfma_f32_16x16x32_bf16 v[76:79], v[140:143], v[116:119], v[76:79]
    ds_read_b128 v[104:107], v6 offset:34816
    v_mfma_f32_16x16x32_bf16 v[80:83], v[136:139], v[120:123], v[80:83]
    v_mfma_f32_16x16x32_bf16 v[84:87], v[140:143], v[120:123], v[84:87]
    ds_read_b128 v[108:111], v6 offset:35840
    s_barrier
    ds_read_b128 v[136:139], v9 offset:16384
    ds_read_b128 v[140:143], v10 offset:16384
    s_waitcnt lgkmcnt(8)
    v_mfma_f32_16x16x32_bf16 v[16:19], v[144:147], v[124:127], v[16:19]
    v_mfma_f32_16x16x32_bf16 v[20:23], v[148:151], v[124:127], v[20:23]
    ds_read_b128 v[112:115], v6 offset:36864
    v_mfma_f32_16x16x32_bf16 v[24:27], v[144:147], v[128:131], v[24:27]
    v_mfma_f32_16x16x32_bf16 v[28:31], v[148:151], v[128:131], v[28:31]
    ds_read_b128 v[116:119], v6 offset:37888
    v_mfma_f32_16x16x32_bf16 v[32:35], v[144:147], v[132:135], v[32:35]
    v_mfma_f32_16x16x32_bf16 v[36:39], v[148:151], v[132:135], v[36:39]
    ds_read_b128 v[120:123], v6 offset:38912
    s_waitcnt lgkmcnt(8)
    v_mfma_f32_16x16x32_bf16 v[40:43], v[144:147], v[88:91], v[40:43]
    v_mfma_f32_16x16x32_bf16 v[44:47], v[148:151], v[88:91], v[44:47]
    ds_read_b128 v[124:127], v6 offset:39936
    v_mfma_f32_16x16x32_bf16 v[48:51], v[144:147], v[92:95], v[48:51]
    v_mfma_f32_16x16x32_bf16 v[52:55], v[148:151], v[92:95], v[52:55]
    ds_read_b128 v[128:131], v6 offset:40960
    v_mfma_f32_16x16x32_bf16 v[56:59], v[144:147], v[96:99], v[56:59]
    v_mfma_f32_16x16x32_bf16 v[60:63], v[148:151], v[96:99], v[60:63]
    ds_read_b128 v[132:135], v6 offset:41984
    s_waitcnt lgkmcnt(8)
    v_mfma_f32_16x16x32_bf16 v[64:67], v[144:147], v[100:103], v[64:67]
    v_mfma_f32_16x16x32_bf16 v[68:71], v[148:151], v[100:103], v[68:71]
    ds_read_b128 v[88:91], v6 offset:43008
    v_mfma_f32_16x16x32_bf16 v[72:75], v[144:147], v[104:107], v[72:75]
    v_mfma_f32_16x16x32_bf16 v[76:79], v[148:151], v[104:107], v[76:79]
    ds_read_b128 v[92:95], v6 offset:44032
    v_mfma_f32_16x16x32_bf16 v[80:83], v[144:147], v[108:111], v[80:83]
    v_mfma_f32_16x16x32_bf16 v[84:87], v[148:151], v[108:111], v[84:87]
    ds_read_b128 v[96:99], v6 offset:45056
    ds_read_b128 v[144:147], v9 offset:24576
    ds_read_b128 v[148:151], v10 offset:24576
    s_waitcnt lgkmcnt(8)
    v_mfma_f32_16x16x32_bf16 v[16:19], v[136:139], v[112:115], v[16:19]
    v_mfma_f32_16x16x32_bf16 v[20:23], v[140:143], v[112:115], v[20:23]
    ds_read_b128 v[100:103], v6 offset:46080
    v_mfma_f32_16x16x32_bf16 v[24:27], v[136:139], v[116:119], v[24:27]
    v_mfma_f32_16x16x32_bf16 v[28:31], v[140:143], v[116:119], v[28:31]
    ds_read_b128 v[104:107], v6 offset:47104
    v_mfma_f32_16x16x32_bf16 v[32:35], v[136:139], v[120:123], v[32:35]
    v_mfma_f32_16x16x32_bf16 v[36:39], v[140:143], v[120:123], v[36:39]
    ds_read_b128 v[108:111], v6 offset:48128
    s_waitcnt lgkmcnt(8)
    v_mfma_f32_16x16x32_bf16 v[40:43], v[136:139], v[124:127], v[40:43]
    v_mfma_f32_16x16x32_bf16 v[44:47], v[140:143], v[124:127], v[44:47]
    ds_read_b128 v[112:115], v6 offset:49152
    v_mfma_f32_16x16x32_bf16 v[48:51], v[136:139], v[128:131], v[48:51]
    v_mfma_f32_16x16x32_bf16 v[52:55], v[140:143], v[128:131], v[52:55]
    ds_read_b128 v[116:119], v6 offset:50176
    v_mfma_f32_16x16x32_bf16 v[56:59], v[136:139], v[132:135], v[56:59]
    v_mfma_f32_16x16x32_bf16 v[60:63], v[140:143], v[132:135], v[60:63]
    ds_read_b128 v[120:123], v6 offset:51200
    s_waitcnt lgkmcnt(8)
    v_mfma_f32_16x16x32_bf16 v[64:67], v[136:139], v[88:91], v[64:67]
    v_mfma_f32_16x16x32_bf16 v[68:71], v[140:143], v[88:91], v[68:71]
    ds_read_b128 v[124:127], v6 offset:52224
    v_mfma_f32_16x16x32_bf16 v[72:75], v[136:139], v[92:95], v[72:75]
    v_mfma_f32_16x16x32_bf16 v[76:79], v[140:143], v[92:95], v[76:79]
    ds_read_b128 v[128:131], v6 offset:53248
    v_mfma_f32_16x16x32_bf16 v[80:83], v[136:139], v[96:99], v[80:83]
    v_mfma_f32_16x16x32_bf16 v[84:87], v[140:143], v[96:99], v[84:87]
    ds_read_b128 v[132:135], v6 offset:54272
    s_barrier
    ds_read_b128 v[136:139], v9 offset:32768
    ds_read_b128 v[140:143], v10 offset:32768
    s_waitcnt lgkmcnt(8)
    v_mfma_f32_16x16x32_bf16 v[16:19], v[144:147], v[100:103], v[16:19]
    v_mfma_f32_16x16x32_bf16 v[20:23], v[148:151], v[100:103], v[20:23]
    ds_read_b128 v[88:91], v7 offset:0
    v_mfma_f32_16x16x32_bf16 v[24:27], v[144:147], v[104:107], v[24:27]
    v_mfma_f32_16x16x32_bf16 v[28:31], v[148:151], v[104:107], v[28:31]
    ds_read_b128 v[92:95], v7 offset:1024
    v_mfma_f32_16x16x32_bf16 v[32:35], v[144:147], v[108:111], v[32:35]
    v_mfma_f32_16x16x32_bf16 v[36:39], v[148:151], v[108:111], v[36:39]
    ds_read_b128 v[96:99], v7 offset:2048
    s_waitcnt lgkmcnt(8)
    v_mfma_f32_16x16x32_bf16 v[40:43], v[144:147], v[112:115], v[40:43]
    v_mfma_f32_16x16x32_bf16 v[44:47], v[148:151], v[112:115], v[44:47]
    ds_read_b128 v[100:103], v7 offset:3072
    v_mfma_f32_16x16x32_bf16 v[48:51], v[144:147], v[116:119], v[48:51]
    v_mfma_f32_16x16x32_bf16 v[52:55], v[148:151], v[116:119], v[52:55]
    ds_read_b128 v[104:107], v7 offset:4096
    v_mfma_f32_16x16x32_bf16 v[56:59], v[144:147], v[120:123], v[56:59]
    v_mfma_f32_16x16x32_bf16 v[60:63], v[148:151], v[120:123], v[60:63]
    ds_read_b128 v[108:111], v7 offset:5120
    s_waitcnt lgkmcnt(8)
    v_mfma_f32_16x16x32_bf16 v[64:67], v[144:147], v[124:127], v[64:67]
    v_mfma_f32_16x16x32_bf16 v[68:71], v[148:151], v[124:127], v[68:71]
    ds_read_b128 v[112:115], v7 offset:6144
    v_mfma_f32_16x16x32_bf16 v[72:75], v[144:147], v[128:131], v[72:75]
    v_mfma_f32_16x16x32_bf16 v[76:79], v[148:151], v[128:131], v[76:79]
    ds_read_b128 v[116:119], v7 offset:7168
    v_mfma_f32_16x16x32_bf16 v[80:83], v[144:147], v[132:135], v[80:83]
    v_mfma_f32_16x16x32_bf16 v[84:87], v[148:151], v[132:135], v[84:87]
    ds_read_b128 v[120:123], v7 offset:8192
    ds_read_b128 v[144:147], v9 offset:40960
    ds_read_b128 v[148:151], v10 offset:40960
    s_waitcnt lgkmcnt(8)
    v_mfma_f32_16x16x32_bf16 v[16:19], v[136:139], v[88:91], v[16:19]
    v_mfma_f32_16x16x32_bf16 v[20:23], v[140:143], v[88:91], v[20:23]
    ds_read_b128 v[124:127], v7 offset:9216
    v_mfma_f32_16x16x32_bf16 v[24:27], v[136:139], v[92:95], v[24:27]
    v_mfma_f32_16x16x32_bf16 v[28:31], v[140:143], v[92:95], v[28:31]
    ds_read_b128 v[128:131], v7 offset:10240
    v_mfma_f32_16x16x32_bf16 v[32:35], v[136:139], v[96:99], v[32:35]
    v_mfma_f32_16x16x32_bf16 v[36:39], v[140:143], v[96:99], v[36:39]
    ds_read_b128 v[132:135], v7 offset:11264
    s_waitcnt lgkmcnt(8)
    v_mfma_f32_16x16x32_bf16 v[40:43], v[136:139], v[100:103], v[40:43]
    v_mfma_f32_16x16x32_bf16 v[44:47], v[140:143], v[100:103], v[44:47]
    ds_read_b128 v[88:91], v7 offset:12288
    v_mfma_f32_16x16x32_bf16 v[48:51], v[136:139], v[104:107], v[48:51]
    v_mfma_f32_16x16x32_bf16 v[52:55], v[140:143], v[104:107], v[52:55]
    ds_read_b128 v[92:95], v7 offset:13312
    v_mfma_f32_16x16x32_bf16 v[56:59], v[136:139], v[108:111], v[56:59]
    v_mfma_f32_16x16x32_bf16 v[60:63], v[140:143], v[108:111], v[60:63]
    ds_read_b128 v[96:99], v7 offset:14336
    s_waitcnt lgkmcnt(8)
    v_mfma_f32_16x16x32_bf16 v[64:67], v[136:139], v[112:115], v[64:67]
    v_mfma_f32_16x16x32_bf16 v[68:71], v[140:143], v[112:115], v[68:71]
    ds_read_b128 v[100:103], v7 offset:15360
    v_mfma_f32_16x16x32_bf16 v[72:75], v[136:139], v[116:119], v[72:75]
    v_mfma_f32_16x16x32_bf16 v[76:79], v[140:143], v[116:119], v[76:79]
    ds_read_b128 v[104:107], v7 offset:16384
    v_mfma_f32_16x16x32_bf16 v[80:83], v[136:139], v[120:123], v[80:83]
    v_mfma_f32_16x16x32_bf16 v[84:87], v[140:143], v[120:123], v[84:87]
    ds_read_b128 v[108:111], v7 offset:17408
    s_waitcnt lgkmcnt(6)
    v_mfma_f32_16x16x32_bf16 v[16:19], v[144:147], v[124:127], v[16:19]
    v_mfma_f32_16x16x32_bf16 v[20:23], v[148:151], v[124:127], v[20:23]
    v_mfma_f32_16x16x32_bf16 v[24:27], v[144:147], v[128:131], v[24:27]
    v_mfma_f32_16x16x32_bf16 v[28:31], v[148:151], v[128:131], v[28:31]
    v_mfma_f32_16x16x32_bf16 v[32:35], v[144:147], v[132:135], v[32:35]
    v_mfma_f32_16x16x32_bf16 v[36:39], v[148:151], v[132:135], v[36:39]
    s_waitcnt lgkmcnt(3)
    v_mfma_f32_16x16x32_bf16 v[40:43], v[144:147], v[88:91], v[40:43]
    v_mfma_f32_16x16x32_bf16 v[44:47], v[148:151], v[88:91], v[44:47]
    v_mfma_f32_16x16x32_bf16 v[48:51], v[144:147], v[92:95], v[48:51]
    v_mfma_f32_16x16x32_bf16 v[52:55], v[148:151], v[92:95], v[52:55]
    v_mfma_f32_16x16x32_bf16 v[56:59], v[144:147], v[96:99], v[56:59]
    v_mfma_f32_16x16x32_bf16 v[60:63], v[148:151], v[96:99], v[60:63]
    s_waitcnt lgkmcnt(0)
    v_mfma_f32_16x16x32_bf16 v[64:67], v[144:147], v[100:103], v[64:67]
    v_mfma_f32_16x16x32_bf16 v[68:71], v[148:151], v[100:103], v[68:71]
    v_mfma_f32_16x16x32_bf16 v[72:75], v[144:147], v[104:107], v[72:75]
    v_mfma_f32_16x16x32_bf16 v[76:79], v[148:151], v[104:107], v[76:79]
    v_mfma_f32_16x16x32_bf16 v[80:83], v[144:147], v[108:111], v[80:83]
    v_mfma_f32_16x16x32_bf16 v[84:87], v[148:151], v[108:111], v[84:87]
    s_barrier
    v_and_b32 v10, 15, v1
    v_lshrrev_b32 v13, 4, v1
    s_mov_b32 s26, s34
    s_add_u32 s16, s4, 20443136
    s_addc_u32 s17, s5, 0
    s_mov_b32 s18, 4718592
    s_mov_b32 s19, 0x00020000
    s_and_b32 s30, s22, 3
    s_lshl_b32 s30, s30, 3
    s_lshl_b32 s31, s30, 6
    s_add_u32 s31, s31, s26
    s_mul_i32 s31, s31, 2304
    v_mul_u32_u24 v14, 18, v13
    v_add_u32 v15, v14, v10
    v_lshlrev_b32 v15, 4, v15
    v_cvt_pk_bf16_f32 v88, v16, v17
    v_cvt_pk_bf16_f32 v89, v18, v19
    v_cvt_pk_bf16_f32 v90, v20, v21
    v_cvt_pk_bf16_f32 v91, v22, v23
    s_add_u32 s32, s31, 0
    buffer_store_dwordx4 v[88:91], v15, s[16:19], s32 offen offset:1152 sc1
    v_cvt_pk_bf16_f32 v92, v24, v25
    v_cvt_pk_bf16_f32 v93, v26, v27
    v_cvt_pk_bf16_f32 v94, v28, v29
    v_cvt_pk_bf16_f32 v95, v30, v31
    s_add_u32 s32, s31, 147456
    buffer_store_dwordx4 v[92:95], v15, s[16:19], s32 offen offset:1152 sc1
    v_cvt_pk_bf16_f32 v96, v32, v33
    v_cvt_pk_bf16_f32 v97, v34, v35
    v_cvt_pk_bf16_f32 v98, v36, v37
    v_cvt_pk_bf16_f32 v99, v38, v39
    s_add_u32 s32, s31, 294912
    buffer_store_dwordx4 v[96:99], v15, s[16:19], s32 offen offset:1152 sc1
    v_cvt_pk_bf16_f32 v100, v40, v41
    v_cvt_pk_bf16_f32 v101, v42, v43
    v_cvt_pk_bf16_f32 v102, v44, v45
    v_cvt_pk_bf16_f32 v103, v46, v47
    s_add_u32 s32, s31, 442368
    buffer_store_dwordx4 v[100:103], v15, s[16:19], s32 offen offset:1152 sc1
    v_cvt_pk_bf16_f32 v104, v48, v49
    v_cvt_pk_bf16_f32 v105, v50, v51
    v_cvt_pk_bf16_f32 v106, v52, v53
    v_cvt_pk_bf16_f32 v107, v54, v55
    s_add_u32 s32, s31, 589824
    buffer_store_dwordx4 v[104:107], v15, s[16:19], s32 offen offset:1152 sc1
    v_cvt_pk_bf16_f32 v108, v56, v57
    v_cvt_pk_bf16_f32 v109, v58, v59
    v_cvt_pk_bf16_f32 v110, v60, v61
    v_cvt_pk_bf16_f32 v111, v62, v63
    s_add_u32 s32, s31, 737280
    buffer_store_dwordx4 v[108:111], v15, s[16:19], s32 offen offset:1152 sc1
    v_cvt_pk_bf16_f32 v88, v64, v65
    v_cvt_pk_bf16_f32 v89, v66, v67
    v_cvt_pk_bf16_f32 v90, v68, v69
    v_cvt_pk_bf16_f32 v91, v70, v71
    s_add_u32 s32, s31, 884736
    buffer_store_dwordx4 v[88:91], v15, s[16:19], s32 offen offset:1152 sc1
    v_cvt_pk_bf16_f32 v92, v72, v73
    v_cvt_pk_bf16_f32 v93, v74, v75
    v_cvt_pk_bf16_f32 v94, v76, v77
    v_cvt_pk_bf16_f32 v95, v78, v79
    s_add_u32 s32, s31, 1032192
    buffer_store_dwordx4 v[92:95], v15, s[16:19], s32 offen offset:1152 sc1
    v_cvt_pk_bf16_f32 v96, v80, v81
    v_cvt_pk_bf16_f32 v97, v82, v83
    v_cvt_pk_bf16_f32 v98, v84, v85
    v_cvt_pk_bf16_f32 v99, v86, v87
    v_lshrrev_b32 v9, 1, v10
    s_mov_b32 s32, 147456
    v_mul_lo_u32 v9, v9, s32
    v_and_b32 v11, 1, v10
    v_add_u32 v11, v11, v14
    v_add_u32 v11, 16, v11
    v_lshl_add_u32 v9, v11, 4, v9
    buffer_store_dwordx4 v[96:99], v9, s[16:19], s31 offen offset:1152
    s_endpgm
K1_PREP:
    s_sub_u32 s3, s2, 192
K1P_FIN:
    v_readfirstlane_b32 s70, v0
    s_nop 0
    s_cmp_ge_u32 s70, 256
    s_cbranch_scc1 K1P_X
    s_waitcnt lgkmcnt(0)
    s_mov_b32 s12, s4
    s_mov_b32 s13, s5
    s_mov_b32 s14, 27648
    s_mov_b32 s15, 0x00020000
    s_add_u32 s16, s4, 28672
    s_addc_u32 s17, s5, 0
    s_mov_b32 s18, 13824
    s_mov_b32 s19, 0x00020000
    s_add_u32 s24, s4, 45056
    s_addc_u32 s25, s5, 0
    s_mov_b32 s26, 2304
    s_mov_b32 s27, 0x00020000
    v_lshlrev_b32 v1, 2, v0
    s_add_u32 s28, s4, 51245056
    s_addc_u32 s29, s5, 0
    s_mov_b32 s30, 18432
    s_mov_b32 s31, 0x00020000
    v_lshlrev_b32 v2, 8, v0
    v_mov_b32 v3, 0
    buffer_store_dword v3, v2, s[28:31], 0 offen
    s_mov_b32 s70, 0
    buffer_load_dword v20, v1, s[12:15], s70 offen
    s_mov_b32 s71, 13824
    buffer_load_dword v40, v1, s[12:15], s71 offen
    s_mov_b32 s70, 1024
    buffer_load_dword v21, v1, s[12:15], s70 offen
    s_mov_b32 s71, 14848
    buffer_load_dword v41, v1, s[12:15], s71 offen
    s_mov_b32 s70, 2048
    buffer_load_dword v22, v1, s[12:15], s70 offen
    s_mov_b32 s71, 15872
    buffer_load_dword v42, v1, s[12:15], s71 offen
    s_mov_b32 s70, 3072
    buffer_load_dword v23, v1, s[12:15], s70 offen
    s_mov_b32 s71, 16896
    buffer_load_dword v43, v1, s[12:15], s71 offen
    s_mov_b32 s70, 4096
    buffer_load_dword v24, v1, s[12:15], s70 offen
    s_mov_b32 s71, 17920
    buffer_load_dword v44, v1, s[12:15], s71 offen
    s_mov_b32 s70, 5120
    buffer_load_dword v25, v1, s[12:15], s70 offen
    s_mov_b32 s71, 18944
    buffer_load_dword v45, v1, s[12:15], s71 offen
    s_mov_b32 s70, 6144
    buffer_load_dword v26, v1, s[12:15], s70 offen
    s_mov_b32 s71, 19968
    buffer_load_dword v46, v1, s[12:15], s71 offen
    s_mov_b32 s70, 7168
    buffer_load_dword v27, v1, s[12:15], s70 offen
    s_mov_b32 s71, 20992
    buffer_load_dword v47, v1, s[12:15], s71 offen
    s_mov_b32 s70, 8192
    buffer_load_dword v28, v1, s[12:15], s70 offen
    s_mov_b32 s71, 22016
    buffer_load_dword v48, v1, s[12:15], s71 offen
    s_mov_b32 s70, 9216
    buffer_load_dword v29, v1, s[12:15], s70 offen
    s_mov_b32 s71, 23040
    buffer_load_dword v49, v1, s[12:15], s71 offen
    s_mov_b32 s70, 10240
    buffer_load_dword v30, v1, s[12:15], s70 offen
    s_mov_b32 s71, 24064
    buffer_load_dword v50, v1, s[12:15], s71 offen
    s_mov_b32 s70, 11264
    buffer_load_dword v31, v1, s[12:15], s70 offen
    s_mov_b32 s71, 25088
    buffer_load_dword v51, v1, s[12:15], s71 offen
    s_mov_b32 s70, 12288
    buffer_load_dword v32, v1, s[12:15], s70 offen
    s_mov_b32 s71, 26112
    buffer_load_dword v52, v1, s[12:15], s71 offen
    s_mov_b32 s70, 13312
    buffer_load_dword v33, v1, s[12:15], s70 offen
    s_mov_b32 s71, 27136
    buffer_load_dword v53, v1, s[12:15], s71 offen
    s_waitcnt vmcnt(0)
    v_add_f32 v20, v20, v40
    v_cvt_pk_bf16_f32 v20, v20, v20
    v_lshlrev_b32 v20, 16, v20
    s_mov_b32 s70, 0
    buffer_store_dword v20, v1, s[16:19], s70 offen
    v_add_f32 v21, v21, v41
    v_cvt_pk_bf16_f32 v21, v21, v21
    v_lshlrev_b32 v21, 16, v21
    s_mov_b32 s70, 1024
    buffer_store_dword v21, v1, s[16:19], s70 offen
    v_add_f32 v22, v22, v42
    v_cvt_pk_bf16_f32 v22, v22, v22
    v_lshlrev_b32 v22, 16, v22
    s_mov_b32 s70, 2048
    buffer_store_dword v22, v1, s[16:19], s70 offen
    v_add_f32 v23, v23, v43
    v_cvt_pk_bf16_f32 v23, v23, v23
    v_lshlrev_b32 v23, 16, v23
    s_mov_b32 s70, 3072
    buffer_store_dword v23, v1, s[16:19], s70 offen
    v_add_f32 v24, v24, v44
    v_cvt_pk_bf16_f32 v24, v24, v24
    v_lshlrev_b32 v24, 16, v24
    s_mov_b32 s70, 4096
    buffer_store_dword v24, v1, s[16:19], s70 offen
    v_add_f32 v25, v25, v45
    v_cvt_pk_bf16_f32 v25, v25, v25
    v_lshlrev_b32 v25, 16, v25
    s_mov_b32 s70, 5120
    buffer_store_dword v25, v1, s[16:19], s70 offen
    v_add_f32 v26, v26, v46
    v_cvt_pk_bf16_f32 v26, v26, v26
    v_lshlrev_b32 v26, 16, v26
    s_mov_b32 s70, 6144
    buffer_store_dword v26, v1, s[16:19], s70 offen
    v_add_f32 v27, v27, v47
    v_cvt_pk_bf16_f32 v27, v27, v27
    v_lshlrev_b32 v27, 16, v27
    s_mov_b32 s70, 7168
    buffer_store_dword v27, v1, s[16:19], s70 offen
    v_add_f32 v28, v28, v48
    v_cvt_pk_bf16_f32 v28, v28, v28
    v_lshlrev_b32 v28, 16, v28
    s_mov_b32 s70, 8192
    buffer_store_dword v28, v1, s[16:19], s70 offen
    v_add_f32 v29, v29, v49
    v_cvt_pk_bf16_f32 v29, v29, v29
    v_lshlrev_b32 v29, 16, v29
    s_mov_b32 s70, 9216
    buffer_store_dword v29, v1, s[16:19], s70 offen
    v_add_f32 v30, v30, v50
    v_cvt_pk_bf16_f32 v30, v30, v30
    v_lshlrev_b32 v30, 16, v30
    s_mov_b32 s70, 10240
    buffer_store_dword v30, v1, s[16:19], s70 offen
    v_add_f32 v31, v31, v51
    v_cvt_pk_bf16_f32 v31, v31, v31
    v_lshlrev_b32 v31, 16, v31
    s_mov_b32 s70, 11264
    buffer_store_dword v31, v1, s[16:19], s70 offen
    v_add_f32 v32, v32, v52
    v_cvt_pk_bf16_f32 v32, v32, v32
    v_lshlrev_b32 v32, 16, v32
    s_mov_b32 s70, 12288
    buffer_store_dword v32, v1, s[16:19], s70 offen
    v_add_f32 v33, v33, v53
    v_cvt_pk_bf16_f32 v33, v33, v33
    v_lshlrev_b32 v33, 16, v33
    s_mov_b32 s70, 13312
    buffer_store_dword v33, v1, s[16:19], s70 offen
    s_add_u32 s32, s4, 51224576
    s_addc_u32 s33, s5, 0
    s_mov_b32 s34, 18432
    s_mov_b32 s35, 0x00020000
    v_mov_b32 v64, 0
    v_mov_b32 v65, 0
    v_mov_b32 v66, 0
    v_mov_b32 v67, 0
    v_lshlrev_b32 v4, 4, v0
    s_mov_b32 s70, 0
    buffer_store_dwordx4 v[64:67], v4, s[32:35], s70 offen
    s_mov_b32 s70, 4096
    buffer_store_dwordx4 v[64:67], v4, s[32:35], s70 offen
    s_mov_b32 s70, 8192
    buffer_store_dwordx4 v[64:67], v4, s[32:35], s70 offen
    s_mov_b32 s70, 12288
    buffer_store_dwordx4 v[64:67], v4, s[32:35], s70 offen
    s_mov_b32 s70, 16384
    buffer_store_dwordx4 v[64:67], v4, s[32:35], s70 offen
    s_waitcnt vmcnt(0)
    s_barrier
    s_mov_b32 s70, 9216
    buffer_load_dword v62, v1, s[12:15], s70 offen
    s_mov_b32 s70, 23040
    buffer_load_dword v63, v1, s[12:15], s70 offen
    s_mov_b32 s70, 6912
    buffer_load_dword v60, v1, s[12:15], s70 offen
    s_mov_b32 s70, 20736
    buffer_load_dword v61, v1, s[12:15], s70 offen
    s_waitcnt vmcnt(0)
    v_add_f32 v62, v62, v63
    v_cvt_pk_bf16_f32 v62, v62, v62
    v_lshlrev_b32 v62, 16, v62
    v_add_f32 v62, 1.0, v62
    v_cvt_pk_bf16_f32 v62, v62, v62
    v_lshlrev_b32 v62, 16, v62
    v_add_f32 v60, v60, v61
    v_cvt_pk_bf16_f32 v60, v60, v60
    v_lshlrev_b32 v60, 16, v60
    s_mov_b32 s70, 0
    buffer_store_dword v62, v1, s[24:27], s70 offen
    v_add_u32 v3, 0, v0
    v_lshrrev_b32 v4, 5, v3
    v_lshlrev_b32 v4, 2, v4
    v_bfe_u32 v5, v3, 2, 2
    v_add_u32 v4, v4, v5
    v_lshlrev_b32 v4, 8, v4
    v_bfe_u32 v5, v3, 4, 1
    v_lshl_add_u32 v4, v5, 3, v4
    v_and_b32 v5, 3, v3
    v_lshl_add_u32 v4, v5, 1, v4
    s_movk_i32 s70, 576
    v_cmp_gt_u32 vcc, s70, v3
    s_nop 0
    s_and_saveexec_b64 s[62:63], vcc
    buffer_store_short_d16_hi v62, v4, s[32:35], 0 offen
    buffer_store_short_d16_hi v60, v4, s[32:35], 0 offen offset:16
    s_mov_b64 exec, s[62:63]
    s_mov_b32 s70, 10240
    buffer_load_dword v62, v1, s[12:15], s70 offen
    s_mov_b32 s70, 24064
    buffer_load_dword v63, v1, s[12:15], s70 offen
    s_mov_b32 s70, 7936
    buffer_load_dword v60, v1, s[12:15], s70 offen
    s_mov_b32 s70, 21760
    buffer_load_dword v61, v1, s[12:15], s70 offen
    s_waitcnt vmcnt(0)
    v_add_f32 v62, v62, v63
    v_cvt_pk_bf16_f32 v62, v62, v62
    v_lshlrev_b32 v62, 16, v62
    v_add_f32 v62, 1.0, v62
    v_cvt_pk_bf16_f32 v62, v62, v62
    v_lshlrev_b32 v62, 16, v62
    v_add_f32 v60, v60, v61
    v_cvt_pk_bf16_f32 v60, v60, v60
    v_lshlrev_b32 v60, 16, v60
    s_mov_b32 s70, 1024
    buffer_store_dword v62, v1, s[24:27], s70 offen
    v_add_u32 v3, 256, v0
    v_lshrrev_b32 v4, 5, v3
    v_lshlrev_b32 v4, 2, v4
    v_bfe_u32 v5, v3, 2, 2
    v_add_u32 v4, v4, v5
    v_lshlrev_b32 v4, 8, v4
    v_bfe_u32 v5, v3, 4, 1
    v_lshl_add_u32 v4, v5, 3, v4
    v_and_b32 v5, 3, v3
    v_lshl_add_u32 v4, v5, 1, v4
    s_movk_i32 s70, 576
    v_cmp_gt_u32 vcc, s70, v3
    s_nop 0
    s_and_saveexec_b64 s[62:63], vcc
    buffer_store_short_d16_hi v62, v4, s[32:35], 0 offen
    buffer_store_short_d16_hi v60, v4, s[32:35], 0 offen offset:16
    s_mov_b64 exec, s[62:63]
    s_mov_b32 s70, 11264
    buffer_load_dword v62, v1, s[12:15], s70 offen
    s_mov_b32 s70, 25088
    buffer_load_dword v63, v1, s[12:15], s70 offen
    s_mov_b32 s70, 8960
    buffer_load_dword v60, v1, s[12:15], s70 offen
    s_mov_b32 s70, 22784
    buffer_load_dword v61, v1, s[12:15], s70 offen
    s_waitcnt vmcnt(0)
    v_add_f32 v62, v62, v63
    v_cvt_pk_bf16_f32 v62, v62, v62
    v_lshlrev_b32 v62, 16, v62
    v_add_f32 v62, 1.0, v62
    v_cvt_pk_bf16_f32 v62, v62, v62
    v_lshlrev_b32 v62, 16, v62
    v_add_f32 v60, v60, v61
    v_cvt_pk_bf16_f32 v60, v60, v60
    v_lshlrev_b32 v60, 16, v60
    s_mov_b32 s70, 2048
    buffer_store_dword v62, v1, s[24:27], s70 offen
    v_add_u32 v3, 512, v0
    v_lshrrev_b32 v4, 5, v3
    v_lshlrev_b32 v4, 2, v4
    v_bfe_u32 v5, v3, 2, 2
    v_add_u32 v4, v4, v5
    v_lshlrev_b32 v4, 8, v4
    v_bfe_u32 v5, v3, 4, 1
    v_lshl_add_u32 v4, v5, 3, v4
    v_and_b32 v5, 3, v3
    v_lshl_add_u32 v4, v5, 1, v4
    s_movk_i32 s70, 576
    v_cmp_gt_u32 vcc, s70, v3
    s_nop 0
    s_and_saveexec_b64 s[62:63], vcc
    buffer_store_short_d16_hi v62, v4, s[32:35], 0 offen
    buffer_store_short_d16_hi v60, v4, s[32:35], 0 offen offset:16
    s_mov_b64 exec, s[62:63]
    s_endpgm
K1P_X:
K1_END:
    s_endpgm

.text
.globl k2_kernel
.p2align 8
.type k2_kernel,@function
k2_kernel:
    s_cmp_ge_u32 s2, 256
    s_cbranch_scc1 K2_END
    s_load_dwordx2 s[4:5], s[0:1], 80
    s_load_dwordx2 s[46:47], s[0:1], 32
    s_load_dwordx2 s[48:49], s[0:1], 40
    s_load_dwordx2 s[50:51], s[0:1], 16
    v_lshrrev_b32 v1, 6, v0
    s_nop 0
    v_readfirstlane_b32 s20, v1
    v_and_b32 v1, 63, v0
    s_and_b32 s21, s2, 7
    s_lshl_b32 s21, s21, 2
    s_bfe_u32 s22, s2, 0x20003
    s_add_u32 s21, s21, s22
    s_lshr_b32 s22, s2, 5
    s_and_b32 s23, s20, 7
    s_lshr_b32 s24, s20, 3
    s_lshl_b32 s25, s22, 3
    s_add_u32 s25, s25, s23
    s_mov_b32 s40, 0
    v_lshlrev_b32 v5, 4, v1
    v_and_b32 v6, 31, v1
    v_lshlrev_b32 v7, 2, v6
    v_lshlrev_b32 v8, 2, v1
    s_mul_i32 s44, s24, 72
    s_add_u32 s44, s44, s23
    s_lshl_b32 s44, s44, 10
    s_waitcnt lgkmcnt(0)
    s_mul_i32 s26, s21, 147456
    s_add_u32 s8, s4, s26
    s_addc_u32 s9, s5, 0
    s_add_u32 s8, s8, 20443136
    s_addc_u32 s9, s9, 0
    s_mov_b32 s10, 147456
    s_mov_b32 s11, 0x00020000
    s_add_u32 s12, s4, 18083840
    s_addc_u32 s13, s5, 0
    s_mov_b32 s14, 2359296
    s_mov_b32 s15, 0x00020000
    s_add_u32 s16, s4, 25161728
    s_addc_u32 s17, s5, 0
    s_mov_b32 s18, 8192
    s_mov_b32 s19, 0x00020000
    s_lshl_b32 s26, s21, 6
    s_add_u32 s26, s26, s25
    s_mul_i32 s26, s26, 1152
    buffer_load_dwordx4 v[88:91], v5, s[12:15], s26 offen
    buffer_load_dword v92, v7, s[12:15], s26 offen offset:1024
    s_lshl_b32 s26, s21, 8
    buffer_load_dword v9, v8, s[16:19], s26 offen
K2_RESTART:
    s_add_u32 s26, s44, 0
    s_mov_b32 m0, s26
    s_nop 0
    buffer_load_dwordx4 v5, s[8:11], s26 offen lds
    s_add_u32 s26, s44, 8192
    s_mov_b32 m0, s26
    s_nop 0
    buffer_load_dwordx4 v5, s[8:11], s26 offen lds
K2_SKIPQ0:
    s_mul_i32 s27, s24, 73728
    v_add_u32 v2, s27, v5
    v_add_u32 v3, s27, v7
    v_min_u32 v4, 17, v6
    v_lshrrev_b32 v10, 5, v1
    v_mul_u32_u24 v11, 18, v10
    v_add_u32 v4, v4, v11
    v_lshlrev_b32 v4, 4, v4
    v_add_u32 v4, s27, v4
    v_mov_b32 v48, 0
    v_mov_b32 v49, 0
    v_mov_b32 v50, 0
    v_mov_b32 v51, 0
    v_mov_b32 v52, 0
    v_mov_b32 v53, 0
    v_mov_b32 v54, 0
    v_mov_b32 v55, 0
    v_mov_b32 v56, 0
    v_mov_b32 v57, 0
    v_mov_b32 v58, 0
    v_mov_b32 v59, 0
    v_mov_b32 v60, 0
    v_mov_b32 v61, 0
    v_mov_b32 v62, 0
    v_mov_b32 v63, 0
    v_cmp_eq_u32 vcc, 18, v6
    v_mov_b32 v12, 0x3f803f80
    s_nop 0
    v_cndmask_b32 v12, 0, v12, vcc
    v_mov_b32 v112, v12
    v_mov_b32 v113, v12
    v_mov_b32 v114, v12
    v_mov_b32 v115, v12
    v_mov_b32 v116, v12
    v_mov_b32 v117, v12
    v_mov_b32 v118, v12
    v_mov_b32 v119, v12
    v_mov_b32 v120, v12
    v_mov_b32 v121, v12
    v_mov_b32 v122, v12
    v_mov_b32 v123, v12
    v_mov_b32 v124, v12
    v_mov_b32 v125, v12
    v_mov_b32 v126, v12
    v_mov_b32 v127, v12
    s_mov_b32 s42, 0x3ffff
    s_mov_b32 s43, 0x3ffff
    s_cmp_lg_u32 s40, 0
    s_cbranch_scc1 K2_SKIPQ
    v_mov_b32 v93, 0
    v_mov_b32 v94, 0
    v_mov_b32 v95, 0
    v_mov_b32 v105, 0
    v_mov_b32 v106, 0
    v_mov_b32 v107, 0
    v_mov_b32 v109, 0
    v_mov_b32 v110, 0
    v_mov_b32 v111, 0
    s_waitcnt vmcnt(2)
    v_cmp_eq_u32 vcc, 0, v10
    s_nop 1
    v_cndmask_b32 v92, 0, v92, vcc
    v_mov_b32 v12, 0
    v_lshlrev_b32 v13, 16, v88
    v_fmac_f32 v12, v13, v13
    v_and_b32 v13, 0xffff0000, v88
    v_fmac_f32 v12, v13, v13
    v_lshlrev_b32 v13, 16, v89
    v_fmac_f32 v12, v13, v13
    v_and_b32 v13, 0xffff0000, v89
    v_fmac_f32 v12, v13, v13
    v_lshlrev_b32 v13, 16, v90
    v_fmac_f32 v12, v13, v13
    v_and_b32 v13, 0xffff0000, v90
    v_fmac_f32 v12, v13, v13
    v_lshlrev_b32 v13, 16, v91
    v_fmac_f32 v12, v13, v13
    v_and_b32 v13, 0xffff0000, v91
    v_fmac_f32 v12, v13, v13
    v_lshlrev_b32 v13, 16, v92
    v_fmac_f32 v12, v13, v13
    v_and_b32 v13, 0xffff0000, v92
    v_fmac_f32 v12, v13, v13
    v_mov_b32 v13, v12
    s_nop 1
    v_permlane32_swap_b32 v12, v13
    v_add_f32 v12, v12, v13
    v_max_f32_dpp v9, v9, v9 quad_perm:[1,0,3,2] row_mask:0xf bank_mask:0xf
    s_nop 1
    v_max_f32_dpp v9, v9, v9 quad_perm:[2,3,0,1] row_mask:0xf bank_mask:0xf
    s_nop 1
    v_max_f32_dpp v9, v9, v9 row_half_mirror row_mask:0xf bank_mask:0xf
    s_nop 1
    v_max_f32_dpp v9, v9, v9 row_mirror row_mask:0xf bank_mask:0xf
    v_mov_b32 v13, v9
    s_nop 1
    v_permlane16_swap_b32 v9, v13
    v_max_f32 v9, v9, v13
    v_mov_b32 v13, v9
    s_nop 1
    v_permlane32_swap_b32 v9, v13
    v_max_f32 v9, v9, v13
    v_mul_f32 v12, v12, v9
    v_sqrt_f32 v12, v12
    s_nop 0
    v_mul_f32 v12, 0xbf820000, v12
    v_mov_b32 v64, v12
    v_mov_b32 v65, v12
    v_mov_b32 v66, v12
    v_mov_b32 v67, v12
    v_mov_b32 v68, v12
    v_mov_b32 v69, v12
    v_mov_b32 v70, v12
    v_mov_b32 v71, v12
    v_mov_b32 v72, v12
    v_mov_b32 v73, v12
    v_mov_b32 v74, v12
    v_mov_b32 v75, v12
    v_mov_b32 v76, v12
    v_mov_b32 v77, v12
    v_mov_b32 v78, v12
    v_mov_b32 v79, v12
K2_SKIPQ:
    s_cmp_eq_u32 s40, 0
    s_cbranch_scc1 K2_MAIN
    s_add_u32 s26, s44, 16384
    s_mov_b32 m0, s26
    s_nop 0
    buffer_load_dwordx4 v5, s[8:11], s26 offen lds
    s_add_u32 s26, s44, 24576
    s_mov_b32 m0, s26
    s_nop 0
    buffer_load_dwordx4 v5, s[8:11], s26 offen lds
    s_add_u32 s26, s44, 32768
    s_mov_b32 m0, s26
    s_nop 0
    buffer_load_dwordx4 v5, s[8:11], s26 offen lds
    s_add_u32 s26, s44, 40960
    s_mov_b32 m0, s26
    s_nop 0
    buffer_load_dwordx4 v5, s[8:11], s26 offen lds
    s_add_u32 s26, s44, 49152
    s_mov_b32 m0, s26
    s_nop 0
    buffer_load_dwordx4 v5, s[8:11], s26 offen lds
    s_add_u32 s26, s44, 57344
    s_mov_b32 m0, s26
    s_nop 0
    buffer_load_dwordx4 v5, s[8:11], s26 offen lds
    s_add_u32 s26, s44, 65536
    s_mov_b32 m0, s26
    s_nop 0
    buffer_load_dwordx4 v5, s[8:11], s26 offen lds
    s_waitcnt vmcnt(0) lgkmcnt(0)
    s_barrier
    v_mov_b32 v12, 0xff800000
    v_mov_b32 v14, v2
    v_mov_b32 v15, v3
    s_mov_b32 s28, 32
K2_MAXLOOP:
    ds_read_b128 v[96:99], v14
    ds_read_b32 v104, v15 offset:1024
    s_waitcnt lgkmcnt(0)
    v_mfma_f32_32x32x16_bf16 v[16:31], v[96:99], v[88:91], 0
    v_mfma_f32_32x32x8_bf16 v[16:31], v[104:105], v[92:93], v[16:31]
    s_nop 11
    v_max3_f32 v12, v12, v16, v17
    v_max3_f32 v12, v12, v18, v19
    v_max3_f32 v12, v12, v20, v21
    v_max3_f32 v12, v12, v22, v23
    v_max3_f32 v12, v12, v24, v25
    v_max3_f32 v12, v12, v26, v27
    v_max3_f32 v12, v12, v28, v29
    v_max3_f32 v12, v12, v30, v31
    v_add_u32 v14, 2304, v14
    v_add_u32 v15, 2304, v15
    s_sub_u32 s28, s28, 1
    s_cmp_lg_u32 s28, 0
    s_cbranch_scc1 K2_MAXLOOP
    v_mov_b32 v13, v12
    s_nop 1
    v_permlane32_swap_b32 v12, v13
    v_max_f32 v12, v12, v13
    s_lshl_b32 s28, s20, 8
    s_add_u32 s28, s28, 147456
    v_add_u32 v14, s28, v8
    ds_write_b32 v14, v12
    s_waitcnt lgkmcnt(0)
    s_barrier
    s_xor_b32 s28, s20, 8
    s_lshl_b32 s28, s28, 8
    s_add_u32 s28, s28, 147456
    v_add_u32 v14, s28, v8
    ds_read_b32 v13, v14
    s_waitcnt lgkmcnt(0)
    v_max_f32 v12, v12, v13
    v_sub_f32 v12, 0, v12
    v_mov_b32 v64, v12
    v_mov_b32 v65, v12
    v_mov_b32 v66, v12
    v_mov_b32 v67, v12
    v_mov_b32 v68, v12
    v_mov_b32 v69, v12
    v_mov_b32 v70, v12
    v_mov_b32 v71, v12
    v_mov_b32 v72, v12
    v_mov_b32 v73, v12
    v_mov_b32 v74, v12
    v_mov_b32 v75, v12
    v_mov_b32 v76, v12
    v_mov_b32 v77, v12
    v_mov_b32 v78, v12
    v_mov_b32 v79, v12
K2_MAIN:
    s_waitcnt vmcnt(0) lgkmcnt(0)
    s_barrier
    ds_read_b128 v[96:99], v2 offset:0
    ds_read_b32 v104, v3 offset:1024
    ds_read_b128 v[100:103], v2 offset:2304
    ds_read_b32 v108, v3 offset:3328
    s_mov_b64 exec, s[42:43]
    ds_read_b128 v[112:115], v4 offset:1152
    ds_read_b128 v[116:119], v4 offset:1728
    s_mov_b64 exec, -1
    v_mov_b32 v84, 0
    v_mov_b32 v85, 0
    v_mov_b32 v86, 0
    v_mov_b32 v87, 0
    s_waitcnt lgkmcnt(0)
    v_mfma_f32_32x32x16_bf16 v[16:31], v[96:99], v[88:91], v[64:79]
    v_mfma_f32_32x32x8_bf16 v[16:31], v[104:105], v[92:93], v[16:31]
    s_setprio 3
    s_waitcnt lgkmcnt(0)
    v_mfma_f32_32x32x16_bf16 v[32:47], v[100:103], v[88:91], v[64:79]
    v_mfma_f32_32x32x16_bf16 v[48:63], v[124:127], v[84:87], v[48:63]
    s_nop 7
    v_exp_f32 v16, v16
    v_exp_f32 v17, v17
    v_exp_f32 v18, v18
    v_exp_f32 v19, v19
    v_exp_f32 v20, v20
    v_exp_f32 v21, v21
    v_exp_f32 v22, v22
    v_exp_f32 v23, v23
    v_mfma_f32_32x32x8_bf16 v[32:47], v[108:109], v[92:93], v[32:47]
    ds_read_b128 v[96:99], v2 offset:4608
    ds_read_b32 v104, v3 offset:5632
    s_mov_b64 exec, s[42:43]
    ds_read_b128 v[120:123], v4 offset:3456
    ds_read_b128 v[124:127], v4 offset:4032
    s_mov_b64 exec, -1
    s_add_u32 s26, s44, 16384
    s_mov_b32 m0, s26
    s_nop 0
    buffer_load_dwordx4 v5, s[8:11], s26 offen lds
    s_add_u32 s26, s44, 24576
    s_mov_b32 m0, s26
    s_nop 0
    buffer_load_dwordx4 v5, s[8:11], s26 offen lds
    v_cvt_pk_bf16_f32 v80, v16, v17
    v_cvt_pk_bf16_f32 v81, v18, v19
    v_cvt_pk_bf16_f32 v82, v20, v21
    v_cvt_pk_bf16_f32 v83, v22, v23
    v_exp_f32 v24, v24
    v_exp_f32 v25, v25
    v_exp_f32 v26, v26
    v_exp_f32 v27, v27
    v_exp_f32 v28, v28
    v_exp_f32 v29, v29
    v_exp_f32 v30, v30
    v_exp_f32 v31, v31
    v_mfma_f32_32x32x16_bf16 v[48:63], v[112:115], v[80:83], v[48:63]
    v_cvt_pk_bf16_f32 v84, v24, v25
    v_cvt_pk_bf16_f32 v85, v26, v27
    v_cvt_pk_bf16_f32 v86, v28, v29
    v_cvt_pk_bf16_f32 v87, v30, v31
    s_waitcnt lgkmcnt(0)
    v_mfma_f32_32x32x16_bf16 v[16:31], v[96:99], v[88:91], v[64:79]
    v_mfma_f32_32x32x16_bf16 v[48:63], v[116:119], v[84:87], v[48:63]
    v_exp_f32 v32, v32
    v_exp_f32 v33, v33
    v_exp_f32 v34, v34
    v_exp_f32 v35, v35
    v_exp_f32 v36, v36
    v_exp_f32 v37, v37
    v_exp_f32 v38, v38
    v_exp_f32 v39, v39
    v_mfma_f32_32x32x8_bf16 v[16:31], v[104:105], v[92:93], v[16:31]
    ds_read_b128 v[100:103], v2 offset:6912
    ds_read_b32 v108, v3 offset:7936
    s_mov_b64 exec, s[42:43]
    ds_read_b128 v[112:115], v4 offset:5760
    ds_read_b128 v[116:119], v4 offset:6336
    s_mov_b64 exec, -1
    s_add_u32 s26, s44, 32768
    s_mov_b32 m0, s26
    s_nop 0
    buffer_load_dwordx4 v5, s[8:11], s26 offen lds
    s_add_u32 s26, s44, 40960
    s_mov_b32 m0, s26
    s_nop 0
    buffer_load_dwordx4 v5, s[8:11], s26 offen lds
    v_cvt_pk_bf16_f32 v80, v32, v33
    v_cvt_pk_bf16_f32 v81, v34, v35
    v_cvt_pk_bf16_f32 v82, v36, v37
    v_cvt_pk_bf16_f32 v83, v38, v39
    v_exp_f32 v40, v40
    v_exp_f32 v41, v41
    v_exp_f32 v42, v42
    v_exp_f32 v43, v43
    v_exp_f32 v44, v44
    v_exp_f32 v45, v45
    v_exp_f32 v46, v46
    v_exp_f32 v47, v47
    v_mfma_f32_32x32x16_bf16 v[48:63], v[120:123], v[80:83], v[48:63]
    v_cvt_pk_bf16_f32 v84, v40, v41
    v_cvt_pk_bf16_f32 v85, v42, v43
    v_cvt_pk_bf16_f32 v86, v44, v45
    v_cvt_pk_bf16_f32 v87, v46, v47
    s_waitcnt lgkmcnt(0)
    v_mfma_f32_32x32x16_bf16 v[32:47], v[100:103], v[88:91], v[64:79]
    v_mfma_f32_32x32x16_bf16 v[48:63], v[124:127], v[84:87], v[48:63]
    v_exp_f32 v16, v16
    v_exp_f32 v17, v17
    v_exp_f32 v18, v18
    v_exp_f32 v19, v19
    v_exp_f32 v20, v20
    v_exp_f32 v21, v21
    v_exp_f32 v22, v22
    v_exp_f32 v23, v23
    v_mfma_f32_32x32x8_bf16 v[32:47], v[108:109], v[92:93], v[32:47]
    ds_read_b128 v[96:99], v2 offset:9216
    ds_read_b32 v104, v3 offset:10240
    s_mov_b64 exec, s[42:43]
    ds_read_b128 v[120:123], v4 offset:8064
    ds_read_b128 v[124:127], v4 offset:8640
    s_mov_b64 exec, -1
    s_add_u32 s26, s44, 49152
    s_mov_b32 m0, s26
    s_nop 0
    buffer_load_dwordx4 v5, s[8:11], s26 offen lds
    s_add_u32 s26, s44, 57344
    s_mov_b32 m0, s26
    s_nop 0
    buffer_load_dwordx4 v5, s[8:11], s26 offen lds
    v_cvt_pk_bf16_f32 v80, v16, v17
    v_cvt_pk_bf16_f32 v81, v18, v19
    v_cvt_pk_bf16_f32 v82, v20, v21
    v_cvt_pk_bf16_f32 v83, v22, v23
    v_exp_f32 v24, v24
    v_exp_f32 v25, v25
    v_exp_f32 v26, v26
    v_exp_f32 v27, v27
    v_exp_f32 v28, v28
    v_exp_f32 v29, v29
    v_exp_f32 v30, v30
    v_exp_f32 v31, v31
    v_mfma_f32_32x32x16_bf16 v[48:63], v[112:115], v[80:83], v[48:63]
    v_cvt_pk_bf16_f32 v84, v24, v25
    v_cvt_pk_bf16_f32 v85, v26, v27
    v_cvt_pk_bf16_f32 v86, v28, v29
    v_cvt_pk_bf16_f32 v87, v30, v31
    s_waitcnt lgkmcnt(0)
    v_mfma_f32_32x32x16_bf16 v[16:31], v[96:99], v[88:91], v[64:79]
    v_mfma_f32_32x32x16_bf16 v[48:63], v[116:119], v[84:87], v[48:63]
    v_exp_f32 v32, v32
    v_exp_f32 v33, v33
    v_exp_f32 v34, v34
    v_exp_f32 v35, v35
    v_exp_f32 v36, v36
    v_exp_f32 v37, v37
    v_exp_f32 v38, v38
    v_exp_f32 v39, v39
    v_mfma_f32_32x32x8_bf16 v[16:31], v[104:105], v[92:93], v[16:31]
    ds_read_b128 v[100:103], v2 offset:11520
    ds_read_b32 v108, v3 offset:12544
    s_mov_b64 exec, s[42:43]
    ds_read_b128 v[112:115], v4 offset:10368
    ds_read_b128 v[116:119], v4 offset:10944
    s_mov_b64 exec, -1
    s_add_u32 s26, s44, 65536
    s_mov_b32 m0, s26
    s_nop 0
    buffer_load_dwordx4 v5, s[8:11], s26 offen lds
    v_cvt_pk_bf16_f32 v80, v32, v33
    v_cvt_pk_bf16_f32 v81, v34, v35
    v_cvt_pk_bf16_f32 v82, v36, v37
    v_cvt_pk_bf16_f32 v83, v38, v39
    v_exp_f32 v40, v40
    v_exp_f32 v41, v41
    v_exp_f32 v42, v42
    v_exp_f32 v43, v43
    v_exp_f32 v44, v44
    v_exp_f32 v45, v45
    v_exp_f32 v46, v46
    v_exp_f32 v47, v47
    v_mfma_f32_32x32x16_bf16 v[48:63], v[120:123], v[80:83], v[48:63]
    v_cvt_pk_bf16_f32 v84, v40, v41
    v_cvt_pk_bf16_f32 v85, v42, v43
    v_cvt_pk_bf16_f32 v86, v44, v45
    v_cvt_pk_bf16_f32 v87, v46, v47
    s_waitcnt lgkmcnt(0)
    v_mfma_f32_32x32x16_bf16 v[32:47], v[100:103], v[88:91], v[64:79]
    v_mfma_f32_32x32x16_bf16 v[48:63], v[124:127], v[84:87], v[48:63]
    v_exp_f32 v16, v16
    v_exp_f32 v17, v17
    v_exp_f32 v18, v18
    v_exp_f32 v19, v19
    v_exp_f32 v20, v20
    v_exp_f32 v21, v21
    v_exp_f32 v22, v22
    v_exp_f32 v23, v23
    v_mfma_f32_32x32x8_bf16 v[32:47], v[108:109], v[92:93], v[32:47]
    ds_read_b128 v[96:99], v2 offset:13824
    ds_read_b32 v104, v3 offset:14848
    s_mov_b64 exec, s[42:43]
    ds_read_b128 v[120:123], v4 offset:12672
    ds_read_b128 v[124:127], v4 offset:13248
    s_mov_b64 exec, -1
    v_cvt_pk_bf16_f32 v80, v16, v17
    v_cvt_pk_bf16_f32 v81, v18, v19
    v_cvt_pk_bf16_f32 v82, v20, v21
    v_cvt_pk_bf16_f32 v83, v22, v23
    v_exp_f32 v24, v24
    v_exp_f32 v25, v25
    v_exp_f32 v26, v26
    v_exp_f32 v27, v27
    v_exp_f32 v28, v28
    v_exp_f32 v29, v29
    v_exp_f32 v30, v30
    v_exp_f32 v31, v31
    v_mfma_f32_32x32x16_bf16 v[48:63], v[112:115], v[80:83], v[48:63]
    v_cvt_pk_bf16_f32 v84, v24, v25
    v_cvt_pk_bf16_f32 v85, v26, v27
    v_cvt_pk_bf16_f32 v86, v28, v29
    v_cvt_pk_bf16_f32 v87, v30, v31
    s_waitcnt vmcnt(0)
    s_barrier
    s_cmp_ge_u32 s2, 8
    s_cbranch_scc1 K2_NCP
    s_cmp_ge_u32 s20, 3
    s_cbranch_scc1 CPF_K2_E
    s_getpc_b64 s[72:73]
CPF_K2_PC:
    s_add_u32 s72, s72, k34_kernel-CPF_K2_PC
    s_addc_u32 s73, s73, 0
    s_lshl_b32 s74, s20, 13
    s_add_u32 s72, s72, s74
    s_addc_u32 s73, s73, 0
    v_and_b32 v12, 63, v0
    v_lshlrev_b32 v12, 7, v12
    v_mov_b32 v13, s73
    v_add_co_u32 v12, vcc, s72, v12
    s_nop 1
    v_addc_co_u32 v13, vcc, 0, v13, vcc
    global_load_dword v14, v[12:13], off
CPF_K2_E:
K2_NCP:
    s_waitcnt lgkmcnt(0)
    v_mfma_f32_32x32x16_bf16 v[16:31], v[96:99], v[88:91], v[64:79]
    v_mfma_f32_32x32x16_bf16 v[48:63], v[116:119], v[84:87], v[48:63]
    v_exp_f32 v32, v32
    v_exp_f32 v33, v33
    v_exp_f32 v34, v34
    v_exp_f32 v35, v35
    v_exp_f32 v36, v36
    v_exp_f32 v37, v37
    v_exp_f32 v38, v38
    v_exp_f32 v39, v39
    v_mfma_f32_32x32x8_bf16 v[16:31], v[104:105], v[92:93], v[16:31]
    ds_read_b128 v[100:103], v2 offset:16128
    ds_read_b32 v108, v3 offset:17152
    s_mov_b64 exec, s[42:43]
    ds_read_b128 v[112:115], v4 offset:14976
    ds_read_b128 v[116:119], v4 offset:15552
    s_mov_b64 exec, -1
    v_cvt_pk_bf16_f32 v80, v32, v33
    v_cvt_pk_bf16_f32 v81, v34, v35
    v_cvt_pk_bf16_f32 v82, v36, v37
    v_cvt_pk_bf16_f32 v83, v38, v39
    v_exp_f32 v40, v40
    v_exp_f32 v41, v41
    v_exp_f32 v42, v42
    v_exp_f32 v43, v43
    v_exp_f32 v44, v44
    v_exp_f32 v45, v45
    v_exp_f32 v46, v46
    v_exp_f32 v47, v47
    v_mfma_f32_32x32x16_bf16 v[48:63], v[120:123], v[80:83], v[48:63]
    v_cvt_pk_bf16_f32 v84, v40, v41
    v_cvt_pk_bf16_f32 v85, v42, v43
    v_cvt_pk_bf16_f32 v86, v44, v45
    v_cvt_pk_bf16_f32 v87, v46, v47
    s_mul_i32 s52, s2, 48
    s_add_u32 s52, s52, s20
    s_mov_b32 s68, s52
    s_mov_b32 s60, -1
    s_cmp_ge_u32 s52, 11016
    s_cbranch_scc1 K2_PI0_E
    v_lshrrev_b32 v9, 1, v1
    v_and_b32 v10, 1, v1
    v_lshlrev_b32 v10, 4, v10
    s_cmp_ge_u32 s52, 10368
    s_cbranch_scc1 K2_PI0_O
    s_cmp_ge_u32 s52, 5184
    s_cbranch_scc1 K2_PI0_2
    s_mul_i32 s53, s52, 3641
    s_lshr_b32 s53, s53, 20
    s_mul_i32 s54, s53, 288
    s_sub_u32 s54, s52, s54
    s_mul_i32 s55, s54, 171
    s_lshr_b32 s55, s55, 9
    s_mul_i32 s61, s55, 3
    s_sub_u32 s61, s54, s61
    s_mul_i32 s60, s55, 54
    s_mul_i32 s62, s53, 3
    s_add_u32 s60, s60, s62
    s_add_u32 s60, s60, s61
    s_lshl_b32 s60, s60, 10
    s_add_u32 s56, s4, 7430144
    s_addc_u32 s57, s5, 0
    s_mov_b32 s58, 5308416
    s_mov_b32 s59, 0x00020000
    s_mov_b32 s64, s46
    s_mov_b32 s65, s47
    s_mov_b32 s66, 5308416
    s_mov_b32 s67, 0x00020000
    v_mul_u32_u24 v9, 9216, v9
    s_mul_i32 s61, s53, 294912
    s_lshl_b32 s62, s54, 5
    s_add_u32 s61, s61, s62
    s_branch K2_PI0_G
K2_PI0_2:
    s_sub_u32 s52, s52, 5184
    s_mul_i32 s53, s52, 3641
    s_lshr_b32 s53, s53, 17
    s_mul_i32 s54, s53, 36
    s_sub_u32 s54, s52, s54
    s_mul_i32 s55, s54, 86
    s_lshr_b32 s55, s55, 8
    s_mul_i32 s61, s55, 3
    s_sub_u32 s61, s54, s61
    s_mul_i32 s62, s53, 57
    s_lshr_b32 s62, s62, 10
    s_mul_i32 s63, s62, 18
    s_sub_u32 s63, s53, s63
    s_mul_i32 s60, s62, 12
    s_add_u32 s60, s60, s55
    s_mul_i32 s60, s60, 18
    s_add_u32 s60, s60, s63
    s_mul_i32 s60, s60, 3
    s_add_u32 s60, s60, s61
    s_lshl_b32 s60, s60, 10
    s_add_u32 s56, s4, 12738560
    s_addc_u32 s57, s5, 0
    s_mov_b32 s58, 5308416
    s_mov_b32 s59, 0x00020000
    s_mov_b32 s64, s48
    s_mov_b32 s65, s49
    s_mov_b32 s66, 5308416
    s_mov_b32 s67, 0x00020000
    v_mul_u32_u24 v9, 1152, v9
    s_mul_i32 s61, s53, 36864
    s_lshl_b32 s62, s54, 5
    s_add_u32 s61, s61, s62
    s_branch K2_PI0_G
K2_PI0_O:
    s_sub_u32 s52, s52, 10368
    s_mul_i32 s53, s52, 911
    s_lshr_b32 s53, s53, 15
    s_mul_i32 s54, s53, 36
    s_sub_u32 s54, s52, s54
    s_mul_i32 s55, s54, 43
    s_lshr_b32 s55, s55, 8
    s_mul_i32 s61, s55, 6
    s_sub_u32 s61, s54, s61
    s_mul_i32 s60, s55, 18
    s_add_u32 s60, s60, s53
    s_mul_i32 s60, s60, 6
    s_add_u32 s60, s60, s61
    s_lshl_b32 s60, s60, 10
    s_add_u32 s56, s4, 6766592
    s_addc_u32 s57, s5, 0
    s_mov_b32 s58, 663552
    s_mov_b32 s59, 0x00020000
    s_mov_b32 s64, s50
    s_mov_b32 s65, s51
    s_mov_b32 s66, 663552
    s_mov_b32 s67, 0x00020000
    v_bfe_u32 v11, v9, 2, 2
    s_cmp_ge_u32 s53, 16
    s_cbranch_scc1 K2_PI0_O2
    v_lshrrev_b32 v12, 1, v11
    v_mul_u32_u24 v12, 18, v12
    v_and_b32 v11, 1, v11
    v_lshl_add_u32 v12, v11, 2, v12
    v_lshrrev_b32 v11, 4, v9
    v_lshl_add_u32 v12, v11, 3, v12
    v_and_b32 v11, 3, v9
    v_add_u32 v9, v12, v11
    s_mul_i32 s61, s53, 36
    s_branch K2_PI0_O3
K2_PI0_O2:
    v_mul_u32_u24 v12, 72, v11
    v_lshrrev_b32 v11, 4, v9
    v_lshlrev_b32 v11, 1, v11
    v_bfe_u32 v13, v9, 1, 1
    v_add_u32 v11, v11, v13
    v_mul_u32_u24 v11, 18, v11
    v_add_u32 v12, v12, v11
    v_and_b32 v11, 1, v9
    v_add_u32 v12, v12, v11
    v_add_u32 v9, 16, v12
    s_sub_u32 s61, s53, 16
    s_mul_i32 s61, s61, 288
K2_PI0_O3:
    v_mul_u32_u24 v9, 1152, v9
    s_mul_i32 s61, s61, 1152
    s_lshl_b32 s62, s54, 5
    s_add_u32 s61, s61, s62
K2_PI0_G:
    v_add_u32 v9, v9, v10
    s_lshl_b32 s62, s20, 10
    s_add_u32 m0, s62, 147456
    s_nop 0
    buffer_load_dwordx4 v9, s[64:67], s61 offen lds
K2_PI0_E:
    s_waitcnt lgkmcnt(0)
    v_mfma_f32_32x32x16_bf16 v[32:47], v[100:103], v[88:91], v[64:79]
    v_mfma_f32_32x32x16_bf16 v[48:63], v[124:127], v[84:87], v[48:63]
    v_exp_f32 v16, v16
    v_exp_f32 v17, v17
    v_exp_f32 v18, v18
    v_exp_f32 v19, v19
    v_exp_f32 v20, v20
    v_exp_f32 v21, v21
    v_exp_f32 v22, v22
    v_exp_f32 v23, v23
    v_mfma_f32_32x32x8_bf16 v[32:47], v[108:109], v[92:93], v[32:47]
    ds_read_b128 v[96:99], v2 offset:18432
    ds_read_b32 v104, v3 offset:19456
    s_mov_b64 exec, s[42:43]
    ds_read_b128 v[120:123], v4 offset:17280
    ds_read_b128 v[124:127], v4 offset:17856
    s_mov_b64 exec, -1
    v_cvt_pk_bf16_f32 v80, v16, v17
    v_cvt_pk_bf16_f32 v81, v18, v19
    v_cvt_pk_bf16_f32 v82, v20, v21
    v_cvt_pk_bf16_f32 v83, v22, v23
    v_exp_f32 v24, v24
    v_exp_f32 v25, v25
    v_exp_f32 v26, v26
    v_exp_f32 v27, v27
    v_exp_f32 v28, v28
    v_exp_f32 v29, v29
    v_exp_f32 v30, v30
    v_exp_f32 v31, v31
    v_mfma_f32_32x32x16_bf16 v[48:63], v[112:115], v[80:83], v[48:63]
    v_cvt_pk_bf16_f32 v84, v24, v25
    v_cvt_pk_bf16_f32 v85, v26, v27
    v_cvt_pk_bf16_f32 v86, v28, v29
    v_cvt_pk_bf16_f32 v87, v30, v31
    s_waitcnt lgkmcnt(0)
    v_mfma_f32_32x32x16_bf16 v[16:31], v[96:99], v[88:91], v[64:79]
    v_mfma_f32_32x32x16_bf16 v[48:63], v[116:119], v[84:87], v[48:63]
    v_exp_f32 v32, v32
    v_exp_f32 v33, v33
    v_exp_f32 v34, v34
    v_exp_f32 v35, v35
    v_exp_f32 v36, v36
    v_exp_f32 v37, v37
    v_exp_f32 v38, v38
    v_exp_f32 v39, v39
    v_mfma_f32_32x32x8_bf16 v[16:31], v[104:105], v[92:93], v[16:31]
    ds_read_b128 v[100:103], v2 offset:20736
    ds_read_b32 v108, v3 offset:21760
    s_mov_b64 exec, s[42:43]
    ds_read_b128 v[112:115], v4 offset:19584
    ds_read_b128 v[116:119], v4 offset:20160
    s_mov_b64 exec, -1
    v_cvt_pk_bf16_f32 v80, v32, v33
    v_cvt_pk_bf16_f32 v81, v34, v35
    v_cvt_pk_bf16_f32 v82, v36, v37
    v_cvt_pk_bf16_f32 v83, v38, v39
    v_exp_f32 v40, v40
    v_exp_f32 v41, v41
    v_exp_f32 v42, v42
    v_exp_f32 v43, v43
    v_exp_f32 v44, v44
    v_exp_f32 v45, v45
    v_exp_f32 v46, v46
    v_exp_f32 v47, v47
    v_mfma_f32_32x32x16_bf16 v[48:63], v[120:123], v[80:83], v[48:63]
    v_cvt_pk_bf16_f32 v84, v40, v41
    v_cvt_pk_bf16_f32 v85, v42, v43
    v_cvt_pk_bf16_f32 v86, v44, v45
    v_cvt_pk_bf16_f32 v87, v46, v47
    v_add_u32 v2, 18432, v2
    v_add_u32 v3, 18432, v3
    v_add_u32 v4, 18432, v4
    s_mov_b32 s28, 3
K2_LOOP:
    s_cmp_eq_u32 s28, 3
    s_cbranch_scc1 K2_P2
    s_cmp_eq_u32 s28, 2
    s_cbranch_scc1 K2_P1
    s_setprio 0
    s_branch K2_PD
K2_P1:
    s_setprio 1
    s_branch K2_PD
K2_P2:
    s_setprio 2
K2_PD:
    s_cmp_eq_u32 s60, -1
    s_cbranch_scc1 K2_PC_E
    s_waitcnt vmcnt(0)
    v_lshrrev_b32 v9, 2, v1
    v_lshlrev_b32 v9, 5, v9
    v_and_b32 v10, 3, v1
    v_lshl_add_u32 v9, v10, 3, v9
    s_lshl_b32 s62, s20, 10
    s_add_u32 s62, s62, 147456
    v_add_u32 v9, s62, v9
    ds_read_b64_tr_b16 v[12:13], v9
    ds_read_b64_tr_b16 v[14:15], v9 offset:512
    s_waitcnt lgkmcnt(0)
    buffer_store_dwordx4 v[12:15], v5, s[56:59], s60 offen sc1
K2_PC_E:
    s_add_u32 s68, s68, 16
    s_mov_b32 s52, s68
    s_mov_b32 s60, -1
    s_cmp_eq_u32 s28, 1
    s_cbranch_scc1 K2_PI1_E
    s_mov_b32 s60, -1
    s_cmp_ge_u32 s52, 11016
    s_cbranch_scc1 K2_PI1_E
    v_lshrrev_b32 v9, 1, v1
    v_and_b32 v10, 1, v1
    v_lshlrev_b32 v10, 4, v10
    s_cmp_ge_u32 s52, 10368
    s_cbranch_scc1 K2_PI1_O
    s_cmp_ge_u32 s52, 5184
    s_cbranch_scc1 K2_PI1_2
    s_mul_i32 s53, s52, 3641
    s_lshr_b32 s53, s53, 20
    s_mul_i32 s54, s53, 288
    s_sub_u32 s54, s52, s54
    s_mul_i32 s55, s54, 171
    s_lshr_b32 s55, s55, 9
    s_mul_i32 s61, s55, 3
    s_sub_u32 s61, s54, s61
    s_mul_i32 s60, s55, 54
    s_mul_i32 s62, s53, 3
    s_add_u32 s60, s60, s62
    s_add_u32 s60, s60, s61
    s_lshl_b32 s60, s60, 10
    s_add_u32 s56, s4, 7430144
    s_addc_u32 s57, s5, 0
    s_mov_b32 s58, 5308416
    s_mov_b32 s59, 0x00020000
    s_mov_b32 s64, s46
    s_mov_b32 s65, s47
    s_mov_b32 s66, 5308416
    s_mov_b32 s67, 0x00020000
    v_mul_u32_u24 v9, 9216, v9
    s_mul_i32 s61, s53, 294912
    s_lshl_b32 s62, s54, 5
    s_add_u32 s61, s61, s62
    s_branch K2_PI1_G
K2_PI1_2:
    s_sub_u32 s52, s52, 5184
    s_mul_i32 s53, s52, 3641
    s_lshr_b32 s53, s53, 17
    s_mul_i32 s54, s53, 36
    s_sub_u32 s54, s52, s54
    s_mul_i32 s55, s54, 86
    s_lshr_b32 s55, s55, 8
    s_mul_i32 s61, s55, 3
    s_sub_u32 s61, s54, s61
    s_mul_i32 s62, s53, 57
    s_lshr_b32 s62, s62, 10
    s_mul_i32 s63, s62, 18
    s_sub_u32 s63, s53, s63
    s_mul_i32 s60, s62, 12
    s_add_u32 s60, s60, s55
    s_mul_i32 s60, s60, 18
    s_add_u32 s60, s60, s63
    s_mul_i32 s60, s60, 3
    s_add_u32 s60, s60, s61
    s_lshl_b32 s60, s60, 10
    s_add_u32 s56, s4, 12738560
    s_addc_u32 s57, s5, 0
    s_mov_b32 s58, 5308416
    s_mov_b32 s59, 0x00020000
    s_mov_b32 s64, s48
    s_mov_b32 s65, s49
    s_mov_b32 s66, 5308416
    s_mov_b32 s67, 0x00020000
    v_mul_u32_u24 v9, 1152, v9
    s_mul_i32 s61, s53, 36864
    s_lshl_b32 s62, s54, 5
    s_add_u32 s61, s61, s62
    s_branch K2_PI1_G
K2_PI1_O:
    s_sub_u32 s52, s52, 10368
    s_mul_i32 s53, s52, 911
    s_lshr_b32 s53, s53, 15
    s_mul_i32 s54, s53, 36
    s_sub_u32 s54, s52, s54
    s_mul_i32 s55, s54, 43
    s_lshr_b32 s55, s55, 8
    s_mul_i32 s61, s55, 6
    s_sub_u32 s61, s54, s61
    s_mul_i32 s60, s55, 18
    s_add_u32 s60, s60, s53
    s_mul_i32 s60, s60, 6
    s_add_u32 s60, s60, s61
    s_lshl_b32 s60, s60, 10
    s_add_u32 s56, s4, 6766592
    s_addc_u32 s57, s5, 0
    s_mov_b32 s58, 663552
    s_mov_b32 s59, 0x00020000
    s_mov_b32 s64, s50
    s_mov_b32 s65, s51
    s_mov_b32 s66, 663552
    s_mov_b32 s67, 0x00020000
    v_bfe_u32 v11, v9, 2, 2
    s_cmp_ge_u32 s53, 16
    s_cbranch_scc1 K2_PI1_O2
    v_lshrrev_b32 v12, 1, v11
    v_mul_u32_u24 v12, 18, v12
    v_and_b32 v11, 1, v11
    v_lshl_add_u32 v12, v11, 2, v12
    v_lshrrev_b32 v11, 4, v9
    v_lshl_add_u32 v12, v11, 3, v12
    v_and_b32 v11, 3, v9
    v_add_u32 v9, v12, v11
    s_mul_i32 s61, s53, 36
    s_branch K2_PI1_O3
K2_PI1_O2:
    v_mul_u32_u24 v12, 72, v11
    v_lshrrev_b32 v11, 4, v9
    v_lshlrev_b32 v11, 1, v11
    v_bfe_u32 v13, v9, 1, 1
    v_add_u32 v11, v11, v13
    v_mul_u32_u24 v11, 18, v11
    v_add_u32 v12, v12, v11
    v_and_b32 v11, 1, v9
    v_add_u32 v12, v12, v11
    v_add_u32 v9, 16, v12
    s_sub_u32 s61, s53, 16
    s_mul_i32 s61, s61, 288
K2_PI1_O3:
    v_mul_u32_u24 v9, 1152, v9
    s_mul_i32 s61, s61, 1152
    s_lshl_b32 s62, s54, 5
    s_add_u32 s61, s61, s62
K2_PI1_G:
    v_add_u32 v9, v9, v10
    s_lshl_b32 s62, s20, 10
    s_add_u32 m0, s62, 147456
    s_nop 0
    buffer_load_dwordx4 v9, s[64:67], s61 offen lds
K2_PI1_E:
    s_waitcnt lgkmcnt(0)
    v_mfma_f32_32x32x16_bf16 v[32:47], v[100:103], v[88:91], v[64:79]
    v_mfma_f32_32x32x16_bf16 v[48:63], v[124:127], v[84:87], v[48:63]
    v_exp_f32 v16, v16
    v_exp_f32 v17, v17
    v_exp_f32 v18, v18
    v_exp_f32 v19, v19
    v_exp_f32 v20, v20
    v_exp_f32 v21, v21
    v_exp_f32 v22, v22
    v_exp_f32 v23, v23
    v_mfma_f32_32x32x8_bf16 v[32:47], v[108:109], v[92:93], v[32:47]
    ds_read_b128 v[96:99], v2 offset:4608
    ds_read_b32 v104, v3 offset:5632
    s_mov_b64 exec, s[42:43]
    ds_read_b128 v[120:123], v4 offset:3456
    ds_read_b128 v[124:127], v4 offset:4032
    s_mov_b64 exec, -1
    v_cvt_pk_bf16_f32 v80, v16, v17
    v_cvt_pk_bf16_f32 v81, v18, v19
    v_cvt_pk_bf16_f32 v82, v20, v21
    v_cvt_pk_bf16_f32 v83, v22, v23
    v_exp_f32 v24, v24
    v_exp_f32 v25, v25
    v_exp_f32 v26, v26
    v_exp_f32 v27, v27
    v_exp_f32 v28, v28
    v_exp_f32 v29, v29
    v_exp_f32 v30, v30
    v_exp_f32 v31, v31
    v_mfma_f32_32x32x16_bf16 v[48:63], v[112:115], v[80:83], v[48:63]
    v_cvt_pk_bf16_f32 v84, v24, v25
    v_cvt_pk_bf16_f32 v85, v26, v27
    v_cvt_pk_bf16_f32 v86, v28, v29
    v_cvt_pk_bf16_f32 v87, v30, v31
    s_waitcnt lgkmcnt(0)
    v_mfma_f32_32x32x16_bf16 v[16:31], v[96:99], v[88:91], v[64:79]
    v_mfma_f32_32x32x16_bf16 v[48:63], v[116:119], v[84:87], v[48:63]
    v_exp_f32 v32, v32
    v_exp_f32 v33, v33
    v_exp_f32 v34, v34
    v_exp_f32 v35, v35
    v_exp_f32 v36, v36
    v_exp_f32 v37, v37
    v_exp_f32 v38, v38
    v_exp_f32 v39, v39
    v_mfma_f32_32x32x8_bf16 v[16:31], v[104:105], v[92:93], v[16:31]
    ds_read_b128 v[100:103], v2 offset:6912
    ds_read_b32 v108, v3 offset:7936
    s_mov_b64 exec, s[42:43]
    ds_read_b128 v[112:115], v4 offset:5760
    ds_read_b128 v[116:119], v4 offset:6336
    s_mov_b64 exec, -1
    v_cvt_pk_bf16_f32 v80, v32, v33
    v_cvt_pk_bf16_f32 v81, v34, v35
    v_cvt_pk_bf16_f32 v82, v36, v37
    v_cvt_pk_bf16_f32 v83, v38, v39
    v_exp_f32 v40, v40
    v_exp_f32 v41, v41
    v_exp_f32 v42, v42
    v_exp_f32 v43, v43
    v_exp_f32 v44, v44
    v_exp_f32 v45, v45
    v_exp_f32 v46, v46
    v_exp_f32 v47, v47
    v_mfma_f32_32x32x16_bf16 v[48:63], v[120:123], v[80:83], v[48:63]
    v_cvt_pk_bf16_f32 v84, v40, v41
    v_cvt_pk_bf16_f32 v85, v42, v43
    v_cvt_pk_bf16_f32 v86, v44, v45
    v_cvt_pk_bf16_f32 v87, v46, v47
    s_waitcnt lgkmcnt(0)
    v_mfma_f32_32x32x16_bf16 v[32:47], v[100:103], v[88:91], v[64:79]
    v_mfma_f32_32x32x16_bf16 v[48:63], v[124:127], v[84:87], v[48:63]
    v_exp_f32 v16, v16
    v_exp_f32 v17, v17
    v_exp_f32 v18, v18
    v_exp_f32 v19, v19
    v_exp_f32 v20, v20
    v_exp_f32 v21, v21
    v_exp_f32 v22, v22
    v_exp_f32 v23, v23
    v_mfma_f32_32x32x8_bf16 v[32:47], v[108:109], v[92:93], v[32:47]
    ds_read_b128 v[96:99], v2 offset:9216
    ds_read_b32 v104, v3 offset:10240
    s_mov_b64 exec, s[42:43]
    ds_read_b128 v[120:123], v4 offset:8064
    ds_read_b128 v[124:127], v4 offset:8640
    s_mov_b64 exec, -1
    v_cvt_pk_bf16_f32 v80, v16, v17
    v_cvt_pk_bf16_f32 v81, v18, v19
    v_cvt_pk_bf16_f32 v82, v20, v21
    v_cvt_pk_bf16_f32 v83, v22, v23
    v_exp_f32 v24, v24
    v_exp_f32 v25, v25
    v_exp_f32 v26, v26
    v_exp_f32 v27, v27
    v_exp_f32 v28, v28
    v_exp_f32 v29, v29
    v_exp_f32 v30, v30
    v_exp_f32 v31, v31
    v_mfma_f32_32x32x16_bf16 v[48:63], v[112:115], v[80:83], v[48:63]
    v_cvt_pk_bf16_f32 v84, v24, v25
    v_cvt_pk_bf16_f32 v85, v26, v27
    v_cvt_pk_bf16_f32 v86, v28, v29
    v_cvt_pk_bf16_f32 v87, v30, v31
    s_waitcnt lgkmcnt(0)
    v_mfma_f32_32x32x16_bf16 v[16:31], v[96:99], v[88:91], v[64:79]
    v_mfma_f32_32x32x16_bf16 v[48:63], v[116:119], v[84:87], v[48:63]
    v_exp_f32 v32, v32
    v_exp_f32 v33, v33
    v_exp_f32 v34, v34
    v_exp_f32 v35, v35
    v_exp_f32 v36, v36
    v_exp_f32 v37, v37
    v_exp_f32 v38, v38
    v_exp_f32 v39, v39
    v_mfma_f32_32x32x8_bf16 v[16:31], v[104:105], v[92:93], v[16:31]
    ds_read_b128 v[100:103], v2 offset:11520
    ds_read_b32 v108, v3 offset:12544
    s_mov_b64 exec, s[42:43]
    ds_read_b128 v[112:115], v4 offset:10368
    ds_read_b128 v[116:119], v4 offset:10944
    s_mov_b64 exec, -1
    v_cvt_pk_bf16_f32 v80, v32, v33
    v_cvt_pk_bf16_f32 v81, v34, v35
    v_cvt_pk_bf16_f32 v82, v36, v37
    v_cvt_pk_bf16_f32 v83, v38, v39
    v_exp_f32 v40, v40
    v_exp_f32 v41, v41
    v_exp_f32 v42, v42
    v_exp_f32 v43, v43
    v_exp_f32 v44, v44
    v_exp_f32 v45, v45
    v_exp_f32 v46, v46
    v_exp_f32 v47, v47
    v_mfma_f32_32x32x16_bf16 v[48:63], v[120:123], v[80:83], v[48:63]
    v_cvt_pk_bf16_f32 v84, v40, v41
    v_cvt_pk_bf16_f32 v85, v42, v43
    v_cvt_pk_bf16_f32 v86, v44, v45
    v_cvt_pk_bf16_f32 v87, v46, v47
    s_waitcnt lgkmcnt(0)
    v_mfma_f32_32x32x16_bf16 v[32:47], v[100:103], v[88:91], v[64:79]
    v_mfma_f32_32x32x16_bf16 v[48:63], v[124:127], v[84:87], v[48:63]
    v_exp_f32 v16, v16
    v_exp_f32 v17, v17
    v_exp_f32 v18, v18
    v_exp_f32 v19, v19
    v_exp_f32 v20, v20
    v_exp_f32 v21, v21
    v_exp_f32 v22, v22
    v_exp_f32 v23, v23
    v_mfma_f32_32x32x8_bf16 v[32:47], v[108:109], v[92:93], v[32:47]
    ds_read_b128 v[96:99], v2 offset:13824
    ds_read_b32 v104, v3 offset:14848
    s_mov_b64 exec, s[42:43]
    ds_read_b128 v[120:123], v4 offset:12672
    ds_read_b128 v[124:127], v4 offset:13248
    s_mov_b64 exec, -1
    v_cvt_pk_bf16_f32 v80, v16, v17
    v_cvt_pk_bf16_f32 v81, v18, v19
    v_cvt_pk_bf16_f32 v82, v20, v21
    v_cvt_pk_bf16_f32 v83, v22, v23
    v_exp_f32 v24, v24
    v_exp_f32 v25, v25
    v_exp_f32 v26, v26
    v_exp_f32 v27, v27
    v_exp_f32 v28, v28
    v_exp_f32 v29, v29
    v_exp_f32 v30, v30
    v_exp_f32 v31, v31
    v_mfma_f32_32x32x16_bf16 v[48:63], v[112:115], v[80:83], v[48:63]
    v_cvt_pk_bf16_f32 v84, v24, v25
    v_cvt_pk_bf16_f32 v85, v26, v27
    v_cvt_pk_bf16_f32 v86, v28, v29
    v_cvt_pk_bf16_f32 v87, v30, v31
    s_waitcnt lgkmcnt(0)
    v_mfma_f32_32x32x16_bf16 v[16:31], v[96:99], v[88:91], v[64:79]
    v_mfma_f32_32x32x16_bf16 v[48:63], v[116:119], v[84:87], v[48:63]
    v_exp_f32 v32, v32
    v_exp_f32 v33, v33
    v_exp_f32 v34, v34
    v_exp_f32 v35, v35
    v_exp_f32 v36, v36
    v_exp_f32 v37, v37
    v_exp_f32 v38, v38
    v_exp_f32 v39, v39
    v_mfma_f32_32x32x8_bf16 v[16:31], v[104:105], v[92:93], v[16:31]
    ds_read_b128 v[100:103], v2 offset:16128
    ds_read_b32 v108, v3 offset:17152
    s_mov_b64 exec, s[42:43]
    ds_read_b128 v[112:115], v4 offset:14976
    ds_read_b128 v[116:119], v4 offset:15552
    s_mov_b64 exec, -1
    v_cvt_pk_bf16_f32 v80, v32, v33
    v_cvt_pk_bf16_f32 v81, v34, v35
    v_cvt_pk_bf16_f32 v82, v36, v37
    v_cvt_pk_bf16_f32 v83, v38, v39
    v_exp_f32 v40, v40
    v_exp_f32 v41, v41
    v_exp_f32 v42, v42
    v_exp_f32 v43, v43
    v_exp_f32 v44, v44
    v_exp_f32 v45, v45
    v_exp_f32 v46, v46
    v_exp_f32 v47, v47
    v_mfma_f32_32x32x16_bf16 v[48:63], v[120:123], v[80:83], v[48:63]
    v_cvt_pk_bf16_f32 v84, v40, v41
    v_cvt_pk_bf16_f32 v85, v42, v43
    v_cvt_pk_bf16_f32 v86, v44, v45
    v_cvt_pk_bf16_f32 v87, v46, v47
    s_waitcnt lgkmcnt(0)
    v_mfma_f32_32x32x16_bf16 v[32:47], v[100:103], v[88:91], v[64:79]
    v_mfma_f32_32x32x16_bf16 v[48:63], v[124:127], v[84:87], v[48:63]
    v_exp_f32 v16, v16
    v_exp_f32 v17, v17
    v_exp_f32 v18, v18
    v_exp_f32 v19, v19
    v_exp_f32 v20, v20
    v_exp_f32 v21, v21
    v_exp_f32 v22, v22
    v_exp_f32 v23, v23
    v_mfma_f32_32x32x8_bf16 v[32:47], v[108:109], v[92:93], v[32:47]
    ds_read_b128 v[96:99], v2 offset:18432
    ds_read_b32 v104, v3 offset:19456
    s_mov_b64 exec, s[42:43]
    ds_read_b128 v[120:123], v4 offset:17280
    ds_read_b128 v[124:127], v4 offset:17856
    s_mov_b64 exec, -1
    v_cvt_pk_bf16_f32 v80, v16, v17
    v_cvt_pk_bf16_f32 v81, v18, v19
    v_cvt_pk_bf16_f32 v82, v20, v21
    v_cvt_pk_bf16_f32 v83, v22, v23
    v_exp_f32 v24, v24
    v_exp_f32 v25, v25
    v_exp_f32 v26, v26
    v_exp_f32 v27, v27
    v_exp_f32 v28, v28
    v_exp_f32 v29, v29
    v_exp_f32 v30, v30
    v_exp_f32 v31, v31
    v_mfma_f32_32x32x16_bf16 v[48:63], v[112:115], v[80:83], v[48:63]
    v_cvt_pk_bf16_f32 v84, v24, v25
    v_cvt_pk_bf16_f32 v85, v26, v27
    v_cvt_pk_bf16_f32 v86, v28, v29
    v_cvt_pk_bf16_f32 v87, v30, v31
    s_waitcnt lgkmcnt(0)
    v_mfma_f32_32x32x16_bf16 v[16:31], v[96:99], v[88:91], v[64:79]
    v_mfma_f32_32x32x16_bf16 v[48:63], v[116:119], v[84:87], v[48:63]
    v_exp_f32 v32, v32
    v_exp_f32 v33, v33
    v_exp_f32 v34, v34
    v_exp_f32 v35, v35
    v_exp_f32 v36, v36
    v_exp_f32 v37, v37
    v_exp_f32 v38, v38
    v_exp_f32 v39, v39
    v_mfma_f32_32x32x8_bf16 v[16:31], v[104:105], v[92:93], v[16:31]
    ds_read_b128 v[100:103], v2 offset:20736
    ds_read_b32 v108, v3 offset:21760
    s_mov_b64 exec, s[42:43]
    ds_read_b128 v[112:115], v4 offset:19584
    ds_read_b128 v[116:119], v4 offset:20160
    s_mov_b64 exec, -1
    v_cvt_pk_bf16_f32 v80, v32, v33
    v_cvt_pk_bf16_f32 v81, v34, v35
    v_cvt_pk_bf16_f32 v82, v36, v37
    v_cvt_pk_bf16_f32 v83, v38, v39
    v_exp_f32 v40, v40
    v_exp_f32 v41, v41
    v_exp_f32 v42, v42
    v_exp_f32 v43, v43
    v_exp_f32 v44, v44
    v_exp_f32 v45, v45
    v_exp_f32 v46, v46
    v_exp_f32 v47, v47
    v_mfma_f32_32x32x16_bf16 v[48:63], v[120:123], v[80:83], v[48:63]
    v_cvt_pk_bf16_f32 v84, v40, v41
    v_cvt_pk_bf16_f32 v85, v42, v43
    v_cvt_pk_bf16_f32 v86, v44, v45
    v_cvt_pk_bf16_f32 v87, v46, v47
    v_add_u32 v2, 18432, v2
    v_add_u32 v3, 18432, v3
    v_add_u32 v4, 18432, v4
    s_sub_u32 s28, s28, 1
    s_cmp_lg_u32 s28, 0
    s_cbranch_scc1 K2_LOOP
    v_mfma_f32_32x32x16_bf16 v[48:63], v[124:127], v[84:87], v[48:63]
    v_mov_b32 v12, 0
    v_mov_b32 v13, 147456
    s_cmp_lg_u32 s20, 0
    s_nop 1
    s_cbranch_scc1 K2_NZ
    ds_write_b32 v13, v12
K2_NZ:
    s_waitcnt lgkmcnt(0)
    s_barrier
    s_mul_i32 s28, s23, 3072
    v_add_u32 v14, s28, v5
    s_cmp_eq_u32 s24, 0
    s_cbranch_scc1 K2_M0
    ds_write_b128 v14, v[48:51] offset:0
    ds_write_b128 v14, v[52:55] offset:1024
    ds_write_b128 v14, v[56:59] offset:2048
    s_waitcnt lgkmcnt(0)
    s_barrier
    s_branch K2_M1
K2_M0:
    s_barrier
    ds_read_b128 v[16:19], v14 offset:0
    ds_read_b128 v[20:23], v14 offset:1024
    ds_read_b128 v[24:27], v14 offset:2048
    s_waitcnt lgkmcnt(0)
    v_add_f32 v48, v48, v16
    v_add_f32 v49, v49, v17
    v_add_f32 v50, v50, v18
    v_add_f32 v51, v51, v19
    v_add_f32 v52, v52, v20
    v_add_f32 v53, v53, v21
    v_add_f32 v54, v54, v22
    v_add_f32 v55, v55, v23
    v_add_f32 v56, v56, v24
    v_add_f32 v57, v57, v25
    v_add_f32 v58, v58, v26
    v_add_f32 v59, v59, v27
    v_mov_b32 v12, v58
    s_nop 1
    v_permlane32_swap_b32 v58, v12
    s_mov_b32 s29, 0x12800000
    v_cmp_nle_f32 vcc, s29, v58
    s_nop 0
    s_cmp_eq_u64 vcc, 0
    s_cbranch_scc1 K2_M1
    v_mov_b32 v12, 1
    v_mov_b32 v13, 147456
    ds_write_b32 v13, v12
    s_waitcnt lgkmcnt(0)
K2_M1:
    s_barrier
    v_mov_b32 v13, 147456
    ds_read_b32 v12, v13
    s_waitcnt lgkmcnt(0)
    v_readfirstlane_b32 s29, v12
    s_nop 0
    s_cmp_eq_u32 s29, 0
    s_cbranch_scc1 K2_FIN
    s_cmp_lg_u32 s40, 0
    s_cbranch_scc1 K2_FIN
    s_mov_b32 s40, 1
    s_barrier
    s_branch K2_RESTART
K2_FIN:
    s_cmp_lg_u32 s24, 0
    s_cbranch_scc1 K2_END
    v_rcp_f32 v12, v58
    s_nop 0
    v_mul_f32 v48, v48, v12
    v_mul_f32 v49, v49, v12
    v_mul_f32 v50, v50, v12
    v_mul_f32 v51, v51, v12
    v_mul_f32 v52, v52, v12
    v_mul_f32 v53, v53, v12
    v_mul_f32 v54, v54, v12
    v_mul_f32 v55, v55, v12
    v_mul_f32 v56, v56, v12
    v_mul_f32 v57, v57, v12
    v_cvt_pk_bf16_f32 v16, v48, v49
    v_cvt_pk_bf16_f32 v17, v50, v51
    v_cvt_pk_bf16_f32 v18, v52, v53
    v_cvt_pk_bf16_f32 v19, v54, v55
    v_cvt_pk_bf16_f32 v20, v56, v57
    s_add_u32 s12, s4, 25169920
    s_addc_u32 s13, s5, 0
    s_mov_b32 s14, 2359296
    s_mov_b32 s15, 0x00020000
    v_bfe_u32 v12, v1, 4, 1
    s_lshl_b32 s28, s25, 1
    v_add_u32 v12, s28, v12
    v_mul_u32_u24 v12, 18, v12
    v_lshlrev_b32 v12, 10, v12
    v_and_b32 v13, 15, v1
    v_lshl_add_u32 v12, v13, 4, v12
    v_lshrrev_b32 v14, 5, v1
    v_lshl_add_u32 v14, v14, 8, v12
    s_lshr_b32 s28, s21, 1
    s_lshl_b32 s28, s28, 10
    s_and_b32 s29, s21, 1
    s_lshl_b32 s29, s29, 9
    s_add_u32 s28, s28, s29
    buffer_store_dwordx4 v[16:19], v14, s[12:15], s28 offen
    s_lshr_b32 s28, s21, 4
    s_add_u32 s28, s28, 16
    s_lshl_b32 s28, s28, 10
    s_bfe_u32 s29, s21, 0x20002
    s_lshl_b32 s29, s29, 8
    s_add_u32 s28, s28, s29
    s_and_b32 s29, s21, 3
    s_lshl_b32 s29, s29, 2
    s_add_u32 s28, s28, s29
    s_mov_b32 exec_hi, 0
    buffer_store_dword v20, v12, s[12:15], s28 offen
K2_END:
    s_endpgm

.text
.globl k34_kernel
.p2align 8
.type k34_kernel,@function
k34_kernel:
    s_cmp_ge_u32 s2, 256
    s_cbranch_scc1 K4_END
    s_load_dwordx2 s[4:5], s[0:1], 80
    s_load_dwordx2 s[6:7], s[0:1], 64
    v_lshrrev_b32 v1, 6, v0
    s_nop 0
    v_readfirstlane_b32 s20, v1
    v_and_b32 v1, 63, v0
    v_lshlrev_b32 v2, 4, v1
    s_and_b32 s26, s2, 7
    s_lshr_b32 s27, s2, 3
    s_and_b32 s22, s26, 3
    s_lshl_b32 s22, s22, 1
    s_and_b32 s28, s27, 1
    s_add_u32 s22, s22, s28
    s_lshr_b32 s21, s26, 2
    s_lshl_b32 s21, s21, 4
    s_lshr_b32 s28, s27, 1
    s_add_u32 s21, s21, s28
    s_lshr_b32 s38, s20, 2
    v_mov_b32 v10, 152576
    v_mov_b32 v11, 0
    ds_write_b32 v10, v11 offset:0
    ds_write_b32 v10, v11 offset:4
    ds_write_b32 v10, v11 offset:8
    v_lshlrev_b32 v10, 2, v1
    v_add_u32 v10, 147456, v10
    ds_write_b32 v10, v11
    ds_write_b32 v10, v11 offset:256
    s_waitcnt lgkmcnt(0)
    s_add_u32 s40, s4, 51245056
    s_addc_u32 s41, s5, 0
    s_mov_b32 s42, 18432
    s_mov_b32 s43, 0x00020000
    s_cmp_ge_u32 s22, 6
    s_cbranch_scc1 K34_UT
    s_cmp_ge_u32 s20, 6
    s_cselect_b32 s39, 1, 0
    s_mul_i32 s28, s39, 6
    s_sub_u32 s44, s20, s28
    s_mul_i32 s26, s22, 110592
    s_add_u32 s8, s4, s26
    s_addc_u32 s9, s5, 0
    s_add_u32 s8, s8, 6766592
    s_addc_u32 s9, s9, 0
    s_mov_b32 s10, 110592
    s_mov_b32 s11, 0x00020000
    s_add_u32 s12, s4, 25169920
    s_addc_u32 s13, s5, 0
    s_mov_b32 s14, 2359296
    s_mov_b32 s15, 0x00020000
    s_mul_i32 s27, s21, 73728
    s_lshl_b32 s28, s44, 10
    s_add_u32 s27, s27, s28
    s_mul_i32 s29, s44, 6144
    s_mul_i32 s28, s39, 3072
    s_add_u32 s29, s29, s28
    s_add_u32 s30, s27, 0
    buffer_load_dwordx4 v[64:67], v2, s[12:15], s30 offen
    s_add_u32 s30, s27, 18432
    buffer_load_dwordx4 v[68:71], v2, s[12:15], s30 offen
    s_add_u32 s30, s27, 36864
    buffer_load_dwordx4 v[72:75], v2, s[12:15], s30 offen
    s_add_u32 s30, s27, 55296
    buffer_load_dwordx4 v[76:79], v2, s[12:15], s30 offen
    s_add_u32 s30, s29, 0
    buffer_load_dwordx4 v[80:83], v2, s[8:11], s30 offen offset:0
    buffer_load_dwordx4 v[84:87], v2, s[8:11], s30 offen offset:1024
    buffer_load_dwordx4 v[88:91], v2, s[8:11], s30 offen offset:2048
    s_add_u32 s30, s27, 6144
    buffer_load_dwordx4 v[92:95], v2, s[12:15], s30 offen
    s_add_u32 s30, s27, 24576
    buffer_load_dwordx4 v[96:99], v2, s[12:15], s30 offen
    s_add_u32 s30, s27, 43008
    buffer_load_dwordx4 v[100:103], v2, s[12:15], s30 offen
    s_add_u32 s30, s27, 61440
    buffer_load_dwordx4 v[104:107], v2, s[12:15], s30 offen
    s_add_u32 s30, s29, 36864
    buffer_load_dwordx4 v[108:111], v2, s[8:11], s30 offen offset:0
    buffer_load_dwordx4 v[112:115], v2, s[8:11], s30 offen offset:1024
    buffer_load_dwordx4 v[116:119], v2, s[8:11], s30 offen offset:2048
    s_add_u32 s30, s27, 12288
    buffer_load_dwordx4 v[120:123], v2, s[12:15], s30 offen
    s_add_u32 s30, s27, 30720
    buffer_load_dwordx4 v[124:127], v2, s[12:15], s30 offen
    s_add_u32 s30, s27, 49152
    buffer_load_dwordx4 v[128:131], v2, s[12:15], s30 offen
    s_add_u32 s30, s27, 67584
    buffer_load_dwordx4 v[132:135], v2, s[12:15], s30 offen
    s_add_u32 s30, s29, 73728
    buffer_load_dwordx4 v[136:139], v2, s[8:11], s30 offen offset:0
    buffer_load_dwordx4 v[140:143], v2, s[8:11], s30 offen offset:1024
    buffer_load_dwordx4 v[144:147], v2, s[8:11], s30 offen offset:2048
    s_add_u32 s16, s4, 28672
    s_addc_u32 s17, s5, 0
    s_mov_b32 s18, 13824
    s_mov_b32 s19, 0x00020000
    s_add_u32 s24, s4, 2416640
    s_addc_u32 s25, s5, 0
    s_mov_b32 s26, 2359296
    s_mov_b32 s27, 0x00020000
    s_add_u32 s48, s4, 45056
    s_addc_u32 s49, s5, 0
    s_mov_b32 s50, 2304
    s_mov_b32 s51, 0x00020000
    s_mul_i32 s32, s22, 6
    s_lshl_b32 s33, s38, 1
    s_add_u32 s32, s32, s33
    v_lshrrev_b32 v9, 4, v1
    v_lshlrev_b32 v9, 4, v9
    s_lshl_b32 s52, s32, 6
    s_add_u32 s33, s52, 4608
    buffer_load_dwordx4 v[148:151], v9, s[16:19], s33 offen
    buffer_load_dwordx4 v[152:155], v9, s[16:19], s33 offen offset:64
    buffer_load_dwordx4 v[156:159], v9, s[48:51], s52 offen
    buffer_load_dwordx4 v[160:163], v9, s[48:51], s52 offen offset:64
    s_and_b32 s34, s20, 3
    s_lshl_b32 s35, s21, 2
    s_add_u32 s34, s34, s35
    s_mul_i32 s35, s34, 18432
    s_lshr_b32 s36, s32, 1
    s_lshl_b32 s36, s36, 10
    s_add_u32 s35, s35, s36
    v_add_u32 v8, s35, v2
    buffer_load_dwordx4 v[164:167], v8, s[24:27], 0 offen
    s_waitcnt vmcnt(19)
    v_mfma_f32_16x16x32_bf16 v[16:19], v[80:83], v[64:67], 0
    v_mfma_f32_16x16x32_bf16 v[20:23], v[80:83], v[68:71], 0
    v_mfma_f32_16x16x32_bf16 v[24:27], v[80:83], v[72:75], 0
    v_mfma_f32_16x16x32_bf16 v[28:31], v[80:83], v[76:79], 0
    v_mfma_f32_16x16x32_bf16 v[32:35], v[84:87], v[64:67], 0
    v_mfma_f32_16x16x32_bf16 v[36:39], v[84:87], v[68:71], 0
    v_mfma_f32_16x16x32_bf16 v[40:43], v[84:87], v[72:75], 0
    v_mfma_f32_16x16x32_bf16 v[44:47], v[84:87], v[76:79], 0
    v_mfma_f32_16x16x32_bf16 v[48:51], v[88:91], v[64:67], 0
    v_mfma_f32_16x16x32_bf16 v[52:55], v[88:91], v[68:71], 0
    v_mfma_f32_16x16x32_bf16 v[56:59], v[88:91], v[72:75], 0
    v_mfma_f32_16x16x32_bf16 v[60:63], v[88:91], v[76:79], 0
    s_waitcnt vmcnt(12)
    v_mfma_f32_16x16x32_bf16 v[16:19], v[108:111], v[92:95], v[16:19]
    v_mfma_f32_16x16x32_bf16 v[20:23], v[108:111], v[96:99], v[20:23]
    v_mfma_f32_16x16x32_bf16 v[24:27], v[108:111], v[100:103], v[24:27]
    v_mfma_f32_16x16x32_bf16 v[28:31], v[108:111], v[104:107], v[28:31]
    v_mfma_f32_16x16x32_bf16 v[32:35], v[112:115], v[92:95], v[32:35]
    v_mfma_f32_16x16x32_bf16 v[36:39], v[112:115], v[96:99], v[36:39]
    v_mfma_f32_16x16x32_bf16 v[40:43], v[112:115], v[100:103], v[40:43]
    v_mfma_f32_16x16x32_bf16 v[44:47], v[112:115], v[104:107], v[44:47]
    v_mfma_f32_16x16x32_bf16 v[48:51], v[116:119], v[92:95], v[48:51]
    v_mfma_f32_16x16x32_bf16 v[52:55], v[116:119], v[96:99], v[52:55]
    v_mfma_f32_16x16x32_bf16 v[56:59], v[116:119], v[100:103], v[56:59]
    v_mfma_f32_16x16x32_bf16 v[60:63], v[116:119], v[104:107], v[60:63]
    s_waitcnt vmcnt(5)
    v_mfma_f32_16x16x32_bf16 v[16:19], v[136:139], v[120:123], v[16:19]
    v_mfma_f32_16x16x32_bf16 v[20:23], v[136:139], v[124:127], v[20:23]
    v_mfma_f32_16x16x32_bf16 v[24:27], v[136:139], v[128:131], v[24:27]
    v_mfma_f32_16x16x32_bf16 v[28:31], v[136:139], v[132:135], v[28:31]
    v_mfma_f32_16x16x32_bf16 v[32:35], v[140:143], v[120:123], v[32:35]
    v_mfma_f32_16x16x32_bf16 v[36:39], v[140:143], v[124:127], v[36:39]
    v_mfma_f32_16x16x32_bf16 v[40:43], v[140:143], v[128:131], v[40:43]
    v_mfma_f32_16x16x32_bf16 v[44:47], v[140:143], v[132:135], v[44:47]
    v_mfma_f32_16x16x32_bf16 v[48:51], v[144:147], v[120:123], v[48:51]
    v_mfma_f32_16x16x32_bf16 v[52:55], v[144:147], v[124:127], v[52:55]
    v_mfma_f32_16x16x32_bf16 v[56:59], v[144:147], v[128:131], v[56:59]
    v_mfma_f32_16x16x32_bf16 v[60:63], v[144:147], v[132:135], v[60:63]
    s_mul_i32 s45, s44, 24576
    s_mul_i32 s46, s39, 12288
    s_add_u32 s45, s45, s46
    v_add_u32 v10, s45, v2
    ds_write_b128 v10, v[16:19] offset:0
    ds_write_b128 v10, v[20:23] offset:1024
    ds_write_b128 v10, v[24:27] offset:2048
    ds_write_b128 v10, v[28:31] offset:3072
    ds_write_b128 v10, v[32:35] offset:4096
    ds_write_b128 v10, v[36:39] offset:5120
    ds_write_b128 v10, v[40:43] offset:6144
    ds_write_b128 v10, v[44:47] offset:7168
    ds_write_b128 v10, v[48:51] offset:8192
    ds_write_b128 v10, v[52:55] offset:9216
    ds_write_b128 v10, v[56:59] offset:10240
    ds_write_b128 v10, v[60:63] offset:11264
    s_waitcnt lgkmcnt(0)
    s_barrier
    s_lshl_b32 s45, s38, 13
    s_and_b32 s46, s20, 3
    s_lshl_b32 s46, s46, 10
    s_add_u32 s45, s45, s46
    v_add_u32 v10, s45, v2
    v_add_u32 v11, 49152, v10
    v_add_u32 v12, 98304, v10
    ds_read_b128 v[64:67], v10 offset:0
    ds_read_b128 v[68:71], v10 offset:24576
    ds_read_b128 v[72:75], v11 offset:0
    ds_read_b128 v[76:79], v11 offset:24576
    ds_read_b128 v[80:83], v12 offset:0
    ds_read_b128 v[84:87], v12 offset:24576
    ds_read_b128 v[88:91], v10 offset:4096
    ds_read_b128 v[92:95], v10 offset:28672
    ds_read_b128 v[96:99], v11 offset:4096
    ds_read_b128 v[100:103], v11 offset:28672
    ds_read_b128 v[104:107], v12 offset:4096
    ds_read_b128 v[108:111], v12 offset:28672
    s_add_u32 s8, s4, 27529216
    s_addc_u32 s9, s5, 0
    s_mov_b32 s10, 2359296
    s_mov_b32 s11, 0x00020000
    s_add_u32 s12, s4, 29888512
    s_addc_u32 s13, s5, 0
    s_mov_b32 s14, 2359296
    s_mov_b32 s15, 0x00020000
    v_mov_b32 v13, 0
    v_mov_b32 v14, 0
    s_waitcnt vmcnt(0) lgkmcnt(0)
    v_add_f32 v64, v64, v68
    v_add_f32 v72, v72, v76
    v_add_f32 v80, v80, v84
    v_add_f32 v65, v65, v69
    v_add_f32 v73, v73, v77
    v_add_f32 v81, v81, v85
    v_add_f32 v66, v66, v70
    v_add_f32 v74, v74, v78
    v_add_f32 v82, v82, v86
    v_add_f32 v67, v67, v71
    v_add_f32 v75, v75, v79
    v_add_f32 v83, v83, v87
    v_add_f32 v64, v64, v72
    v_add_f32 v65, v65, v73
    v_add_f32 v66, v66, v74
    v_add_f32 v67, v67, v75
    v_add_f32 v64, v64, v80
    v_lshlrev_b32 v68, 16, v164
    v_add_f32 v65, v65, v81
    v_and_b32 v69, 0xffff0000, v164
    v_add_f32 v66, v66, v82
    v_lshlrev_b32 v70, 16, v165
    v_add_f32 v67, v67, v83
    v_and_b32 v71, 0xffff0000, v165
    v_fma_f32 v64, v64, v148, v68
    v_fma_f32 v65, v65, v149, v69
    v_fma_f32 v66, v66, v150, v70
    v_fma_f32 v67, v67, v151, v71
    v_cvt_pk_bf16_f32 v112, v64, v65
    v_cvt_pk_bf16_f32 v113, v66, v67
    v_lshlrev_b32 v68, 16, v112
    v_and_b32 v69, 0xffff0000, v112
    v_lshlrev_b32 v70, 16, v113
    v_and_b32 v71, 0xffff0000, v113
    v_add_f32 v13, v13, v68
    v_fmac_f32 v14, v68, v68
    v_mul_f32 v72, v68, v156
    v_add_f32 v13, v13, v69
    v_fmac_f32 v14, v69, v69
    v_mul_f32 v73, v69, v157
    v_add_f32 v13, v13, v70
    v_fmac_f32 v14, v70, v70
    v_mul_f32 v74, v70, v158
    v_add_f32 v13, v13, v71
    v_fmac_f32 v14, v71, v71
    v_mul_f32 v75, v71, v159
    v_cvt_pk_bf16_f32 v116, v72, v73
    v_cvt_pk_bf16_f32 v117, v74, v75
    v_add_f32 v88, v88, v92
    v_add_f32 v96, v96, v100
    v_add_f32 v104, v104, v108
    v_add_f32 v89, v89, v93
    v_add_f32 v97, v97, v101
    v_add_f32 v105, v105, v109
    v_add_f32 v90, v90, v94
    v_add_f32 v98, v98, v102
    v_add_f32 v106, v106, v110
    v_add_f32 v91, v91, v95
    v_add_f32 v99, v99, v103
    v_add_f32 v107, v107, v111
    v_add_f32 v88, v88, v96
    v_add_f32 v89, v89, v97
    v_add_f32 v90, v90, v98
    v_add_f32 v91, v91, v99
    v_add_f32 v88, v88, v104
    v_lshlrev_b32 v92, 16, v166
    v_add_f32 v89, v89, v105
    v_and_b32 v93, 0xffff0000, v166
    v_add_f32 v90, v90, v106
    v_lshlrev_b32 v94, 16, v167
    v_add_f32 v91, v91, v107
    v_and_b32 v95, 0xffff0000, v167
    v_fma_f32 v88, v88, v152, v92
    v_fma_f32 v89, v89, v153, v93
    v_fma_f32 v90, v90, v154, v94
    v_fma_f32 v91, v91, v155, v95
    v_cvt_pk_bf16_f32 v114, v88, v89
    v_cvt_pk_bf16_f32 v115, v90, v91
    v_lshlrev_b32 v92, 16, v114
    v_and_b32 v93, 0xffff0000, v114
    v_lshlrev_b32 v94, 16, v115
    v_and_b32 v95, 0xffff0000, v115
    v_add_f32 v13, v13, v92
    v_fmac_f32 v14, v92, v92
    v_mul_f32 v96, v92, v160
    v_add_f32 v13, v13, v93
    v_fmac_f32 v14, v93, v93
    v_mul_f32 v97, v93, v161
    v_add_f32 v13, v13, v94
    v_fmac_f32 v14, v94, v94
    v_mul_f32 v98, v94, v162
    v_add_f32 v13, v13, v95
    v_fmac_f32 v14, v95, v95
    v_mul_f32 v99, v95, v163
    v_cvt_pk_bf16_f32 v118, v96, v97
    v_cvt_pk_bf16_f32 v119, v98, v99
    buffer_store_dwordx4 v[112:115], v8, s[8:11], 0 offen sc1
    buffer_store_dwordx4 v[116:119], v8, s[12:15], 0 offen sc1
    v_mov_b32 v15, v13
    s_nop 1
    v_permlane16_swap_b32 v13, v15
    v_add_f32 v13, v13, v15
    v_mov_b32 v15, v13
    s_nop 1
    v_permlane32_swap_b32 v13, v15
    v_add_f32 v13, v13, v15
    v_mov_b32 v15, v14
    s_nop 1
    v_permlane16_swap_b32 v14, v15
    v_add_f32 v14, v14, v15
    v_mov_b32 v15, v14
    s_nop 1
    v_permlane32_swap_b32 v14, v15
    v_add_f32 v14, v14, v15
    v_and_b32 v15, 15, v1
    v_lshlrev_b32 v15, 3, v15
    s_and_b32 s46, s20, 3
    s_lshl_b32 s46, s46, 7
    s_add_u32 s46, s46, 147456
    v_add_u32 v15, s46, v15
    s_mov_b64 exec, 0xffff
    ds_add_f32 v15, v13
    ds_add_f32 v15, v14 offset:4
    s_mov_b64 exec, -1
    s_waitcnt lgkmcnt(0)
    s_barrier
    s_cmp_ge_u32 s20, 4
    s_cbranch_scc1 K34_NST
    s_add_u32 s8, s4, 32247808
    s_addc_u32 s9, s5, 0
    s_mov_b32 s10, 102400
    s_mov_b32 s11, 0x00020000
    ds_read_b64 v[120:121], v15
    s_mul_i32 s36, s34, 768
    s_lshl_b32 s37, s22, 3
    s_add_u32 s36, s36, s37
    v_and_b32 v12, 15, v1
    v_mul_u32_u24 v12, 48, v12
    s_waitcnt lgkmcnt(0)
    s_mov_b64 exec, 0xffff
    buffer_store_dwordx2 v[120:121], v12, s[8:11], s36 offen sc1
    s_mov_b64 exec, -1
K34_NST:
    s_waitcnt vmcnt(0)
    s_barrier
    s_cmp_lg_u32 s20, 0
    s_cbranch_scc1 K34_JOIN
    s_lshl_b32 s36, s21, 8
    v_mov_b32 v10, 0
    v_mov_b32 v11, 1
    s_mov_b64 exec, 1
    buffer_atomic_add v11, v10, s[40:43], s36 offen sc1
    s_mov_b64 exec, -1
    s_branch K34_JOIN
K34_UT:
    s_mul_i32 s36, s21, 9
    s_sub_u32 s37, s22, 6
    s_mul_i32 s44, s37, 5
    s_add_u32 s36, s36, s44
    s_add_u32 s36, s36, s20
    s_sub_u32 s44, 5, s37
    s_cmp_ge_u32 s20, s44
    s_cbranch_scc1 K34_UTD
    v_and_b32 v3, 15, v1
    v_lshrrev_b32 v4, 4, v1
    v_lshlrev_b32 v5, 4, v4
    s_add_u32 s8, s4, 7430144
    s_addc_u32 s9, s5, 0
    s_mov_b32 s10, 5308416
    s_mov_b32 s11, 0x00020000
    s_add_u32 s12, s4, 51224576
    s_addc_u32 s13, s5, 0
    s_mov_b32 s14, 18432
    s_mov_b32 s15, 0x00020000
    s_add_u32 s16, s4, 18046976
    s_addc_u32 s17, s5, 0
    s_mov_b32 s18, 36864
    s_mov_b32 s19, 0x00020000
    s_mul_i32 s44, s36, 171
    s_lshr_b32 s44, s44, 9
    s_mul_i32 s45, s44, 3
    s_sub_u32 s45, s36, s45
    s_mul_i32 s46, s44, 54
    s_add_u32 s46, s46, s45
    s_lshl_b32 s46, s46, 10
    s_add_u32 s47, s46, 0
    buffer_load_dwordx4 v[88:91], v2, s[8:11], s47 offen
    s_mov_b32 s47, 0
    buffer_load_dwordx4 v[16:19], v2, s[12:15], s47 offen
    s_add_u32 s47, s46, 3072
    buffer_load_dwordx4 v[92:95], v2, s[8:11], s47 offen
    s_mov_b32 s47, 1024
    buffer_load_dwordx4 v[20:23], v2, s[12:15], s47 offen
    s_add_u32 s47, s46, 6144
    buffer_load_dwordx4 v[96:99], v2, s[8:11], s47 offen
    s_mov_b32 s47, 2048
    buffer_load_dwordx4 v[24:27], v2, s[12:15], s47 offen
    s_add_u32 s47, s46, 9216
    buffer_load_dwordx4 v[100:103], v2, s[8:11], s47 offen
    s_mov_b32 s47, 3072
    buffer_load_dwordx4 v[28:31], v2, s[12:15], s47 offen
    s_add_u32 s47, s46, 12288
    buffer_load_dwordx4 v[104:107], v2, s[8:11], s47 offen
    s_mov_b32 s47, 4096
    buffer_load_dwordx4 v[32:35], v2, s[12:15], s47 offen
    s_add_u32 s47, s46, 15360
    buffer_load_dwordx4 v[108:111], v2, s[8:11], s47 offen
    s_mov_b32 s47, 5120
    buffer_load_dwordx4 v[36:39], v2, s[12:15], s47 offen
    s_add_u32 s47, s46, 18432
    buffer_load_dwordx4 v[112:115], v2, s[8:11], s47 offen
    s_mov_b32 s47, 6144
    buffer_load_dwordx4 v[40:43], v2, s[12:15], s47 offen
    s_add_u32 s47, s46, 21504
    buffer_load_dwordx4 v[116:119], v2, s[8:11], s47 offen
    s_mov_b32 s47, 7168
    buffer_load_dwordx4 v[44:47], v2, s[12:15], s47 offen
    s_add_u32 s47, s46, 24576
    buffer_load_dwordx4 v[120:123], v2, s[8:11], s47 offen
    s_mov_b32 s47, 8192
    buffer_load_dwordx4 v[48:51], v2, s[12:15], s47 offen
    s_add_u32 s47, s46, 27648
    buffer_load_dwordx4 v[124:127], v2, s[8:11], s47 offen
    s_mov_b32 s47, 9216
    buffer_load_dwordx4 v[52:55], v2, s[12:15], s47 offen
    s_add_u32 s47, s46, 30720
    buffer_load_dwordx4 v[128:131], v2, s[8:11], s47 offen
    s_mov_b32 s47, 10240
    buffer_load_dwordx4 v[56:59], v2, s[12:15], s47 offen
    s_add_u32 s47, s46, 33792
    buffer_load_dwordx4 v[132:135], v2, s[8:11], s47 offen
    s_mov_b32 s47, 11264
    buffer_load_dwordx4 v[60:63], v2, s[12:15], s47 offen
    s_add_u32 s47, s46, 36864
    buffer_load_dwordx4 v[136:139], v2, s[8:11], s47 offen
    s_mov_b32 s47, 12288
    buffer_load_dwordx4 v[64:67], v2, s[12:15], s47 offen
    s_add_u32 s47, s46, 39936
    buffer_load_dwordx4 v[140:143], v2, s[8:11], s47 offen
    s_mov_b32 s47, 13312
    buffer_load_dwordx4 v[68:71], v2, s[12:15], s47 offen
    s_add_u32 s47, s46, 43008
    buffer_load_dwordx4 v[144:147], v2, s[8:11], s47 offen
    s_mov_b32 s47, 14336
    buffer_load_dwordx4 v[72:75], v2, s[12:15], s47 offen
    s_add_u32 s47, s46, 46080
    buffer_load_dwordx4 v[148:151], v2, s[8:11], s47 offen
    s_mov_b32 s47, 15360
    buffer_load_dwordx4 v[76:79], v2, s[12:15], s47 offen
    s_add_u32 s47, s46, 49152
    buffer_load_dwordx4 v[152:155], v2, s[8:11], s47 offen
    s_mov_b32 s47, 16384
    buffer_load_dwordx4 v[80:83], v2, s[12:15], s47 offen
    s_add_u32 s47, s46, 52224
    buffer_load_dwordx4 v[156:159], v2, s[8:11], s47 offen
    s_mov_b32 s47, 17408
    buffer_load_dwordx4 v[84:87], v2, s[12:15], s47 offen
    s_waitcnt vmcnt(0)
    v_mfma_f32_16x16x32_bf16 v[8:11], v[88:91], v[16:19], 0
    v_mfma_f32_16x16x32_bf16 v[8:11], v[92:95], v[20:23], v[8:11]
    v_mfma_f32_16x16x32_bf16 v[8:11], v[96:99], v[24:27], v[8:11]
    v_mfma_f32_16x16x32_bf16 v[8:11], v[100:103], v[28:31], v[8:11]
    v_mfma_f32_16x16x32_bf16 v[8:11], v[104:107], v[32:35], v[8:11]
    v_mfma_f32_16x16x32_bf16 v[8:11], v[108:111], v[36:39], v[8:11]
    v_mfma_f32_16x16x32_bf16 v[8:11], v[112:115], v[40:43], v[8:11]
    v_mfma_f32_16x16x32_bf16 v[8:11], v[116:119], v[44:47], v[8:11]
    v_mfma_f32_16x16x32_bf16 v[8:11], v[120:123], v[48:51], v[8:11]
    v_mfma_f32_16x16x32_bf16 v[8:11], v[124:127], v[52:55], v[8:11]
    v_mfma_f32_16x16x32_bf16 v[8:11], v[128:131], v[56:59], v[8:11]
    v_mfma_f32_16x16x32_bf16 v[8:11], v[132:135], v[60:63], v[8:11]
    v_mfma_f32_16x16x32_bf16 v[8:11], v[136:139], v[64:67], v[8:11]
    v_mfma_f32_16x16x32_bf16 v[8:11], v[140:143], v[68:71], v[8:11]
    v_mfma_f32_16x16x32_bf16 v[8:11], v[144:147], v[72:75], v[8:11]
    v_mfma_f32_16x16x32_bf16 v[8:11], v[148:151], v[76:79], v[8:11]
    v_mfma_f32_16x16x32_bf16 v[8:11], v[152:155], v[80:83], v[8:11]
    v_mfma_f32_16x16x32_bf16 v[8:11], v[156:159], v[84:87], v[8:11]
    s_mov_b32 s47, 18432
    v_mul_lo_u32 v7, v3, s47
    v_lshl_add_u32 v7, v4, 4, v7
    s_lshl_b32 s47, s36, 6
    v_cmp_gt_u32 vcc, 2, v3
    s_nop 0
    s_and_saveexec_b64 s[48:49], vcc
    s_nop 0
    buffer_store_dwordx4 v[8:11], v7, s[16:19], s47 offen sc1
    s_mov_b64 exec, s[48:49]
K34_UTD:
    s_waitcnt vmcnt(0)
    s_barrier
    s_cmp_lg_u32 s20, 0
    s_cbranch_scc1 K34_JOIN
    s_lshr_b32 s44, s21, 2
    s_lshl_b32 s44, s44, 8
    s_add_u32 s44, s44, 8192
    v_mov_b32 v10, 0
    v_mov_b32 v11, 1
    s_mov_b64 exec, 1
    buffer_atomic_add v11, v10, s[40:43], s44 offen sc1
    s_mov_b64 exec, -1
K34_JOIN:
    s_waitcnt vmcnt(0)
    s_mul_i32 s31, s22, 12
    s_add_u32 s31, s31, s20
    s_mul_i32 s31, s31, 55296
    s_add_u32 s8, s4, 7430144
    s_addc_u32 s9, s5, 0
    s_mov_b32 s10, 5308416
    s_mov_b32 s11, 0x00020000
    s_add_u32 s12, s4, 12738560
    s_addc_u32 s13, s5, 0
    s_mov_b32 s14, 5308416
    s_mov_b32 s15, 0x00020000
    s_cmp_lg_u32 s20, 0
    s_cbranch_scc1 K34_POLLD
    v_mov_b32 v10, 0
    s_lshl_b32 s36, s21, 8
    s_lshl_b32 s37, s22, 8
    s_add_u32 s37, s37, 8192
    s_mov_b32 s46, 0
K34_POLL:
    buffer_load_dword v11, v10, s[40:43], s36 offen sc1
    buffer_load_dword v12, v10, s[40:43], s37 offen sc1
    s_waitcnt vmcnt(0)
    v_readfirstlane_b32 s44, v11
    v_readfirstlane_b32 s45, v12
    s_cmp_lt_u32 s44, 6
    s_cbranch_scc1 K34_SLP
    s_cmp_ge_u32 s45, 8
    s_cbranch_scc1 K34_POLLD
K34_SLP:
    s_sleep 4
    s_add_u32 s46, s46, 1
    s_cmp_lt_u32 s46, 400000
    s_cbranch_scc1 K34_POLL
K34_POLLD:
    s_add_u32 s33, s31, 0
    buffer_load_dwordx4 v[64:67], v2, s[8:11], s33 offen offset:0
    buffer_load_dwordx4 v[68:71], v2, s[8:11], s33 offen offset:1024
    buffer_load_dwordx4 v[72:75], v2, s[8:11], s33 offen offset:2048
    buffer_load_dwordx4 v[76:79], v2, s[8:11], s33 offen offset:3072
    s_add_u32 s33, s31, 4096
    buffer_load_dwordx4 v[80:83], v2, s[8:11], s33 offen offset:0
    buffer_load_dwordx4 v[84:87], v2, s[8:11], s33 offen offset:1024
    buffer_load_dwordx4 v[88:91], v2, s[8:11], s33 offen offset:2048
    buffer_load_dwordx4 v[92:95], v2, s[8:11], s33 offen offset:3072
    s_add_u32 s33, s31, 8192
    buffer_load_dwordx4 v[96:99], v2, s[8:11], s33 offen offset:0
    s_barrier
    s_add_u32 s16, s4, 29888512
    s_addc_u32 s17, s5, 0
    s_mov_b32 s18, 2359296
    s_mov_b32 s19, 0x00020000
    s_add_u32 s24, s4, 18046976
    s_addc_u32 s25, s5, 0
    s_mov_b32 s26, 36864
    s_mov_b32 s27, 0x00020000
    s_add_u32 s48, s4, 32247808
    s_addc_u32 s49, s5, 0
    s_mov_b32 s50, 102400
    s_mov_b32 s51, 0x00020000
    s_and_b32 s28, s20, 3
    s_lshl_b32 s29, s21, 2
    s_add_u32 s29, s29, s28
    s_mul_i32 s29, s29, 18
    s_add_u32 s29, s29, s38
    s_lshl_b32 s29, s29, 10
    s_add_u32 s34, s29, 0
    buffer_load_dwordx4 v[16:19], v2, s[16:19], s34 offen sc1
    s_add_u32 s34, s29, 3072
    buffer_load_dwordx4 v[20:23], v2, s[16:19], s34 offen sc1
    s_add_u32 s34, s29, 6144
    buffer_load_dwordx4 v[24:27], v2, s[16:19], s34 offen sc1
    s_add_u32 s34, s29, 9216
    buffer_load_dwordx4 v[28:31], v2, s[16:19], s34 offen sc1
    s_add_u32 s34, s29, 12288
    buffer_load_dwordx4 v[32:35], v2, s[16:19], s34 offen sc1
    s_add_u32 s34, s29, 15360
    buffer_load_dwordx4 v[36:39], v2, s[16:19], s34 offen sc1
    s_movk_i32 s34, 144
    v_cmp_le_u32 vcc, s34, v0
    v_mov_b32 v10, 16128
    s_nop 0
    v_cndmask_b32 v10, 0, v10, vcc
    v_lshlrev_b32 v11, 4, v0
    v_add_u32 v10, v10, v11
    s_mul_i32 s35, s22, 2304
    s_movk_i32 s34, 288
    v_cmp_gt_u32 vcc, s34, v0
    v_mov_b32 v12, 0x7f000000
    s_nop 0
    v_cndmask_b32 v10, v12, v10, vcc
    buffer_load_dwordx4 v[40:43], v10, s[24:27], s35 offen sc1
    v_and_b32 v8, 15, v1
    v_mul_u32_u24 v9, 48, v8
    s_and_b32 s35, s20, 3
    s_lshl_b32 s36, s21, 2
    s_add_u32 s35, s35, s36
    s_mul_i32 s35, s35, 768
    buffer_load_dwordx4 v[44:47], v9, s[48:51], s35 offen offset:0 sc1
    buffer_load_dwordx4 v[48:51], v9, s[48:51], s35 offen offset:16 sc1
    buffer_load_dwordx4 v[52:55], v9, s[48:51], s35 offen offset:32 sc1
    s_lshl_b32 s30, s20, 10
    v_add_u32 v12, s30, v2
    v_add_u32 v13, 36864, v12
    s_waitcnt vmcnt(0)
    ds_write_b128 v12, v[16:19] offset:0
    ds_write_b128 v12, v[20:23] offset:12288
    ds_write_b128 v12, v[24:27] offset:24576
    ds_write_b128 v13, v[28:31] offset:0
    ds_write_b128 v13, v[32:35] offset:12288
    ds_write_b128 v13, v[36:39] offset:24576
    s_movk_i32 s34, 288
    v_cmp_gt_u32 vcc, s34, v0
    s_nop 0
    s_and_saveexec_b64 s[44:45], vcc
    v_add_u32 v11, 147456, v11
    ds_write_b128 v11, v[40:43]
    s_mov_b64 exec, s[44:45]
    v_add_f32 v44, v44, v46
    v_add_f32 v45, v45, v47
    v_add_f32 v44, v44, v48
    v_add_f32 v45, v45, v49
    v_add_f32 v44, v44, v50
    v_add_f32 v45, v45, v51
    v_add_f32 v44, v44, v52
    v_add_f32 v45, v45, v53
    v_add_f32 v44, v44, v54
    v_add_f32 v45, v45, v55
    v_mul_f32 v44, 0x3ae38e39, v44
    v_mul_f32 v45, 0x3ae38e39, v45
    v_fma_f32 v45, -v44, v44, v45
    v_max_f32 v45, 0, v45
    v_add_f32 v45, 0x3727c5ac, v45
    v_rsq_f32 v45, v45
    s_nop 0
    v_mul_f32 v46, 0x3fb8aa3b, v45
    v_mul_f32 v47, v46, v44
    v_lshlrev_b32 v8, 3, v8
    s_and_b32 s35, s20, 3
    s_lshl_b32 s35, s35, 7
    s_add_u32 s35, s35, 152064
    v_add_u32 v8, s35, v8
    ds_write_b64 v8, v[46:47]
    s_waitcnt lgkmcnt(0)
    s_barrier
    s_cmp_lt_u32 s20, 4
    s_cbranch_scc1 K4_PA
    s_cmp_lt_u32 s20, 8
    s_cbranch_scc1 K4_PB
    s_setprio 1
    s_branch K4_PD
K4_PB:
    s_setprio 2
    s_branch K4_PD
K4_PA:
    s_setprio 3
K4_PD:
    v_mov_b32 v3, v2
    v_add_u32 v4, 36864, v2
    v_add_u32 v5, 73728, v2
    v_add_u32 v6, 110592, v2
    ds_read_b128 v[136:139], v3 offset:0
    ds_read_b128 v[140:143], v3 offset:1024
    ds_read_b128 v[144:147], v3 offset:2048
    ds_read_b128 v[148:151], v3 offset:3072
    ds_read_b128 v[152:155], v3 offset:4096
    ds_read_b128 v[156:159], v3 offset:5120
    ds_read_b128 v[160:163], v3 offset:6144
    ds_read_b128 v[164:167], v3 offset:7168
    s_waitcnt vmcnt(16) lgkmcnt(4)
    v_mfma_f32_16x16x32_bf16 v[16:19], v[64:67], v[136:139], 0
    v_mfma_f32_16x16x32_bf16 v[20:23], v[64:67], v[140:143], 0
    v_mfma_f32_16x16x32_bf16 v[24:27], v[64:67], v[144:147], 0
    v_mfma_f32_16x16x32_bf16 v[28:31], v[64:67], v[148:151], 0
    buffer_load_dwordx4 v[100:103], v2, s[8:11], s33 offen offset:1024
    buffer_load_dwordx4 v[104:107], v2, s[8:11], s33 offen offset:2048
    v_mfma_f32_16x16x32_bf16 v[32:35], v[68:71], v[136:139], 0
    v_mfma_f32_16x16x32_bf16 v[36:39], v[68:71], v[140:143], 0
    v_mfma_f32_16x16x32_bf16 v[40:43], v[68:71], v[144:147], 0
    v_mfma_f32_16x16x32_bf16 v[44:47], v[68:71], v[148:151], 0
    buffer_load_dwordx4 v[108:111], v2, s[8:11], s33 offen offset:3072
    s_add_u32 s33, s31, 12288
    buffer_load_dwordx4 v[112:115], v2, s[8:11], s33 offen offset:0
    v_mfma_f32_16x16x32_bf16 v[48:51], v[72:75], v[136:139], 0
    v_mfma_f32_16x16x32_bf16 v[52:55], v[72:75], v[140:143], 0
    v_mfma_f32_16x16x32_bf16 v[56:59], v[72:75], v[144:147], 0
    v_mfma_f32_16x16x32_bf16 v[60:63], v[72:75], v[148:151], 0
    buffer_load_dwordx4 v[116:119], v2, s[8:11], s33 offen offset:1024
    buffer_load_dwordx4 v[120:123], v2, s[8:11], s33 offen offset:2048
    ds_read_b128 v[136:139], v3 offset:8192
    ds_read_b128 v[140:143], v3 offset:9216
    ds_read_b128 v[144:147], v3 offset:10240
    ds_read_b128 v[148:151], v3 offset:11264
    s_waitcnt vmcnt(19) lgkmcnt(4)
    v_mfma_f32_16x16x32_bf16 v[16:19], v[76:79], v[152:155], v[16:19]
    v_mfma_f32_16x16x32_bf16 v[20:23], v[76:79], v[156:159], v[20:23]
    v_mfma_f32_16x16x32_bf16 v[24:27], v[76:79], v[160:163], v[24:27]
    v_mfma_f32_16x16x32_bf16 v[28:31], v[76:79], v[164:167], v[28:31]
    buffer_load_dwordx4 v[124:127], v2, s[8:11], s33 offen offset:3072
    s_add_u32 s33, s31, 16384
    buffer_load_dwordx4 v[128:131], v2, s[8:11], s33 offen offset:0
    v_mfma_f32_16x16x32_bf16 v[32:35], v[80:83], v[152:155], v[32:35]
    v_mfma_f32_16x16x32_bf16 v[36:39], v[80:83], v[156:159], v[36:39]
    v_mfma_f32_16x16x32_bf16 v[40:43], v[80:83], v[160:163], v[40:43]
    v_mfma_f32_16x16x32_bf16 v[44:47], v[80:83], v[164:167], v[44:47]
    buffer_load_dwordx4 v[132:135], v2, s[8:11], s33 offen offset:1024
    buffer_load_dwordx4 v[64:67], v2, s[8:11], s33 offen offset:2048
    v_mfma_f32_16x16x32_bf16 v[48:51], v[84:87], v[152:155], v[48:51]
    v_mfma_f32_16x16x32_bf16 v[52:55], v[84:87], v[156:159], v[52:55]
    v_mfma_f32_16x16x32_bf16 v[56:59], v[84:87], v[160:163], v[56:59]
    v_mfma_f32_16x16x32_bf16 v[60:63], v[84:87], v[164:167], v[60:63]
    buffer_load_dwordx4 v[68:71], v2, s[8:11], s33 offen offset:3072
    s_add_u32 s33, s31, 20480
    buffer_load_dwordx4 v[72:75], v2, s[8:11], s33 offen offset:0
    ds_read_b128 v[152:155], v3 offset:12288
    ds_read_b128 v[156:159], v3 offset:13312
    ds_read_b128 v[160:163], v3 offset:14336
    ds_read_b128 v[164:167], v3 offset:15360
    s_waitcnt vmcnt(22) lgkmcnt(4)
    v_mfma_f32_16x16x32_bf16 v[16:19], v[88:91], v[136:139], v[16:19]
    v_mfma_f32_16x16x32_bf16 v[20:23], v[88:91], v[140:143], v[20:23]
    v_mfma_f32_16x16x32_bf16 v[24:27], v[88:91], v[144:147], v[24:27]
    v_mfma_f32_16x16x32_bf16 v[28:31], v[88:91], v[148:151], v[28:31]
    buffer_load_dwordx4 v[76:79], v2, s[8:11], s33 offen offset:1024
    buffer_load_dwordx4 v[80:83], v2, s[8:11], s33 offen offset:2048
    v_mfma_f32_16x16x32_bf16 v[32:35], v[92:95], v[136:139], v[32:35]
    v_mfma_f32_16x16x32_bf16 v[36:39], v[92:95], v[140:143], v[36:39]
    v_mfma_f32_16x16x32_bf16 v[40:43], v[92:95], v[144:147], v[40:43]
    v_mfma_f32_16x16x32_bf16 v[44:47], v[92:95], v[148:151], v[44:47]
    buffer_load_dwordx4 v[84:87], v2, s[8:11], s33 offen offset:3072
    s_add_u32 s33, s31, 24576
    buffer_load_dwordx4 v[88:91], v2, s[8:11], s33 offen offset:0
    v_mfma_f32_16x16x32_bf16 v[48:51], v[96:99], v[136:139], v[48:51]
    v_mfma_f32_16x16x32_bf16 v[52:55], v[96:99], v[140:143], v[52:55]
    v_mfma_f32_16x16x32_bf16 v[56:59], v[96:99], v[144:147], v[56:59]
    v_mfma_f32_16x16x32_bf16 v[60:63], v[96:99], v[148:151], v[60:63]
    buffer_load_dwordx4 v[92:95], v2, s[8:11], s33 offen offset:1024
    buffer_load_dwordx4 v[96:99], v2, s[8:11], s33 offen offset:2048
    ds_read_b128 v[136:139], v3 offset:16384
    ds_read_b128 v[140:143], v3 offset:17408
    ds_read_b128 v[144:147], v3 offset:18432
    ds_read_b128 v[148:151], v3 offset:19456
    s_waitcnt vmcnt(15) lgkmcnt(4)
    v_mfma_f32_16x16x32_bf16 v[16:19], v[100:103], v[152:155], v[16:19]
    v_mfma_f32_16x16x32_bf16 v[20:23], v[100:103], v[156:159], v[20:23]
    v_mfma_f32_16x16x32_bf16 v[24:27], v[100:103], v[160:163], v[24:27]
    v_mfma_f32_16x16x32_bf16 v[28:31], v[100:103], v[164:167], v[28:31]
    buffer_load_dwordx4 v[100:103], v2, s[8:11], s33 offen offset:3072
    v_mfma_f32_16x16x32_bf16 v[32:35], v[104:107], v[152:155], v[32:35]
    v_mfma_f32_16x16x32_bf16 v[36:39], v[104:107], v[156:159], v[36:39]
    v_mfma_f32_16x16x32_bf16 v[40:43], v[104:107], v[160:163], v[40:43]
    v_mfma_f32_16x16x32_bf16 v[44:47], v[104:107], v[164:167], v[44:47]
    s_add_u32 s33, s31, 28672
    buffer_load_dwordx4 v[104:107], v2, s[8:11], s33 offen offset:0
    v_mfma_f32_16x16x32_bf16 v[48:51], v[108:111], v[152:155], v[48:51]
    v_mfma_f32_16x16x32_bf16 v[52:55], v[108:111], v[156:159], v[52:55]
    v_mfma_f32_16x16x32_bf16 v[56:59], v[108:111], v[160:163], v[56:59]
    v_mfma_f32_16x16x32_bf16 v[60:63], v[108:111], v[164:167], v[60:63]
    buffer_load_dwordx4 v[108:111], v2, s[8:11], s33 offen offset:1024
    ds_read_b128 v[152:155], v3 offset:20480
    ds_read_b128 v[156:159], v3 offset:21504
    ds_read_b128 v[160:163], v3 offset:22528
    ds_read_b128 v[164:167], v3 offset:23552
    s_waitcnt vmcnt(15) lgkmcnt(4)
    v_mfma_f32_16x16x32_bf16 v[16:19], v[112:115], v[136:139], v[16:19]
    v_mfma_f32_16x16x32_bf16 v[20:23], v[112:115], v[140:143], v[20:23]
    v_mfma_f32_16x16x32_bf16 v[24:27], v[112:115], v[144:147], v[24:27]
    v_mfma_f32_16x16x32_bf16 v[28:31], v[112:115], v[148:151], v[28:31]
    buffer_load_dwordx4 v[112:115], v2, s[8:11], s33 offen offset:2048
    v_mfma_f32_16x16x32_bf16 v[32:35], v[116:119], v[136:139], v[32:35]
    v_mfma_f32_16x16x32_bf16 v[36:39], v[116:119], v[140:143], v[36:39]
    v_mfma_f32_16x16x32_bf16 v[40:43], v[116:119], v[144:147], v[40:43]
    v_mfma_f32_16x16x32_bf16 v[44:47], v[116:119], v[148:151], v[44:47]
    buffer_load_dwordx4 v[116:119], v2, s[8:11], s33 offen offset:3072
    v_mfma_f32_16x16x32_bf16 v[48:51], v[120:123], v[136:139], v[48:51]
    v_mfma_f32_16x16x32_bf16 v[52:55], v[120:123], v[140:143], v[52:55]
    v_mfma_f32_16x16x32_bf16 v[56:59], v[120:123], v[144:147], v[56:59]
    v_mfma_f32_16x16x32_bf16 v[60:63], v[120:123], v[148:151], v[60:63]
    s_add_u32 s33, s31, 32768
    buffer_load_dwordx4 v[120:123], v2, s[8:11], s33 offen offset:0
    ds_read_b128 v[136:139], v3 offset:24576
    ds_read_b128 v[140:143], v3 offset:25600
    ds_read_b128 v[144:147], v3 offset:26624
    ds_read_b128 v[148:151], v3 offset:27648
    s_waitcnt vmcnt(15) lgkmcnt(4)
    v_mfma_f32_16x16x32_bf16 v[16:19], v[124:127], v[152:155], v[16:19]
    v_mfma_f32_16x16x32_bf16 v[20:23], v[124:127], v[156:159], v[20:23]
    v_mfma_f32_16x16x32_bf16 v[24:27], v[124:127], v[160:163], v[24:27]
    v_mfma_f32_16x16x32_bf16 v[28:31], v[124:127], v[164:167], v[28:31]
    buffer_load_dwordx4 v[124:127], v2, s[8:11], s33 offen offset:1024
    v_mfma_f32_16x16x32_bf16 v[32:35], v[128:131], v[152:155], v[32:35]
    v_mfma_f32_16x16x32_bf16 v[36:39], v[128:131], v[156:159], v[36:39]
    v_mfma_f32_16x16x32_bf16 v[40:43], v[128:131], v[160:163], v[40:43]
    v_mfma_f32_16x16x32_bf16 v[44:47], v[128:131], v[164:167], v[44:47]
    buffer_load_dwordx4 v[128:131], v2, s[8:11], s33 offen offset:2048
    v_mfma_f32_16x16x32_bf16 v[48:51], v[132:135], v[152:155], v[48:51]
    v_mfma_f32_16x16x32_bf16 v[52:55], v[132:135], v[156:159], v[52:55]
    v_mfma_f32_16x16x32_bf16 v[56:59], v[132:135], v[160:163], v[56:59]
    v_mfma_f32_16x16x32_bf16 v[60:63], v[132:135], v[164:167], v[60:63]
    buffer_load_dwordx4 v[132:135], v2, s[8:11], s33 offen offset:3072
    ds_read_b128 v[152:155], v3 offset:28672
    ds_read_b128 v[156:159], v3 offset:29696
    ds_read_b128 v[160:163], v3 offset:30720
    ds_read_b128 v[164:167], v3 offset:31744
    s_waitcnt vmcnt(15) lgkmcnt(4)
    v_mfma_f32_16x16x32_bf16 v[16:19], v[64:67], v[136:139], v[16:19]
    v_mfma_f32_16x16x32_bf16 v[20:23], v[64:67], v[140:143], v[20:23]
    v_mfma_f32_16x16x32_bf16 v[24:27], v[64:67], v[144:147], v[24:27]
    v_mfma_f32_16x16x32_bf16 v[28:31], v[64:67], v[148:151], v[28:31]
    s_add_u32 s33, s31, 36864
    buffer_load_dwordx4 v[64:67], v2, s[8:11], s33 offen offset:0
    v_mfma_f32_16x16x32_bf16 v[32:35], v[68:71], v[136:139], v[32:35]
    v_mfma_f32_16x16x32_bf16 v[36:39], v[68:71], v[140:143], v[36:39]
    v_mfma_f32_16x16x32_bf16 v[40:43], v[68:71], v[144:147], v[40:43]
    v_mfma_f32_16x16x32_bf16 v[44:47], v[68:71], v[148:151], v[44:47]
    buffer_load_dwordx4 v[68:71], v2, s[8:11], s33 offen offset:1024
    v_mfma_f32_16x16x32_bf16 v[48:51], v[72:75], v[136:139], v[48:51]
    v_mfma_f32_16x16x32_bf16 v[52:55], v[72:75], v[140:143], v[52:55]
    v_mfma_f32_16x16x32_bf16 v[56:59], v[72:75], v[144:147], v[56:59]
    v_mfma_f32_16x16x32_bf16 v[60:63], v[72:75], v[148:151], v[60:63]
    buffer_load_dwordx4 v[72:75], v2, s[8:11], s33 offen offset:2048
    ds_read_b128 v[136:139], v3 offset:32768
    ds_read_b128 v[140:143], v3 offset:33792
    ds_read_b128 v[144:147], v3 offset:34816
    ds_read_b128 v[148:151], v3 offset:35840
    s_waitcnt vmcnt(15) lgkmcnt(4)
    v_mfma_f32_16x16x32_bf16 v[16:19], v[76:79], v[152:155], v[16:19]
    v_mfma_f32_16x16x32_bf16 v[20:23], v[76:79], v[156:159], v[20:23]
    v_mfma_f32_16x16x32_bf16 v[24:27], v[76:79], v[160:163], v[24:27]
    v_mfma_f32_16x16x32_bf16 v[28:31], v[76:79], v[164:167], v[28:31]
    buffer_load_dwordx4 v[76:79], v2, s[8:11], s33 offen offset:3072
    v_mfma_f32_16x16x32_bf16 v[32:35], v[80:83], v[152:155], v[32:35]
    v_mfma_f32_16x16x32_bf16 v[36:39], v[80:83], v[156:159], v[36:39]
    v_mfma_f32_16x16x32_bf16 v[40:43], v[80:83], v[160:163], v[40:43]
    v_mfma_f32_16x16x32_bf16 v[44:47], v[80:83], v[164:167], v[44:47]
    s_add_u32 s33, s31, 40960
    buffer_load_dwordx4 v[80:83], v2, s[8:11], s33 offen offset:0
    v_mfma_f32_16x16x32_bf16 v[48:51], v[84:87], v[152:155], v[48:51]
    v_mfma_f32_16x16x32_bf16 v[52:55], v[84:87], v[156:159], v[52:55]
    v_mfma_f32_16x16x32_bf16 v[56:59], v[84:87], v[160:163], v[56:59]
    v_mfma_f32_16x16x32_bf16 v[60:63], v[84:87], v[164:167], v[60:63]
    buffer_load_dwordx4 v[84:87], v2, s[8:11], s33 offen offset:1024
    ds_read_b128 v[152:155], v4 offset:0
    ds_read_b128 v[156:159], v4 offset:1024
    ds_read_b128 v[160:163], v4 offset:2048
    ds_read_b128 v[164:167], v4 offset:3072
    s_waitcnt vmcnt(15) lgkmcnt(4)
    v_mfma_f32_16x16x32_bf16 v[16:19], v[88:91], v[136:139], v[16:19]
    v_mfma_f32_16x16x32_bf16 v[20:23], v[88:91], v[140:143], v[20:23]
    v_mfma_f32_16x16x32_bf16 v[24:27], v[88:91], v[144:147], v[24:27]
    v_mfma_f32_16x16x32_bf16 v[28:31], v[88:91], v[148:151], v[28:31]
    buffer_load_dwordx4 v[88:91], v2, s[8:11], s33 offen offset:2048
    v_mfma_f32_16x16x32_bf16 v[32:35], v[92:95], v[136:139], v[32:35]
    v_mfma_f32_16x16x32_bf16 v[36:39], v[92:95], v[140:143], v[36:39]
    v_mfma_f32_16x16x32_bf16 v[40:43], v[92:95], v[144:147], v[40:43]
    v_mfma_f32_16x16x32_bf16 v[44:47], v[92:95], v[148:151], v[44:47]
    buffer_load_dwordx4 v[92:95], v2, s[8:11], s33 offen offset:3072
    v_mfma_f32_16x16x32_bf16 v[48:51], v[96:99], v[136:139], v[48:51]
    v_mfma_f32_16x16x32_bf16 v[52:55], v[96:99], v[140:143], v[52:55]
    v_mfma_f32_16x16x32_bf16 v[56:59], v[96:99], v[144:147], v[56:59]
    v_mfma_f32_16x16x32_bf16 v[60:63], v[96:99], v[148:151], v[60:63]
    s_add_u32 s33, s31, 45056
    buffer_load_dwordx4 v[96:99], v2, s[8:11], s33 offen offset:0
    ds_read_b128 v[136:139], v4 offset:4096
    ds_read_b128 v[140:143], v4 offset:5120
    ds_read_b128 v[144:147], v4 offset:6144
    ds_read_b128 v[148:151], v4 offset:7168
    s_waitcnt vmcnt(15) lgkmcnt(4)
    v_mfma_f32_16x16x32_bf16 v[16:19], v[100:103], v[152:155], v[16:19]
    v_mfma_f32_16x16x32_bf16 v[20:23], v[100:103], v[156:159], v[20:23]
    v_mfma_f32_16x16x32_bf16 v[24:27], v[100:103], v[160:163], v[24:27]
    v_mfma_f32_16x16x32_bf16 v[28:31], v[100:103], v[164:167], v[28:31]
    buffer_load_dwordx4 v[100:103], v2, s[8:11], s33 offen offset:1024
    v_mfma_f32_16x16x32_bf16 v[32:35], v[104:107], v[152:155], v[32:35]
    v_mfma_f32_16x16x32_bf16 v[36:39], v[104:107], v[156:159], v[36:39]
    v_mfma_f32_16x16x32_bf16 v[40:43], v[104:107], v[160:163], v[40:43]
    v_mfma_f32_16x16x32_bf16 v[44:47], v[104:107], v[164:167], v[44:47]
    buffer_load_dwordx4 v[104:107], v2, s[8:11], s33 offen offset:2048
    v_mfma_f32_16x16x32_bf16 v[48:51], v[108:111], v[152:155], v[48:51]
    v_mfma_f32_16x16x32_bf16 v[52:55], v[108:111], v[156:159], v[52:55]
    v_mfma_f32_16x16x32_bf16 v[56:59], v[108:111], v[160:163], v[56:59]
    v_mfma_f32_16x16x32_bf16 v[60:63], v[108:111], v[164:167], v[60:63]
    buffer_load_dwordx4 v[108:111], v2, s[8:11], s33 offen offset:3072
    ds_read_b128 v[152:155], v4 offset:8192
    ds_read_b128 v[156:159], v4 offset:9216
    ds_read_b128 v[160:163], v4 offset:10240
    ds_read_b128 v[164:167], v4 offset:11264
    s_waitcnt vmcnt(15) lgkmcnt(4)
    v_mfma_f32_16x16x32_bf16 v[16:19], v[112:115], v[136:139], v[16:19]
    v_mfma_f32_16x16x32_bf16 v[20:23], v[112:115], v[140:143], v[20:23]
    v_mfma_f32_16x16x32_bf16 v[24:27], v[112:115], v[144:147], v[24:27]
    v_mfma_f32_16x16x32_bf16 v[28:31], v[112:115], v[148:151], v[28:31]
    s_add_u32 s33, s31, 49152
    buffer_load_dwordx4 v[112:115], v2, s[8:11], s33 offen offset:0
    v_mfma_f32_16x16x32_bf16 v[32:35], v[116:119], v[136:139], v[32:35]
    v_mfma_f32_16x16x32_bf16 v[36:39], v[116:119], v[140:143], v[36:39]
    v_mfma_f32_16x16x32_bf16 v[40:43], v[116:119], v[144:147], v[40:43]
    v_mfma_f32_16x16x32_bf16 v[44:47], v[116:119], v[148:151], v[44:47]
    buffer_load_dwordx4 v[116:119], v2, s[8:11], s33 offen offset:1024
    v_mfma_f32_16x16x32_bf16 v[48:51], v[120:123], v[136:139], v[48:51]
    v_mfma_f32_16x16x32_bf16 v[52:55], v[120:123], v[140:143], v[52:55]
    v_mfma_f32_16x16x32_bf16 v[56:59], v[120:123], v[144:147], v[56:59]
    v_mfma_f32_16x16x32_bf16 v[60:63], v[120:123], v[148:151], v[60:63]
    buffer_load_dwordx4 v[120:123], v2, s[8:11], s33 offen offset:2048
    ds_read_b128 v[136:139], v4 offset:12288
    ds_read_b128 v[140:143], v4 offset:13312
    ds_read_b128 v[144:147], v4 offset:14336
    ds_read_b128 v[148:151], v4 offset:15360
    s_waitcnt vmcnt(15) lgkmcnt(4)
    v_mfma_f32_16x16x32_bf16 v[16:19], v[124:127], v[152:155], v[16:19]
    v_mfma_f32_16x16x32_bf16 v[20:23], v[124:127], v[156:159], v[20:23]
    v_mfma_f32_16x16x32_bf16 v[24:27], v[124:127], v[160:163], v[24:27]
    v_mfma_f32_16x16x32_bf16 v[28:31], v[124:127], v[164:167], v[28:31]
    buffer_load_dwordx4 v[124:127], v2, s[8:11], s33 offen offset:3072
    v_mfma_f32_16x16x32_bf16 v[32:35], v[128:131], v[152:155], v[32:35]
    v_mfma_f32_16x16x32_bf16 v[36:39], v[128:131], v[156:159], v[36:39]
    v_mfma_f32_16x16x32_bf16 v[40:43], v[128:131], v[160:163], v[40:43]
    v_mfma_f32_16x16x32_bf16 v[44:47], v[128:131], v[164:167], v[44:47]
    s_add_u32 s33, s31, 53248
    buffer_load_dwordx4 v[128:131], v2, s[8:11], s33 offen offset:0
    v_mfma_f32_16x16x32_bf16 v[48:51], v[132:135], v[152:155], v[48:51]
    v_mfma_f32_16x16x32_bf16 v[52:55], v[132:135], v[156:159], v[52:55]
    v_mfma_f32_16x16x32_bf16 v[56:59], v[132:135], v[160:163], v[56:59]
    v_mfma_f32_16x16x32_bf16 v[60:63], v[132:135], v[164:167], v[60:63]
    buffer_load_dwordx4 v[132:135], v2, s[8:11], s33 offen offset:1024
    ds_read_b128 v[152:155], v4 offset:16384
    ds_read_b128 v[156:159], v4 offset:17408
    ds_read_b128 v[160:163], v4 offset:18432
    ds_read_b128 v[164:167], v4 offset:19456
    s_waitcnt vmcnt(15) lgkmcnt(4)
    v_mfma_f32_16x16x32_bf16 v[16:19], v[64:67], v[136:139], v[16:19]
    v_mfma_f32_16x16x32_bf16 v[20:23], v[64:67], v[140:143], v[20:23]
    v_mfma_f32_16x16x32_bf16 v[24:27], v[64:67], v[144:147], v[24:27]
    v_mfma_f32_16x16x32_bf16 v[28:31], v[64:67], v[148:151], v[28:31]
    s_add_u32 s33, s31, 0
    buffer_load_dwordx4 v[64:67], v2, s[12:15], s33 offen offset:0
    v_mfma_f32_16x16x32_bf16 v[32:35], v[68:71], v[136:139], v[32:35]
    v_mfma_f32_16x16x32_bf16 v[36:39], v[68:71], v[140:143], v[36:39]
    v_mfma_f32_16x16x32_bf16 v[40:43], v[68:71], v[144:147], v[40:43]
    v_mfma_f32_16x16x32_bf16 v[44:47], v[68:71], v[148:151], v[44:47]
    buffer_load_dwordx4 v[68:71], v2, s[12:15], s33 offen offset:1024
    v_mfma_f32_16x16x32_bf16 v[48:51], v[72:75], v[136:139], v[48:51]
    v_mfma_f32_16x16x32_bf16 v[52:55], v[72:75], v[140:143], v[52:55]
    v_mfma_f32_16x16x32_bf16 v[56:59], v[72:75], v[144:147], v[56:59]
    v_mfma_f32_16x16x32_bf16 v[60:63], v[72:75], v[148:151], v[60:63]
    buffer_load_dwordx4 v[72:75], v2, s[12:15], s33 offen offset:2048
    ds_read_b128 v[136:139], v4 offset:20480
    ds_read_b128 v[140:143], v4 offset:21504
    ds_read_b128 v[144:147], v4 offset:22528
    ds_read_b128 v[148:151], v4 offset:23552
    s_waitcnt vmcnt(15) lgkmcnt(4)
    v_mfma_f32_16x16x32_bf16 v[16:19], v[76:79], v[152:155], v[16:19]
    v_mfma_f32_16x16x32_bf16 v[20:23], v[76:79], v[156:159], v[20:23]
    v_mfma_f32_16x16x32_bf16 v[24:27], v[76:79], v[160:163], v[24:27]
    v_mfma_f32_16x16x32_bf16 v[28:31], v[76:79], v[164:167], v[28:31]
    buffer_load_dwordx4 v[76:79], v2, s[12:15], s33 offen offset:3072
    v_mfma_f32_16x16x32_bf16 v[32:35], v[80:83], v[152:155], v[32:35]
    v_mfma_f32_16x16x32_bf16 v[36:39], v[80:83], v[156:159], v[36:39]
    v_mfma_f32_16x16x32_bf16 v[40:43], v[80:83], v[160:163], v[40:43]
    v_mfma_f32_16x16x32_bf16 v[44:47], v[80:83], v[164:167], v[44:47]
    s_add_u32 s33, s31, 4096
    buffer_load_dwordx4 v[80:83], v2, s[12:15], s33 offen offset:0
    v_mfma_f32_16x16x32_bf16 v[48:51], v[84:87], v[152:155], v[48:51]
    v_mfma_f32_16x16x32_bf16 v[52:55], v[84:87], v[156:159], v[52:55]
    v_mfma_f32_16x16x32_bf16 v[56:59], v[84:87], v[160:163], v[56:59]
    v_mfma_f32_16x16x32_bf16 v[60:63], v[84:87], v[164:167], v[60:63]
    buffer_load_dwordx4 v[84:87], v2, s[12:15], s33 offen offset:1024
    ds_read_b128 v[152:155], v4 offset:24576
    ds_read_b128 v[156:159], v4 offset:25600
    ds_read_b128 v[160:163], v4 offset:26624
    ds_read_b128 v[164:167], v4 offset:27648
    s_waitcnt vmcnt(15) lgkmcnt(4)
    v_mfma_f32_16x16x32_bf16 v[16:19], v[88:91], v[136:139], v[16:19]
    v_mfma_f32_16x16x32_bf16 v[20:23], v[88:91], v[140:143], v[20:23]
    v_mfma_f32_16x16x32_bf16 v[24:27], v[88:91], v[144:147], v[24:27]
    v_mfma_f32_16x16x32_bf16 v[28:31], v[88:91], v[148:151], v[28:31]
    buffer_load_dwordx4 v[88:91], v2, s[12:15], s33 offen offset:2048
    v_mfma_f32_16x16x32_bf16 v[32:35], v[92:95], v[136:139], v[32:35]
    v_mfma_f32_16x16x32_bf16 v[36:39], v[92:95], v[140:143], v[36:39]
    v_mfma_f32_16x16x32_bf16 v[40:43], v[92:95], v[144:147], v[40:43]
    v_mfma_f32_16x16x32_bf16 v[44:47], v[92:95], v[148:151], v[44:47]
    buffer_load_dwordx4 v[92:95], v2, s[12:15], s33 offen offset:3072
    v_mfma_f32_16x16x32_bf16 v[48:51], v[96:99], v[136:139], v[48:51]
    v_mfma_f32_16x16x32_bf16 v[52:55], v[96:99], v[140:143], v[52:55]
    v_mfma_f32_16x16x32_bf16 v[56:59], v[96:99], v[144:147], v[56:59]
    v_mfma_f32_16x16x32_bf16 v[60:63], v[96:99], v[148:151], v[60:63]
    s_add_u32 s33, s31, 8192
    buffer_load_dwordx4 v[96:99], v2, s[12:15], s33 offen offset:0
    ds_read_b128 v[136:139], v4 offset:28672
    ds_read_b128 v[140:143], v4 offset:29696
    ds_read_b128 v[144:147], v4 offset:30720
    ds_read_b128 v[148:151], v4 offset:31744
    s_waitcnt vmcnt(15) lgkmcnt(4)
    v_mfma_f32_16x16x32_bf16 v[16:19], v[100:103], v[152:155], v[16:19]
    v_mfma_f32_16x16x32_bf16 v[20:23], v[100:103], v[156:159], v[20:23]
    v_mfma_f32_16x16x32_bf16 v[24:27], v[100:103], v[160:163], v[24:27]
    v_mfma_f32_16x16x32_bf16 v[28:31], v[100:103], v[164:167], v[28:31]
    buffer_load_dwordx4 v[100:103], v2, s[12:15], s33 offen offset:1024
    v_mfma_f32_16x16x32_bf16 v[32:35], v[104:107], v[152:155], v[32:35]
    v_mfma_f32_16x16x32_bf16 v[36:39], v[104:107], v[156:159], v[36:39]
    v_mfma_f32_16x16x32_bf16 v[40:43], v[104:107], v[160:163], v[40:43]
    v_mfma_f32_16x16x32_bf16 v[44:47], v[104:107], v[164:167], v[44:47]
    buffer_load_dwordx4 v[104:107], v2, s[12:15], s33 offen offset:2048
    v_mfma_f32_16x16x32_bf16 v[48:51], v[108:111], v[152:155], v[48:51]
    v_mfma_f32_16x16x32_bf16 v[52:55], v[108:111], v[156:159], v[52:55]
    v_mfma_f32_16x16x32_bf16 v[56:59], v[108:111], v[160:163], v[56:59]
    v_mfma_f32_16x16x32_bf16 v[60:63], v[108:111], v[164:167], v[60:63]
    buffer_load_dwordx4 v[108:111], v2, s[12:15], s33 offen offset:3072
    ds_read_b128 v[152:155], v4 offset:32768
    ds_read_b128 v[156:159], v4 offset:33792
    ds_read_b128 v[160:163], v4 offset:34816
    ds_read_b128 v[164:167], v4 offset:35840
    s_waitcnt vmcnt(15) lgkmcnt(4)
    v_mfma_f32_16x16x32_bf16 v[16:19], v[112:115], v[136:139], v[16:19]
    v_mfma_f32_16x16x32_bf16 v[20:23], v[112:115], v[140:143], v[20:23]
    v_mfma_f32_16x16x32_bf16 v[24:27], v[112:115], v[144:147], v[24:27]
    v_mfma_f32_16x16x32_bf16 v[28:31], v[112:115], v[148:151], v[28:31]
    s_add_u32 s33, s31, 12288
    buffer_load_dwordx4 v[112:115], v2, s[12:15], s33 offen offset:0
    v_mfma_f32_16x16x32_bf16 v[32:35], v[116:119], v[136:139], v[32:35]
    v_mfma_f32_16x16x32_bf16 v[36:39], v[116:119], v[140:143], v[36:39]
    v_mfma_f32_16x16x32_bf16 v[40:43], v[116:119], v[144:147], v[40:43]
    v_mfma_f32_16x16x32_bf16 v[44:47], v[116:119], v[148:151], v[44:47]
    buffer_load_dwordx4 v[116:119], v2, s[12:15], s33 offen offset:1024
    v_mfma_f32_16x16x32_bf16 v[48:51], v[120:123], v[136:139], v[48:51]
    v_mfma_f32_16x16x32_bf16 v[52:55], v[120:123], v[140:143], v[52:55]
    v_mfma_f32_16x16x32_bf16 v[56:59], v[120:123], v[144:147], v[56:59]
    v_mfma_f32_16x16x32_bf16 v[60:63], v[120:123], v[148:151], v[60:63]
    buffer_load_dwordx4 v[120:123], v2, s[12:15], s33 offen offset:2048
    s_waitcnt vmcnt(15) lgkmcnt(0)
    v_mfma_f32_16x16x32_bf16 v[16:19], v[124:127], v[152:155], v[16:19]
    v_mfma_f32_16x16x32_bf16 v[20:23], v[124:127], v[156:159], v[20:23]
    v_mfma_f32_16x16x32_bf16 v[24:27], v[124:127], v[160:163], v[24:27]
    v_mfma_f32_16x16x32_bf16 v[28:31], v[124:127], v[164:167], v[28:31]
    buffer_load_dwordx4 v[124:127], v2, s[12:15], s33 offen offset:3072
    v_mfma_f32_16x16x32_bf16 v[32:35], v[128:131], v[152:155], v[32:35]
    v_mfma_f32_16x16x32_bf16 v[36:39], v[128:131], v[156:159], v[36:39]
    v_mfma_f32_16x16x32_bf16 v[40:43], v[128:131], v[160:163], v[40:43]
    v_mfma_f32_16x16x32_bf16 v[44:47], v[128:131], v[164:167], v[44:47]
    s_add_u32 s33, s31, 16384
    buffer_load_dwordx4 v[128:131], v2, s[12:15], s33 offen offset:0
    v_mfma_f32_16x16x32_bf16 v[48:51], v[132:135], v[152:155], v[48:51]
    v_mfma_f32_16x16x32_bf16 v[52:55], v[132:135], v[156:159], v[52:55]
    v_mfma_f32_16x16x32_bf16 v[56:59], v[132:135], v[160:163], v[56:59]
    v_mfma_f32_16x16x32_bf16 v[60:63], v[132:135], v[164:167], v[60:63]
    buffer_load_dwordx4 v[132:135], v2, s[12:15], s33 offen offset:1024
    s_mul_i32 s35, s20, 3
    v_lshrrev_b32 v14, 4, v1
    v_lshlrev_b32 v14, 4, v14
    s_mul_i32 s36, s20, 192
    s_add_u32 s36, s36, 147456
    v_add_u32 v7, s36, v14
    v_and_b32 v14, 15, v1
    v_lshlrev_b32 v14, 3, v14
    v_add_u32 v14, 152064, v14
    ds_read_b64 v[136:137], v14 offset:0
    ds_read_b64 v[138:139], v14 offset:128
    ds_read_b64 v[140:141], v14 offset:256
    ds_read_b64 v[142:143], v14 offset:384
    ds_read_b128 v[144:147], v7 offset:0
    ds_read_b128 v[148:151], v7 offset:2304
    ds_read_b128 v[152:155], v7 offset:64
    ds_read_b128 v[156:159], v7 offset:2368
    ds_read_b128 v[160:163], v7 offset:128
    ds_read_b128 v[164:167], v7 offset:2432
    s_add_u32 s36, s35, 0
    s_and_b32 s37, s36, 1
    s_lshr_b32 s36, s36, 1
    s_lshl_b32 s36, s36, 12
    s_lshl_b32 s37, s37, 3
    s_add_u32 s36, s36, s37
    v_add_u32 v7, s36, v5
    s_add_u32 s36, s35, 1
    s_and_b32 s37, s36, 1
    s_lshr_b32 s36, s36, 1
    s_lshl_b32 s36, s36, 12
    s_lshl_b32 s37, s37, 3
    s_add_u32 s36, s36, s37
    v_add_u32 v8, s36, v5
    s_add_u32 s36, s35, 2
    s_and_b32 s37, s36, 1
    s_lshr_b32 s36, s36, 1
    s_lshl_b32 s36, s36, 12
    s_lshl_b32 s37, s37, 3
    s_add_u32 s36, s36, s37
    v_add_u32 v9, s36, v5
    s_waitcnt lgkmcnt(0)
    v_mul_f32 v148, 0x3fb8aa3b, v148
    v_mul_f32 v149, 0x3fb8aa3b, v149
    v_mul_f32 v150, 0x3fb8aa3b, v150
    v_mul_f32 v151, 0x3fb8aa3b, v151
    v_fma_f32 v10, -v137, v144, v148
    v_fma_f32 v11, -v137, v145, v149
    v_fma_f32 v12, -v137, v146, v150
    v_fma_f32 v13, -v137, v147, v151
    v_fma_f32 v16, v16, v136, v10
    v_fma_f32 v17, v17, v136, v11
    v_fma_f32 v18, v18, v136, v12
    v_fma_f32 v19, v19, v136, v13
    v_exp_f32 v10, -v16
    v_exp_f32 v11, -v17
    v_exp_f32 v12, -v18
    v_exp_f32 v13, -v19
    v_add_f32 v10, 1.0, v10
    v_add_f32 v11, 1.0, v11
    v_add_f32 v12, 1.0, v12
    v_add_f32 v13, 1.0, v13
    v_rcp_f32 v10, v10
    v_rcp_f32 v11, v11
    v_rcp_f32 v12, v12
    v_rcp_f32 v13, v13
    v_mul_f32 v16, v16, v10
    v_mul_f32 v17, v17, v11
    v_mul_f32 v18, v18, v12
    v_mul_f32 v19, v19, v13
    v_cvt_pk_bf16_f32 v14, v16, v17
    v_cvt_pk_bf16_f32 v15, v18, v19
    ds_write_b64 v7, v[14:15] offset:0
    v_fma_f32 v10, -v139, v144, v148
    v_fma_f32 v11, -v139, v145, v149
    v_fma_f32 v12, -v139, v146, v150
    v_fma_f32 v13, -v139, v147, v151
    v_fma_f32 v20, v20, v138, v10
    v_fma_f32 v21, v21, v138, v11
    v_fma_f32 v22, v22, v138, v12
    v_fma_f32 v23, v23, v138, v13
    v_exp_f32 v10, -v20
    v_exp_f32 v11, -v21
    v_exp_f32 v12, -v22
    v_exp_f32 v13, -v23
    v_add_f32 v10, 1.0, v10
    v_add_f32 v11, 1.0, v11
    v_add_f32 v12, 1.0, v12
    v_add_f32 v13, 1.0, v13
    v_rcp_f32 v10, v10
    v_rcp_f32 v11, v11
    v_rcp_f32 v12, v12
    v_rcp_f32 v13, v13
    v_mul_f32 v20, v20, v10
    v_mul_f32 v21, v21, v11
    v_mul_f32 v22, v22, v12
    v_mul_f32 v23, v23, v13
    v_cvt_pk_bf16_f32 v14, v20, v21
    v_cvt_pk_bf16_f32 v15, v22, v23
    ds_write_b64 v7, v[14:15] offset:1024
    v_fma_f32 v10, -v141, v144, v148
    v_fma_f32 v11, -v141, v145, v149
    v_fma_f32 v12, -v141, v146, v150
    v_fma_f32 v13, -v141, v147, v151
    v_fma_f32 v24, v24, v140, v10
    v_fma_f32 v25, v25, v140, v11
    v_fma_f32 v26, v26, v140, v12
    v_fma_f32 v27, v27, v140, v13
    v_exp_f32 v10, -v24
    v_exp_f32 v11, -v25
    v_exp_f32 v12, -v26
    v_exp_f32 v13, -v27
    v_add_f32 v10, 1.0, v10
    v_add_f32 v11, 1.0, v11
    v_add_f32 v12, 1.0, v12
    v_add_f32 v13, 1.0, v13
    v_rcp_f32 v10, v10
    v_rcp_f32 v11, v11
    v_rcp_f32 v12, v12
    v_rcp_f32 v13, v13
    v_mul_f32 v24, v24, v10
    v_mul_f32 v25, v25, v11
    v_mul_f32 v26, v26, v12
    v_mul_f32 v27, v27, v13
    v_cvt_pk_bf16_f32 v14, v24, v25
    v_cvt_pk_bf16_f32 v15, v26, v27
    ds_write_b64 v7, v[14:15] offset:2048
    v_fma_f32 v10, -v143, v144, v148
    v_fma_f32 v11, -v143, v145, v149
    v_fma_f32 v12, -v143, v146, v150
    v_fma_f32 v13, -v143, v147, v151
    v_fma_f32 v28, v28, v142, v10
    v_fma_f32 v29, v29, v142, v11
    v_fma_f32 v30, v30, v142, v12
    v_fma_f32 v31, v31, v142, v13
    v_exp_f32 v10, -v28
    v_exp_f32 v11, -v29
    v_exp_f32 v12, -v30
    v_exp_f32 v13, -v31
    v_add_f32 v10, 1.0, v10
    v_add_f32 v11, 1.0, v11
    v_add_f32 v12, 1.0, v12
    v_add_f32 v13, 1.0, v13
    v_rcp_f32 v10, v10
    v_rcp_f32 v11, v11
    v_rcp_f32 v12, v12
    v_rcp_f32 v13, v13
    v_mul_f32 v28, v28, v10
    v_mul_f32 v29, v29, v11
    v_mul_f32 v30, v30, v12
    v_mul_f32 v31, v31, v13
    v_cvt_pk_bf16_f32 v14, v28, v29
    v_cvt_pk_bf16_f32 v15, v30, v31
    ds_write_b64 v7, v[14:15] offset:3072
    v_mul_f32 v156, 0x3fb8aa3b, v156
    v_mul_f32 v157, 0x3fb8aa3b, v157
    v_mul_f32 v158, 0x3fb8aa3b, v158
    v_mul_f32 v159, 0x3fb8aa3b, v159
    v_fma_f32 v10, -v137, v152, v156
    v_fma_f32 v11, -v137, v153, v157
    v_fma_f32 v12, -v137, v154, v158
    v_fma_f32 v13, -v137, v155, v159
    v_fma_f32 v32, v32, v136, v10
    v_fma_f32 v33, v33, v136, v11
    v_fma_f32 v34, v34, v136, v12
    v_fma_f32 v35, v35, v136, v13
    v_exp_f32 v10, -v32
    v_exp_f32 v11, -v33
    v_exp_f32 v12, -v34
    v_exp_f32 v13, -v35
    v_add_f32 v10, 1.0, v10
    v_add_f32 v11, 1.0, v11
    v_add_f32 v12, 1.0, v12
    v_add_f32 v13, 1.0, v13
    v_rcp_f32 v10, v10
    v_rcp_f32 v11, v11
    v_rcp_f32 v12, v12
    v_rcp_f32 v13, v13
    v_mul_f32 v32, v32, v10
    v_mul_f32 v33, v33, v11
    v_mul_f32 v34, v34, v12
    v_mul_f32 v35, v35, v13
    v_cvt_pk_bf16_f32 v14, v32, v33
    v_cvt_pk_bf16_f32 v15, v34, v35
    ds_write_b64 v8, v[14:15] offset:0
    v_fma_f32 v10, -v139, v152, v156
    v_fma_f32 v11, -v139, v153, v157
    v_fma_f32 v12, -v139, v154, v158
    v_fma_f32 v13, -v139, v155, v159
    v_fma_f32 v36, v36, v138, v10
    v_fma_f32 v37, v37, v138, v11
    v_fma_f32 v38, v38, v138, v12
    v_fma_f32 v39, v39, v138, v13
    v_exp_f32 v10, -v36
    v_exp_f32 v11, -v37
    v_exp_f32 v12, -v38
    v_exp_f32 v13, -v39
    v_add_f32 v10, 1.0, v10
    v_add_f32 v11, 1.0, v11
    v_add_f32 v12, 1.0, v12
    v_add_f32 v13, 1.0, v13
    v_rcp_f32 v10, v10
    v_rcp_f32 v11, v11
    v_rcp_f32 v12, v12
    v_rcp_f32 v13, v13
    v_mul_f32 v36, v36, v10
    v_mul_f32 v37, v37, v11
    v_mul_f32 v38, v38, v12
    v_mul_f32 v39, v39, v13
    v_cvt_pk_bf16_f32 v14, v36, v37
    v_cvt_pk_bf16_f32 v15, v38, v39
    ds_write_b64 v8, v[14:15] offset:1024
    v_fma_f32 v10, -v141, v152, v156
    v_fma_f32 v11, -v141, v153, v157
    v_fma_f32 v12, -v141, v154, v158
    v_fma_f32 v13, -v141, v155, v159
    v_fma_f32 v40, v40, v140, v10
    v_fma_f32 v41, v41, v140, v11
    v_fma_f32 v42, v42, v140, v12
    v_fma_f32 v43, v43, v140, v13
    v_exp_f32 v10, -v40
    v_exp_f32 v11, -v41
    v_exp_f32 v12, -v42
    v_exp_f32 v13, -v43
    v_add_f32 v10, 1.0, v10
    v_add_f32 v11, 1.0, v11
    v_add_f32 v12, 1.0, v12
    v_add_f32 v13, 1.0, v13
    v_rcp_f32 v10, v10
    v_rcp_f32 v11, v11
    v_rcp_f32 v12, v12
    v_rcp_f32 v13, v13
    v_mul_f32 v40, v40, v10
    v_mul_f32 v41, v41, v11
    v_mul_f32 v42, v42, v12
    v_mul_f32 v43, v43, v13
    v_cvt_pk_bf16_f32 v14, v40, v41
    v_cvt_pk_bf16_f32 v15, v42, v43
    ds_write_b64 v8, v[14:15] offset:2048
    v_fma_f32 v10, -v143, v152, v156
    v_fma_f32 v11, -v143, v153, v157
    v_fma_f32 v12, -v143, v154, v158
    v_fma_f32 v13, -v143, v155, v159
    v_fma_f32 v44, v44, v142, v10
    v_fma_f32 v45, v45, v142, v11
    v_fma_f32 v46, v46, v142, v12
    v_fma_f32 v47, v47, v142, v13
    v_exp_f32 v10, -v44
    v_exp_f32 v11, -v45
    v_exp_f32 v12, -v46
    v_exp_f32 v13, -v47
    v_add_f32 v10, 1.0, v10
    v_add_f32 v11, 1.0, v11
    v_add_f32 v12, 1.0, v12
    v_add_f32 v13, 1.0, v13
    v_rcp_f32 v10, v10
    v_rcp_f32 v11, v11
    v_rcp_f32 v12, v12
    v_rcp_f32 v13, v13
    v_mul_f32 v44, v44, v10
    v_mul_f32 v45, v45, v11
    v_mul_f32 v46, v46, v12
    v_mul_f32 v47, v47, v13
    v_cvt_pk_bf16_f32 v14, v44, v45
    v_cvt_pk_bf16_f32 v15, v46, v47
    ds_write_b64 v8, v[14:15] offset:3072
    v_mul_f32 v164, 0x3fb8aa3b, v164
    v_mul_f32 v165, 0x3fb8aa3b, v165
    v_mul_f32 v166, 0x3fb8aa3b, v166
    v_mul_f32 v167, 0x3fb8aa3b, v167
    v_fma_f32 v10, -v137, v160, v164
    v_fma_f32 v11, -v137, v161, v165
    v_fma_f32 v12, -v137, v162, v166
    v_fma_f32 v13, -v137, v163, v167
    v_fma_f32 v48, v48, v136, v10
    v_fma_f32 v49, v49, v136, v11
    v_fma_f32 v50, v50, v136, v12
    v_fma_f32 v51, v51, v136, v13
    v_exp_f32 v10, -v48
    v_exp_f32 v11, -v49
    v_exp_f32 v12, -v50
    v_exp_f32 v13, -v51
    v_add_f32 v10, 1.0, v10
    v_add_f32 v11, 1.0, v11
    v_add_f32 v12, 1.0, v12
    v_add_f32 v13, 1.0, v13
    v_rcp_f32 v10, v10
    v_rcp_f32 v11, v11
    v_rcp_f32 v12, v12
    v_rcp_f32 v13, v13
    v_mul_f32 v48, v48, v10
    v_mul_f32 v49, v49, v11
    v_mul_f32 v50, v50, v12
    v_mul_f32 v51, v51, v13
    v_cvt_pk_bf16_f32 v14, v48, v49
    v_cvt_pk_bf16_f32 v15, v50, v51
    ds_write_b64 v9, v[14:15] offset:0
    v_fma_f32 v10, -v139, v160, v164
    v_fma_f32 v11, -v139, v161, v165
    v_fma_f32 v12, -v139, v162, v166
    v_fma_f32 v13, -v139, v163, v167
    v_fma_f32 v52, v52, v138, v10
    v_fma_f32 v53, v53, v138, v11
    v_fma_f32 v54, v54, v138, v12
    v_fma_f32 v55, v55, v138, v13
    v_exp_f32 v10, -v52
    v_exp_f32 v11, -v53
    v_exp_f32 v12, -v54
    v_exp_f32 v13, -v55
    v_add_f32 v10, 1.0, v10
    v_add_f32 v11, 1.0, v11
    v_add_f32 v12, 1.0, v12
    v_add_f32 v13, 1.0, v13
    v_rcp_f32 v10, v10
    v_rcp_f32 v11, v11
    v_rcp_f32 v12, v12
    v_rcp_f32 v13, v13
    v_mul_f32 v52, v52, v10
    v_mul_f32 v53, v53, v11
    v_mul_f32 v54, v54, v12
    v_mul_f32 v55, v55, v13
    v_cvt_pk_bf16_f32 v14, v52, v53
    v_cvt_pk_bf16_f32 v15, v54, v55
    ds_write_b64 v9, v[14:15] offset:1024
    v_fma_f32 v10, -v141, v160, v164
    v_fma_f32 v11, -v141, v161, v165
    v_fma_f32 v12, -v141, v162, v166
    v_fma_f32 v13, -v141, v163, v167
    v_fma_f32 v56, v56, v140, v10
    v_fma_f32 v57, v57, v140, v11
    v_fma_f32 v58, v58, v140, v12
    v_fma_f32 v59, v59, v140, v13
    v_exp_f32 v10, -v56
    v_exp_f32 v11, -v57
    v_exp_f32 v12, -v58
    v_exp_f32 v13, -v59
    v_add_f32 v10, 1.0, v10
    v_add_f32 v11, 1.0, v11
    v_add_f32 v12, 1.0, v12
    v_add_f32 v13, 1.0, v13
    v_rcp_f32 v10, v10
    v_rcp_f32 v11, v11
    v_rcp_f32 v12, v12
    v_rcp_f32 v13, v13
    v_mul_f32 v56, v56, v10
    v_mul_f32 v57, v57, v11
    v_mul_f32 v58, v58, v12
    v_mul_f32 v59, v59, v13
    v_cvt_pk_bf16_f32 v14, v56, v57
    v_cvt_pk_bf16_f32 v15, v58, v59
    ds_write_b64 v9, v[14:15] offset:2048
    v_fma_f32 v10, -v143, v160, v164
    v_fma_f32 v11, -v143, v161, v165
    v_fma_f32 v12, -v143, v162, v166
    v_fma_f32 v13, -v143, v163, v167
    v_fma_f32 v60, v60, v142, v10
    v_fma_f32 v61, v61, v142, v11
    v_fma_f32 v62, v62, v142, v12
    v_fma_f32 v63, v63, v142, v13
    v_exp_f32 v10, -v60
    v_exp_f32 v11, -v61
    v_exp_f32 v12, -v62
    v_exp_f32 v13, -v63
    v_add_f32 v10, 1.0, v10
    v_add_f32 v11, 1.0, v11
    v_add_f32 v12, 1.0, v12
    v_add_f32 v13, 1.0, v13
    v_rcp_f32 v10, v10
    v_rcp_f32 v11, v11
    v_rcp_f32 v12, v12
    v_rcp_f32 v13, v13
    v_mul_f32 v60, v60, v10
    v_mul_f32 v61, v61, v11
    v_mul_f32 v62, v62, v12
    v_mul_f32 v63, v63, v13
    v_cvt_pk_bf16_f32 v14, v60, v61
    v_cvt_pk_bf16_f32 v15, v62, v63
    ds_write_b64 v9, v[14:15] offset:3072
    s_waitcnt lgkmcnt(0)
    s_lshl_b32 s36, s38, 2
    s_add_u32 s36, s36, 152576
    v_mov_b32 v10, s36
    v_mov_b32 v11, 1
    s_mov_b64 exec, 1
    ds_add_u32 v10, v11
    s_mov_b64 exec, -1
    s_setprio 0
    v_mov_b32 v10, 152576
K4_POLL_1:
    ds_read_b32 v11, v10
    s_waitcnt lgkmcnt(0)
    v_readfirstlane_b32 s36, v11
    s_nop 0
    s_cmp_ge_u32 s36, 4
    s_cbranch_scc1 K4_POLL_1_D
    s_sleep 2
    s_branch K4_POLL_1
K4_POLL_1_D:
    ds_read_b128 v[136:139], v5 offset:0
    ds_read_b128 v[140:143], v5 offset:1024
    ds_read_b128 v[144:147], v5 offset:2048
    ds_read_b128 v[148:151], v5 offset:3072
    ds_read_b128 v[152:155], v5 offset:4096
    ds_read_b128 v[156:159], v5 offset:5120
    ds_read_b128 v[160:163], v5 offset:6144
    ds_read_b128 v[164:167], v5 offset:7168
    s_waitcnt vmcnt(15) lgkmcnt(4)
    v_mfma_f32_16x16x32_bf16 v[16:19], v[64:67], v[136:139], 0
    v_mfma_f32_16x16x32_bf16 v[20:23], v[64:67], v[140:143], 0
    v_mfma_f32_16x16x32_bf16 v[24:27], v[64:67], v[144:147], 0
    v_mfma_f32_16x16x32_bf16 v[28:31], v[64:67], v[148:151], 0
    buffer_load_dwordx4 v[64:67], v2, s[12:15], s33 offen offset:2048
    v_mfma_f32_16x16x32_bf16 v[32:35], v[68:71], v[136:139], 0
    v_mfma_f32_16x16x32_bf16 v[36:39], v[68:71], v[140:143], 0
    v_mfma_f32_16x16x32_bf16 v[40:43], v[68:71], v[144:147], 0
    v_mfma_f32_16x16x32_bf16 v[44:47], v[68:71], v[148:151], 0
    buffer_load_dwordx4 v[68:71], v2, s[12:15], s33 offen offset:3072
    v_mfma_f32_16x16x32_bf16 v[48:51], v[72:75], v[136:139], 0
    v_mfma_f32_16x16x32_bf16 v[52:55], v[72:75], v[140:143], 0
    v_mfma_f32_16x16x32_bf16 v[56:59], v[72:75], v[144:147], 0
    v_mfma_f32_16x16x32_bf16 v[60:63], v[72:75], v[148:151], 0
    s_add_u32 s33, s31, 20480
    buffer_load_dwordx4 v[72:75], v2, s[12:15], s33 offen offset:0
    ds_read_b128 v[136:139], v5 offset:8192
    ds_read_b128 v[140:143], v5 offset:9216
    ds_read_b128 v[144:147], v5 offset:10240
    ds_read_b128 v[148:151], v5 offset:11264
    s_waitcnt vmcnt(15) lgkmcnt(4)
    v_mfma_f32_16x16x32_bf16 v[16:19], v[76:79], v[152:155], v[16:19]
    v_mfma_f32_16x16x32_bf16 v[20:23], v[76:79], v[156:159], v[20:23]
    v_mfma_f32_16x16x32_bf16 v[24:27], v[76:79], v[160:163], v[24:27]
    v_mfma_f32_16x16x32_bf16 v[28:31], v[76:79], v[164:167], v[28:31]
    buffer_load_dwordx4 v[76:79], v2, s[12:15], s33 offen offset:1024
    v_mfma_f32_16x16x32_bf16 v[32:35], v[80:83], v[152:155], v[32:35]
    v_mfma_f32_16x16x32_bf16 v[36:39], v[80:83], v[156:159], v[36:39]
    v_mfma_f32_16x16x32_bf16 v[40:43], v[80:83], v[160:163], v[40:43]
    v_mfma_f32_16x16x32_bf16 v[44:47], v[80:83], v[164:167], v[44:47]
    buffer_load_dwordx4 v[80:83], v2, s[12:15], s33 offen offset:2048
    v_mfma_f32_16x16x32_bf16 v[48:51], v[84:87], v[152:155], v[48:51]
    v_mfma_f32_16x16x32_bf16 v[52:55], v[84:87], v[156:159], v[52:55]
    v_mfma_f32_16x16x32_bf16 v[56:59], v[84:87], v[160:163], v[56:59]
    v_mfma_f32_16x16x32_bf16 v[60:63], v[84:87], v[164:167], v[60:63]
    buffer_load_dwordx4 v[84:87], v2, s[12:15], s33 offen offset:3072
    ds_read_b128 v[152:155], v5 offset:12288
    ds_read_b128 v[156:159], v5 offset:13312
    ds_read_b128 v[160:163], v5 offset:14336
    ds_read_b128 v[164:167], v5 offset:15360
    s_waitcnt vmcnt(15) lgkmcnt(4)
    v_mfma_f32_16x16x32_bf16 v[16:19], v[88:91], v[136:139], v[16:19]
    v_mfma_f32_16x16x32_bf16 v[20:23], v[88:91], v[140:143], v[20:23]
    v_mfma_f32_16x16x32_bf16 v[24:27], v[88:91], v[144:147], v[24:27]
    v_mfma_f32_16x16x32_bf16 v[28:31], v[88:91], v[148:151], v[28:31]
    s_add_u32 s33, s31, 24576
    buffer_load_dwordx4 v[88:91], v2, s[12:15], s33 offen offset:0
    v_mfma_f32_16x16x32_bf16 v[32:35], v[92:95], v[136:139], v[32:35]
    v_mfma_f32_16x16x32_bf16 v[36:39], v[92:95], v[140:143], v[36:39]
    v_mfma_f32_16x16x32_bf16 v[40:43], v[92:95], v[144:147], v[40:43]
    v_mfma_f32_16x16x32_bf16 v[44:47], v[92:95], v[148:151], v[44:47]
    buffer_load_dwordx4 v[92:95], v2, s[12:15], s33 offen offset:1024
    v_mfma_f32_16x16x32_bf16 v[48:51], v[96:99], v[136:139], v[48:51]
    v_mfma_f32_16x16x32_bf16 v[52:55], v[96:99], v[140:143], v[52:55]
    v_mfma_f32_16x16x32_bf16 v[56:59], v[96:99], v[144:147], v[56:59]
    v_mfma_f32_16x16x32_bf16 v[60:63], v[96:99], v[148:151], v[60:63]
    buffer_load_dwordx4 v[96:99], v2, s[12:15], s33 offen offset:2048
    ds_read_b128 v[136:139], v5 offset:16384
    ds_read_b128 v[140:143], v5 offset:17408
    ds_read_b128 v[144:147], v5 offset:18432
    ds_read_b128 v[148:151], v5 offset:19456
    s_waitcnt vmcnt(15) lgkmcnt(4)
    v_mfma_f32_16x16x32_bf16 v[16:19], v[100:103], v[152:155], v[16:19]
    v_mfma_f32_16x16x32_bf16 v[20:23], v[100:103], v[156:159], v[20:23]
    v_mfma_f32_16x16x32_bf16 v[24:27], v[100:103], v[160:163], v[24:27]
    v_mfma_f32_16x16x32_bf16 v[28:31], v[100:103], v[164:167], v[28:31]
    buffer_load_dwordx4 v[100:103], v2, s[12:15], s33 offen offset:3072
    v_mfma_f32_16x16x32_bf16 v[32:35], v[104:107], v[152:155], v[32:35]
    v_mfma_f32_16x16x32_bf16 v[36:39], v[104:107], v[156:159], v[36:39]
    v_mfma_f32_16x16x32_bf16 v[40:43], v[104:107], v[160:163], v[40:43]
    v_mfma_f32_16x16x32_bf16 v[44:47], v[104:107], v[164:167], v[44:47]
    s_add_u32 s33, s31, 28672
    buffer_load_dwordx4 v[104:107], v2, s[12:15], s33 offen offset:0
    v_mfma_f32_16x16x32_bf16 v[48:51], v[108:111], v[152:155], v[48:51]
    v_mfma_f32_16x16x32_bf16 v[52:55], v[108:111], v[156:159], v[52:55]
    v_mfma_f32_16x16x32_bf16 v[56:59], v[108:111], v[160:163], v[56:59]
    v_mfma_f32_16x16x32_bf16 v[60:63], v[108:111], v[164:167], v[60:63]
    buffer_load_dwordx4 v[108:111], v2, s[12:15], s33 offen offset:1024
    ds_read_b128 v[152:155], v5 offset:20480
    ds_read_b128 v[156:159], v5 offset:21504
    ds_read_b128 v[160:163], v5 offset:22528
    ds_read_b128 v[164:167], v5 offset:23552
    s_waitcnt vmcnt(15) lgkmcnt(4)
    v_mfma_f32_16x16x32_bf16 v[16:19], v[112:115], v[136:139], v[16:19]
    v_mfma_f32_16x16x32_bf16 v[20:23], v[112:115], v[140:143], v[20:23]
    v_mfma_f32_16x16x32_bf16 v[24:27], v[112:115], v[144:147], v[24:27]
    v_mfma_f32_16x16x32_bf16 v[28:31], v[112:115], v[148:151], v[28:31]
    buffer_load_dwordx4 v[112:115], v2, s[12:15], s33 offen offset:2048
    v_mfma_f32_16x16x32_bf16 v[32:35], v[116:119], v[136:139], v[32:35]
    v_mfma_f32_16x16x32_bf16 v[36:39], v[116:119], v[140:143], v[36:39]
    v_mfma_f32_16x16x32_bf16 v[40:43], v[116:119], v[144:147], v[40:43]
    v_mfma_f32_16x16x32_bf16 v[44:47], v[116:119], v[148:151], v[44:47]
    buffer_load_dwordx4 v[116:119], v2, s[12:15], s33 offen offset:3072
    v_mfma_f32_16x16x32_bf16 v[48:51], v[120:123], v[136:139], v[48:51]
    v_mfma_f32_16x16x32_bf16 v[52:55], v[120:123], v[140:143], v[52:55]
    v_mfma_f32_16x16x32_bf16 v[56:59], v[120:123], v[144:147], v[56:59]
    v_mfma_f32_16x16x32_bf16 v[60:63], v[120:123], v[148:151], v[60:63]
    s_add_u32 s33, s31, 32768
    buffer_load_dwordx4 v[120:123], v2, s[12:15], s33 offen offset:0
    v_mov_b32 v10, 152580
K4_POLL_2:
    ds_read_b32 v11, v10
    s_waitcnt lgkmcnt(0)
    v_readfirstlane_b32 s36, v11
    s_nop 0
    s_cmp_ge_u32 s36, 4
    s_cbranch_scc1 K4_POLL_2_D
    s_sleep 2
    s_branch K4_POLL_2
K4_POLL_2_D:
    ds_read_b128 v[136:139], v5 offset:24576
    ds_read_b128 v[140:143], v5 offset:25600
    ds_read_b128 v[144:147], v5 offset:26624
    ds_read_b128 v[148:151], v5 offset:27648
    s_waitcnt vmcnt(15) lgkmcnt(4)
    v_mfma_f32_16x16x32_bf16 v[16:19], v[124:127], v[152:155], v[16:19]
    v_mfma_f32_16x16x32_bf16 v[20:23], v[124:127], v[156:159], v[20:23]
    v_mfma_f32_16x16x32_bf16 v[24:27], v[124:127], v[160:163], v[24:27]
    v_mfma_f32_16x16x32_bf16 v[28:31], v[124:127], v[164:167], v[28:31]
    buffer_load_dwordx4 v[124:127], v2, s[12:15], s33 offen offset:1024
    v_mfma_f32_16x16x32_bf16 v[32:35], v[128:131], v[152:155], v[32:35]
    v_mfma_f32_16x16x32_bf16 v[36:39], v[128:131], v[156:159], v[36:39]
    v_mfma_f32_16x16x32_bf16 v[40:43], v[128:131], v[160:163], v[40:43]
    v_mfma_f32_16x16x32_bf16 v[44:47], v[128:131], v[164:167], v[44:47]
    buffer_load_dwordx4 v[128:131], v2, s[12:15], s33 offen offset:2048
    v_mfma_f32_16x16x32_bf16 v[48:51], v[132:135], v[152:155], v[48:51]
    v_mfma_f32_16x16x32_bf16 v[52:55], v[132:135], v[156:159], v[52:55]
    v_mfma_f32_16x16x32_bf16 v[56:59], v[132:135], v[160:163], v[56:59]
    v_mfma_f32_16x16x32_bf16 v[60:63], v[132:135], v[164:167], v[60:63]
    buffer_load_dwordx4 v[132:135], v2, s[12:15], s33 offen offset:3072
    ds_read_b128 v[152:155], v5 offset:28672
    ds_read_b128 v[156:159], v5 offset:29696
    ds_read_b128 v[160:163], v5 offset:30720
    ds_read_b128 v[164:167], v5 offset:31744
    s_waitcnt vmcnt(15) lgkmcnt(4)
    v_mfma_f32_16x16x32_bf16 v[16:19], v[64:67], v[136:139], v[16:19]
    v_mfma_f32_16x16x32_bf16 v[20:23], v[64:67], v[140:143], v[20:23]
    v_mfma_f32_16x16x32_bf16 v[24:27], v[64:67], v[144:147], v[24:27]
    v_mfma_f32_16x16x32_bf16 v[28:31], v[64:67], v[148:151], v[28:31]
    s_add_u32 s33, s31, 36864
    buffer_load_dwordx4 v[64:67], v2, s[12:15], s33 offen offset:0
    v_mfma_f32_16x16x32_bf16 v[32:35], v[68:71], v[136:139], v[32:35]
    v_mfma_f32_16x16x32_bf16 v[36:39], v[68:71], v[140:143], v[36:39]
    v_mfma_f32_16x16x32_bf16 v[40:43], v[68:71], v[144:147], v[40:43]
    v_mfma_f32_16x16x32_bf16 v[44:47], v[68:71], v[148:151], v[44:47]
    buffer_load_dwordx4 v[68:71], v2, s[12:15], s33 offen offset:1024
    v_mfma_f32_16x16x32_bf16 v[48:51], v[72:75], v[136:139], v[48:51]
    v_mfma_f32_16x16x32_bf16 v[52:55], v[72:75], v[140:143], v[52:55]
    v_mfma_f32_16x16x32_bf16 v[56:59], v[72:75], v[144:147], v[56:59]
    v_mfma_f32_16x16x32_bf16 v[60:63], v[72:75], v[148:151], v[60:63]
    buffer_load_dwordx4 v[72:75], v2, s[12:15], s33 offen offset:2048
    ds_read_b128 v[136:139], v5 offset:32768
    ds_read_b128 v[140:143], v5 offset:33792
    ds_read_b128 v[144:147], v5 offset:34816
    ds_read_b128 v[148:151], v5 offset:35840
    s_waitcnt vmcnt(15) lgkmcnt(4)
    v_mfma_f32_16x16x32_bf16 v[16:19], v[76:79], v[152:155], v[16:19]
    v_mfma_f32_16x16x32_bf16 v[20:23], v[76:79], v[156:159], v[20:23]
    v_mfma_f32_16x16x32_bf16 v[24:27], v[76:79], v[160:163], v[24:27]
    v_mfma_f32_16x16x32_bf16 v[28:31], v[76:79], v[164:167], v[28:31]
    buffer_load_dwordx4 v[76:79], v2, s[12:15], s33 offen offset:3072
    v_mfma_f32_16x16x32_bf16 v[32:35], v[80:83], v[152:155], v[32:35]
    v_mfma_f32_16x16x32_bf16 v[36:39], v[80:83], v[156:159], v[36:39]
    v_mfma_f32_16x16x32_bf16 v[40:43], v[80:83], v[160:163], v[40:43]
    v_mfma_f32_16x16x32_bf16 v[44:47], v[80:83], v[164:167], v[44:47]
    s_add_u32 s33, s31, 40960
    buffer_load_dwordx4 v[80:83], v2, s[12:15], s33 offen offset:0
    v_mfma_f32_16x16x32_bf16 v[48:51], v[84:87], v[152:155], v[48:51]
    v_mfma_f32_16x16x32_bf16 v[52:55], v[84:87], v[156:159], v[52:55]
    v_mfma_f32_16x16x32_bf16 v[56:59], v[84:87], v[160:163], v[56:59]
    v_mfma_f32_16x16x32_bf16 v[60:63], v[84:87], v[164:167], v[60:63]
    buffer_load_dwordx4 v[84:87], v2, s[12:15], s33 offen offset:1024
    ds_read_b128 v[152:155], v6 offset:0
    ds_read_b128 v[156:159], v6 offset:1024
    ds_read_b128 v[160:163], v6 offset:2048
    ds_read_b128 v[164:167], v6 offset:3072
    s_waitcnt vmcnt(15) lgkmcnt(4)
    v_mfma_f32_16x16x32_bf16 v[16:19], v[88:91], v[136:139], v[16:19]
    v_mfma_f32_16x16x32_bf16 v[20:23], v[88:91], v[140:143], v[20:23]
    v_mfma_f32_16x16x32_bf16 v[24:27], v[88:91], v[144:147], v[24:27]
    v_mfma_f32_16x16x32_bf16 v[28:31], v[88:91], v[148:151], v[28:31]
    buffer_load_dwordx4 v[88:91], v2, s[12:15], s33 offen offset:2048
    v_mfma_f32_16x16x32_bf16 v[32:35], v[92:95], v[136:139], v[32:35]
    v_mfma_f32_16x16x32_bf16 v[36:39], v[92:95], v[140:143], v[36:39]
    v_mfma_f32_16x16x32_bf16 v[40:43], v[92:95], v[144:147], v[40:43]
    v_mfma_f32_16x16x32_bf16 v[44:47], v[92:95], v[148:151], v[44:47]
    buffer_load_dwordx4 v[92:95], v2, s[12:15], s33 offen offset:3072
    v_mfma_f32_16x16x32_bf16 v[48:51], v[96:99], v[136:139], v[48:51]
    v_mfma_f32_16x16x32_bf16 v[52:55], v[96:99], v[140:143], v[52:55]
    v_mfma_f32_16x16x32_bf16 v[56:59], v[96:99], v[144:147], v[56:59]
    v_mfma_f32_16x16x32_bf16 v[60:63], v[96:99], v[148:151], v[60:63]
    s_add_u32 s33, s31, 45056
    buffer_load_dwordx4 v[96:99], v2, s[12:15], s33 offen offset:0
    ds_read_b128 v[136:139], v6 offset:4096
    ds_read_b128 v[140:143], v6 offset:5120
    ds_read_b128 v[144:147], v6 offset:6144
    ds_read_b128 v[148:151], v6 offset:7168
    s_waitcnt vmcnt(15) lgkmcnt(4)
    v_mfma_f32_16x16x32_bf16 v[16:19], v[100:103], v[152:155], v[16:19]
    v_mfma_f32_16x16x32_bf16 v[20:23], v[100:103], v[156:159], v[20:23]
    v_mfma_f32_16x16x32_bf16 v[24:27], v[100:103], v[160:163], v[24:27]
    v_mfma_f32_16x16x32_bf16 v[28:31], v[100:103], v[164:167], v[28:31]
    buffer_load_dwordx4 v[100:103], v2, s[12:15], s33 offen offset:1024
    v_mfma_f32_16x16x32_bf16 v[32:35], v[104:107], v[152:155], v[32:35]
    v_mfma_f32_16x16x32_bf16 v[36:39], v[104:107], v[156:159], v[36:39]
    v_mfma_f32_16x16x32_bf16 v[40:43], v[104:107], v[160:163], v[40:43]
    v_mfma_f32_16x16x32_bf16 v[44:47], v[104:107], v[164:167], v[44:47]
    buffer_load_dwordx4 v[104:107], v2, s[12:15], s33 offen offset:2048
    v_mfma_f32_16x16x32_bf16 v[48:51], v[108:111], v[152:155], v[48:51]
    v_mfma_f32_16x16x32_bf16 v[52:55], v[108:111], v[156:159], v[52:55]
    v_mfma_f32_16x16x32_bf16 v[56:59], v[108:111], v[160:163], v[56:59]
    v_mfma_f32_16x16x32_bf16 v[60:63], v[108:111], v[164:167], v[60:63]
    buffer_load_dwordx4 v[108:111], v2, s[12:15], s33 offen offset:3072
    ds_read_b128 v[152:155], v6 offset:8192
    ds_read_b128 v[156:159], v6 offset:9216
    ds_read_b128 v[160:163], v6 offset:10240
    ds_read_b128 v[164:167], v6 offset:11264
    s_waitcnt vmcnt(15) lgkmcnt(4)
    v_mfma_f32_16x16x32_bf16 v[16:19], v[112:115], v[136:139], v[16:19]
    v_mfma_f32_16x16x32_bf16 v[20:23], v[112:115], v[140:143], v[20:23]
    v_mfma_f32_16x16x32_bf16 v[24:27], v[112:115], v[144:147], v[24:27]
    v_mfma_f32_16x16x32_bf16 v[28:31], v[112:115], v[148:151], v[28:31]
    s_add_u32 s33, s31, 49152
    buffer_load_dwordx4 v[112:115], v2, s[12:15], s33 offen offset:0
    v_mfma_f32_16x16x32_bf16 v[32:35], v[116:119], v[136:139], v[32:35]
    v_mfma_f32_16x16x32_bf16 v[36:39], v[116:119], v[140:143], v[36:39]
    v_mfma_f32_16x16x32_bf16 v[40:43], v[116:119], v[144:147], v[40:43]
    v_mfma_f32_16x16x32_bf16 v[44:47], v[116:119], v[148:151], v[44:47]
    buffer_load_dwordx4 v[116:119], v2, s[12:15], s33 offen offset:1024
    v_mfma_f32_16x16x32_bf16 v[48:51], v[120:123], v[136:139], v[48:51]
    v_mfma_f32_16x16x32_bf16 v[52:55], v[120:123], v[140:143], v[52:55]
    v_mfma_f32_16x16x32_bf16 v[56:59], v[120:123], v[144:147], v[56:59]
    v_mfma_f32_16x16x32_bf16 v[60:63], v[120:123], v[148:151], v[60:63]
    buffer_load_dwordx4 v[120:123], v2, s[12:15], s33 offen offset:2048
    v_mov_b32 v10, 152584
K4_POLL_3:
    ds_read_b32 v11, v10
    s_waitcnt lgkmcnt(0)
    v_readfirstlane_b32 s36, v11
    s_nop 0
    s_cmp_ge_u32 s36, 4
    s_cbranch_scc1 K4_POLL_3_D
    s_sleep 2
    s_branch K4_POLL_3
K4_POLL_3_D:
    ds_read_b128 v[136:139], v6 offset:12288
    ds_read_b128 v[140:143], v6 offset:13312
    ds_read_b128 v[144:147], v6 offset:14336
    ds_read_b128 v[148:151], v6 offset:15360
    s_waitcnt vmcnt(15) lgkmcnt(4)
    v_mfma_f32_16x16x32_bf16 v[16:19], v[124:127], v[152:155], v[16:19]
    v_mfma_f32_16x16x32_bf16 v[20:23], v[124:127], v[156:159], v[20:23]
    v_mfma_f32_16x16x32_bf16 v[24:27], v[124:127], v[160:163], v[24:27]
    v_mfma_f32_16x16x32_bf16 v[28:31], v[124:127], v[164:167], v[28:31]
    buffer_load_dwordx4 v[124:127], v2, s[12:15], s33 offen offset:3072
    v_mfma_f32_16x16x32_bf16 v[32:35], v[128:131], v[152:155], v[32:35]
    v_mfma_f32_16x16x32_bf16 v[36:39], v[128:131], v[156:159], v[36:39]
    v_mfma_f32_16x16x32_bf16 v[40:43], v[128:131], v[160:163], v[40:43]
    v_mfma_f32_16x16x32_bf16 v[44:47], v[128:131], v[164:167], v[44:47]
    s_add_u32 s33, s31, 53248
    buffer_load_dwordx4 v[128:131], v2, s[12:15], s33 offen offset:0
    v_mfma_f32_16x16x32_bf16 v[48:51], v[132:135], v[152:155], v[48:51]
    v_mfma_f32_16x16x32_bf16 v[52:55], v[132:135], v[156:159], v[52:55]
    v_mfma_f32_16x16x32_bf16 v[56:59], v[132:135], v[160:163], v[56:59]
    v_mfma_f32_16x16x32_bf16 v[60:63], v[132:135], v[164:167], v[60:63]
    buffer_load_dwordx4 v[132:135], v2, s[12:15], s33 offen offset:1024
    ds_read_b128 v[152:155], v6 offset:16384
    ds_read_b128 v[156:159], v6 offset:17408
    ds_read_b128 v[160:163], v6 offset:18432
    ds_read_b128 v[164:167], v6 offset:19456
    s_waitcnt vmcnt(15) lgkmcnt(4)
    v_mfma_f32_16x16x32_bf16 v[16:19], v[64:67], v[136:139], v[16:19]
    v_mfma_f32_16x16x32_bf16 v[20:23], v[64:67], v[140:143], v[20:23]
    v_mfma_f32_16x16x32_bf16 v[24:27], v[64:67], v[144:147], v[24:27]
    v_mfma_f32_16x16x32_bf16 v[28:31], v[64:67], v[148:151], v[28:31]
    v_mfma_f32_16x16x32_bf16 v[32:35], v[68:71], v[136:139], v[32:35]
    v_mfma_f32_16x16x32_bf16 v[36:39], v[68:71], v[140:143], v[36:39]
    v_mfma_f32_16x16x32_bf16 v[40:43], v[68:71], v[144:147], v[40:43]
    v_mfma_f32_16x16x32_bf16 v[44:47], v[68:71], v[148:151], v[44:47]
    v_mfma_f32_16x16x32_bf16 v[48:51], v[72:75], v[136:139], v[48:51]
    v_mfma_f32_16x16x32_bf16 v[52:55], v[72:75], v[140:143], v[52:55]
    v_mfma_f32_16x16x32_bf16 v[56:59], v[72:75], v[144:147], v[56:59]
    v_mfma_f32_16x16x32_bf16 v[60:63], v[72:75], v[148:151], v[60:63]
    ds_read_b128 v[136:139], v6 offset:20480
    ds_read_b128 v[140:143], v6 offset:21504
    ds_read_b128 v[144:147], v6 offset:22528
    ds_read_b128 v[148:151], v6 offset:23552
    s_waitcnt vmcnt(12) lgkmcnt(4)
    v_mfma_f32_16x16x32_bf16 v[16:19], v[76:79], v[152:155], v[16:19]
    v_mfma_f32_16x16x32_bf16 v[20:23], v[76:79], v[156:159], v[20:23]
    v_mfma_f32_16x16x32_bf16 v[24:27], v[76:79], v[160:163], v[24:27]
    v_mfma_f32_16x16x32_bf16 v[28:31], v[76:79], v[164:167], v[28:31]
    v_mfma_f32_16x16x32_bf16 v[32:35], v[80:83], v[152:155], v[32:35]
    v_mfma_f32_16x16x32_bf16 v[36:39], v[80:83], v[156:159], v[36:39]
    v_mfma_f32_16x16x32_bf16 v[40:43], v[80:83], v[160:163], v[40:43]
    v_mfma_f32_16x16x32_bf16 v[44:47], v[80:83], v[164:167], v[44:47]
    v_mfma_f32_16x16x32_bf16 v[48:51], v[84:87], v[152:155], v[48:51]
    v_mfma_f32_16x16x32_bf16 v[52:55], v[84:87], v[156:159], v[52:55]
    v_mfma_f32_16x16x32_bf16 v[56:59], v[84:87], v[160:163], v[56:59]
    v_mfma_f32_16x16x32_bf16 v[60:63], v[84:87], v[164:167], v[60:63]
    ds_read_b128 v[152:155], v6 offset:24576
    ds_read_b128 v[156:159], v6 offset:25600
    ds_read_b128 v[160:163], v6 offset:26624
    ds_read_b128 v[164:167], v6 offset:27648
    s_waitcnt vmcnt(9) lgkmcnt(4)
    v_mfma_f32_16x16x32_bf16 v[16:19], v[88:91], v[136:139], v[16:19]
    v_mfma_f32_16x16x32_bf16 v[20:23], v[88:91], v[140:143], v[20:23]
    v_mfma_f32_16x16x32_bf16 v[24:27], v[88:91], v[144:147], v[24:27]
    v_mfma_f32_16x16x32_bf16 v[28:31], v[88:91], v[148:151], v[28:31]
    v_mfma_f32_16x16x32_bf16 v[32:35], v[92:95], v[136:139], v[32:35]
    v_mfma_f32_16x16x32_bf16 v[36:39], v[92:95], v[140:143], v[36:39]
    v_mfma_f32_16x16x32_bf16 v[40:43], v[92:95], v[144:147], v[40:43]
    v_mfma_f32_16x16x32_bf16 v[44:47], v[92:95], v[148:151], v[44:47]
    v_mfma_f32_16x16x32_bf16 v[48:51], v[96:99], v[136:139], v[48:51]
    v_mfma_f32_16x16x32_bf16 v[52:55], v[96:99], v[140:143], v[52:55]
    v_mfma_f32_16x16x32_bf16 v[56:59], v[96:99], v[144:147], v[56:59]
    v_mfma_f32_16x16x32_bf16 v[60:63], v[96:99], v[148:151], v[60:63]
    ds_read_b128 v[136:139], v6 offset:28672
    ds_read_b128 v[140:143], v6 offset:29696
    ds_read_b128 v[144:147], v6 offset:30720
    ds_read_b128 v[148:151], v6 offset:31744
    s_waitcnt vmcnt(6) lgkmcnt(4)
    v_mfma_f32_16x16x32_bf16 v[16:19], v[100:103], v[152:155], v[16:19]
    v_mfma_f32_16x16x32_bf16 v[20:23], v[100:103], v[156:159], v[20:23]
    v_mfma_f32_16x16x32_bf16 v[24:27], v[100:103], v[160:163], v[24:27]
    v_mfma_f32_16x16x32_bf16 v[28:31], v[100:103], v[164:167], v[28:31]
    v_mfma_f32_16x16x32_bf16 v[32:35], v[104:107], v[152:155], v[32:35]
    v_mfma_f32_16x16x32_bf16 v[36:39], v[104:107], v[156:159], v[36:39]
    v_mfma_f32_16x16x32_bf16 v[40:43], v[104:107], v[160:163], v[40:43]
    v_mfma_f32_16x16x32_bf16 v[44:47], v[104:107], v[164:167], v[44:47]
    v_mfma_f32_16x16x32_bf16 v[48:51], v[108:111], v[152:155], v[48:51]
    v_mfma_f32_16x16x32_bf16 v[52:55], v[108:111], v[156:159], v[52:55]
    v_mfma_f32_16x16x32_bf16 v[56:59], v[108:111], v[160:163], v[56:59]
    v_mfma_f32_16x16x32_bf16 v[60:63], v[108:111], v[164:167], v[60:63]
    ds_read_b128 v[152:155], v6 offset:32768
    ds_read_b128 v[156:159], v6 offset:33792
    ds_read_b128 v[160:163], v6 offset:34816
    ds_read_b128 v[164:167], v6 offset:35840
    s_waitcnt vmcnt(3) lgkmcnt(4)
    v_mfma_f32_16x16x32_bf16 v[16:19], v[112:115], v[136:139], v[16:19]
    v_mfma_f32_16x16x32_bf16 v[20:23], v[112:115], v[140:143], v[20:23]
    v_mfma_f32_16x16x32_bf16 v[24:27], v[112:115], v[144:147], v[24:27]
    v_mfma_f32_16x16x32_bf16 v[28:31], v[112:115], v[148:151], v[28:31]
    v_mfma_f32_16x16x32_bf16 v[32:35], v[116:119], v[136:139], v[32:35]
    v_mfma_f32_16x16x32_bf16 v[36:39], v[116:119], v[140:143], v[36:39]
    v_mfma_f32_16x16x32_bf16 v[40:43], v[116:119], v[144:147], v[40:43]
    v_mfma_f32_16x16x32_bf16 v[44:47], v[116:119], v[148:151], v[44:47]
    v_mfma_f32_16x16x32_bf16 v[48:51], v[120:123], v[136:139], v[48:51]
    v_mfma_f32_16x16x32_bf16 v[52:55], v[120:123], v[140:143], v[52:55]
    v_mfma_f32_16x16x32_bf16 v[56:59], v[120:123], v[144:147], v[56:59]
    v_mfma_f32_16x16x32_bf16 v[60:63], v[120:123], v[148:151], v[60:63]
    s_waitcnt vmcnt(0) lgkmcnt(0)
    v_mfma_f32_16x16x32_bf16 v[16:19], v[124:127], v[152:155], v[16:19]
    v_mfma_f32_16x16x32_bf16 v[20:23], v[124:127], v[156:159], v[20:23]
    v_mfma_f32_16x16x32_bf16 v[24:27], v[124:127], v[160:163], v[24:27]
    v_mfma_f32_16x16x32_bf16 v[28:31], v[124:127], v[164:167], v[28:31]
    v_mfma_f32_16x16x32_bf16 v[32:35], v[128:131], v[152:155], v[32:35]
    v_mfma_f32_16x16x32_bf16 v[36:39], v[128:131], v[156:159], v[36:39]
    v_mfma_f32_16x16x32_bf16 v[40:43], v[128:131], v[160:163], v[40:43]
    v_mfma_f32_16x16x32_bf16 v[44:47], v[128:131], v[164:167], v[44:47]
    v_mfma_f32_16x16x32_bf16 v[48:51], v[132:135], v[152:155], v[48:51]
    v_mfma_f32_16x16x32_bf16 v[52:55], v[132:135], v[156:159], v[52:55]
    v_mfma_f32_16x16x32_bf16 v[56:59], v[132:135], v[160:163], v[56:59]
    v_mfma_f32_16x16x32_bf16 v[60:63], v[132:135], v[164:167], v[60:63]
    s_add_u32 s16, s4, 32350208
    s_addc_u32 s17, s5, 0
    s_mov_b32 s18, 18874368
    s_mov_b32 s19, 0x00020000
    s_lshl_b32 s28, s22, 6
    s_lshl_b32 s29, s21, 1
    s_add_u32 s28, s28, s29
    s_mul_i32 s28, s28, 36
    s_mul_i32 s29, s20, 3
    s_add_u32 s28, s28, s29
    s_lshl_b32 s28, s28, 10
    v_cvt_pk_bf16_f32 v64, v16, v17
    v_cvt_pk_bf16_f32 v65, v18, v19
    v_cvt_pk_bf16_f32 v66, v20, v21
    v_cvt_pk_bf16_f32 v67, v22, v23
    s_add_u32 s29, s28, 0
    buffer_store_dwordx4 v[64:67], v2, s[16:19], s29 offen sc1
    v_cvt_pk_bf16_f32 v68, v24, v25
    v_cvt_pk_bf16_f32 v69, v26, v27
    v_cvt_pk_bf16_f32 v70, v28, v29
    v_cvt_pk_bf16_f32 v71, v30, v31
    s_add_u32 s29, s28, 36864
    buffer_store_dwordx4 v[68:71], v2, s[16:19], s29 offen sc1
    v_cvt_pk_bf16_f32 v72, v32, v33
    v_cvt_pk_bf16_f32 v73, v34, v35
    v_cvt_pk_bf16_f32 v74, v36, v37
    v_cvt_pk_bf16_f32 v75, v38, v39
    s_add_u32 s29, s28, 1024
    buffer_store_dwordx4 v[72:75], v2, s[16:19], s29 offen sc1
    v_cvt_pk_bf16_f32 v76, v40, v41
    v_cvt_pk_bf16_f32 v77, v42, v43
    v_cvt_pk_bf16_f32 v78, v44, v45
    v_cvt_pk_bf16_f32 v79, v46, v47
    s_add_u32 s29, s28, 37888
    buffer_store_dwordx4 v[76:79], v2, s[16:19], s29 offen sc1
    v_cvt_pk_bf16_f32 v80, v48, v49
    v_cvt_pk_bf16_f32 v81, v50, v51
    v_cvt_pk_bf16_f32 v82, v52, v53
    v_cvt_pk_bf16_f32 v83, v54, v55
    s_add_u32 s29, s28, 2048
    buffer_store_dwordx4 v[80:83], v2, s[16:19], s29 offen sc1
    v_cvt_pk_bf16_f32 v84, v56, v57
    v_cvt_pk_bf16_f32 v85, v58, v59
    v_cvt_pk_bf16_f32 v86, v60, v61
    v_cvt_pk_bf16_f32 v87, v62, v63
    s_add_u32 s29, s28, 38912
    buffer_store_dwordx4 v[84:87], v2, s[16:19], s29 offen sc1
    s_waitcnt vmcnt(0)
    s_barrier
    s_lshl_b32 s35, s20, 3
    s_add_u32 s35, s35, s22
    s_cmp_ge_u32 s35, 36
    s_cbranch_scc1 K4_END
    s_lshl_b32 s36, s21, 8
    s_add_u32 s36, s36, 10240
    v_mov_b32 v10, 0
    s_cmp_lg_u32 s20, 0
    s_cbranch_scc1 K4_WAITD
    v_mov_b32 v11, 1
    s_mov_b64 exec, 1
    buffer_atomic_add v11, v10, s[40:43], s36 offen sc1
    s_mov_b64 exec, -1
    s_mov_b32 s46, 0
K4_SPIN:
    buffer_load_dword v11, v10, s[40:43], s36 offen sc1
    s_waitcnt vmcnt(0)
    v_readfirstlane_b32 s37, v11
    s_nop 0
    s_cmp_ge_u32 s37, 8
    s_cbranch_scc1 K4_WAITD
    s_sleep 4
    s_add_u32 s46, s46, 1
    s_cmp_lt_u32 s46, 400000
    s_cbranch_scc1 K4_SPIN
K4_WAITD:
    s_barrier
    s_cmp_ge_u32 s35, 18
    s_cselect_b32 s36, 1, 0
    s_mul_i32 s37, s36, 18
    s_sub_u32 s23, s35, s37
    s_lshl_b32 s37, s21, 1
    s_add_u32 s22, s37, s36
    s_mul_i32 s28, s22, 36
    s_lshl_b32 s29, s23, 1
    s_add_u32 s28, s28, s29
    s_lshl_b32 s28, s28, 10
    v_lshrrev_b32 v3, 4, v1
    v_lshlrev_b32 v4, 4, v3
    s_add_u32 s8, s4, 32350208
    s_addc_u32 s9, s5, 0
    s_mov_b32 s10, 18874368
    s_mov_b32 s11, 0x00020000
    buffer_load_dwordx4 v[16:19], v2, s[8:11], s28 offen sc1
    buffer_load_dwordx4 v[20:23], v2, s[8:11], s28 offen offset:1024 sc1
    s_add_u32 s28, s28, 2359296
    buffer_load_dwordx4 v[24:27], v2, s[8:11], s28 offen sc1
    buffer_load_dwordx4 v[28:31], v2, s[8:11], s28 offen offset:1024 sc1
    s_add_u32 s28, s28, 2359296
    buffer_load_dwordx4 v[32:35], v2, s[8:11], s28 offen sc1
    buffer_load_dwordx4 v[36:39], v2, s[8:11], s28 offen offset:1024 sc1
    s_add_u32 s28, s28, 2359296
    buffer_load_dwordx4 v[40:43], v2, s[8:11], s28 offen sc1
    buffer_load_dwordx4 v[44:47], v2, s[8:11], s28 offen offset:1024 sc1
    s_add_u32 s28, s28, 2359296
    buffer_load_dwordx4 v[48:51], v2, s[8:11], s28 offen sc1
    buffer_load_dwordx4 v[52:55], v2, s[8:11], s28 offen offset:1024 sc1
    s_add_u32 s28, s28, 2359296
    buffer_load_dwordx4 v[56:59], v2, s[8:11], s28 offen sc1
    buffer_load_dwordx4 v[60:63], v2, s[8:11], s28 offen offset:1024 sc1
    s_add_u32 s28, s28, 2359296
    buffer_load_dwordx4 v[64:67], v2, s[8:11], s28 offen sc1
    buffer_load_dwordx4 v[68:71], v2, s[8:11], s28 offen offset:1024 sc1
    s_add_u32 s28, s28, 2359296
    buffer_load_dwordx4 v[72:75], v2, s[8:11], s28 offen sc1
    buffer_load_dwordx4 v[76:79], v2, s[8:11], s28 offen offset:1024 sc1
    s_add_u32 s12, s4, 27529216
    s_addc_u32 s13, s5, 0
    s_mov_b32 s14, 2359296
    s_mov_b32 s15, 0x00020000
    s_add_u32 s16, s4, 28672
    s_addc_u32 s17, s5, 0
    s_mov_b32 s18, 13824
    s_mov_b32 s19, 0x00020000
    s_mov_b32 s24, s6
    s_mov_b32 s25, s7
    s_mov_b32 s26, 2359296
    s_mov_b32 s27, 0x00020000
    s_mul_i32 s28, s22, 36
    s_add_u32 s28, s28, s23
    s_lshl_b32 s28, s28, 10
    buffer_load_dwordx4 v[80:83], v2, s[12:15], s28 offen sc1
    s_add_u32 s28, s28, 18432
    buffer_load_dwordx4 v[84:87], v2, s[12:15], s28 offen sc1
    s_lshl_b32 s28, s23, 7
    s_add_u32 s28, s28, 11520
    buffer_load_dwordx4 v[88:91], v4, s[16:19], s28 offen
    buffer_load_dwordx4 v[92:95], v4, s[16:19], s28 offen offset:64
    v_and_b32 v5, 15, v1
    v_mul_u32_u24 v5, 1152, v5
    v_and_b32 v6, 1, v3
    v_lshl_add_u32 v5, v6, 5, v5
    v_lshrrev_b32 v6, 1, v3
    v_lshl_add_u32 v5, v6, 4, v5
    s_mul_i32 s28, s22, 36864
    s_lshl_b32 s29, s23, 6
    s_add_u32 s28, s28, s29
    v_mov_b32 v96, 0
    v_mov_b32 v97, 0
    v_mov_b32 v98, 0
    v_mov_b32 v99, 0
    v_mov_b32 v100, 0
    v_mov_b32 v101, 0
    v_mov_b32 v102, 0
    v_mov_b32 v103, 0
    v_mov_b32 v104, 0
    v_mov_b32 v105, 0
    v_mov_b32 v106, 0
    v_mov_b32 v107, 0
    v_mov_b32 v108, 0
    v_mov_b32 v109, 0
    v_mov_b32 v110, 0
    v_mov_b32 v111, 0
    s_waitcnt vmcnt(18)
    v_lshlrev_b32 v6, 16, v16
    v_and_b32 v7, 0xffff0000, v16
    v_add_f32 v96, v96, v6
    v_add_f32 v97, v97, v7
    v_lshlrev_b32 v6, 16, v17
    v_and_b32 v7, 0xffff0000, v17
    v_add_f32 v98, v98, v6
    v_add_f32 v99, v99, v7
    v_lshlrev_b32 v6, 16, v18
    v_and_b32 v7, 0xffff0000, v18
    v_add_f32 v100, v100, v6
    v_add_f32 v101, v101, v7
    v_lshlrev_b32 v6, 16, v19
    v_and_b32 v7, 0xffff0000, v19
    v_add_f32 v102, v102, v6
    v_add_f32 v103, v103, v7
    v_lshlrev_b32 v6, 16, v20
    v_and_b32 v7, 0xffff0000, v20
    v_add_f32 v104, v104, v6
    v_add_f32 v105, v105, v7
    v_lshlrev_b32 v6, 16, v21
    v_and_b32 v7, 0xffff0000, v21
    v_add_f32 v106, v106, v6
    v_add_f32 v107, v107, v7
    v_lshlrev_b32 v6, 16, v22
    v_and_b32 v7, 0xffff0000, v22
    v_add_f32 v108, v108, v6
    v_add_f32 v109, v109, v7
    v_lshlrev_b32 v6, 16, v23
    v_and_b32 v7, 0xffff0000, v23
    v_add_f32 v110, v110, v6
    v_add_f32 v111, v111, v7
    s_waitcnt vmcnt(16)
    v_lshlrev_b32 v6, 16, v24
    v_and_b32 v7, 0xffff0000, v24
    v_add_f32 v96, v96, v6
    v_add_f32 v97, v97, v7
    v_lshlrev_b32 v6, 16, v25
    v_and_b32 v7, 0xffff0000, v25
    v_add_f32 v98, v98, v6
    v_add_f32 v99, v99, v7
    v_lshlrev_b32 v6, 16, v26
    v_and_b32 v7, 0xffff0000, v26
    v_add_f32 v100, v100, v6
    v_add_f32 v101, v101, v7
    v_lshlrev_b32 v6, 16, v27
    v_and_b32 v7, 0xffff0000, v27
    v_add_f32 v102, v102, v6
    v_add_f32 v103, v103, v7
    v_lshlrev_b32 v6, 16, v28
    v_and_b32 v7, 0xffff0000, v28
    v_add_f32 v104, v104, v6
    v_add_f32 v105, v105, v7
    v_lshlrev_b32 v6, 16, v29
    v_and_b32 v7, 0xffff0000, v29
    v_add_f32 v106, v106, v6
    v_add_f32 v107, v107, v7
    v_lshlrev_b32 v6, 16, v30
    v_and_b32 v7, 0xffff0000, v30
    v_add_f32 v108, v108, v6
    v_add_f32 v109, v109, v7
    v_lshlrev_b32 v6, 16, v31
    v_and_b32 v7, 0xffff0000, v31
    v_add_f32 v110, v110, v6
    v_add_f32 v111, v111, v7
    s_waitcnt vmcnt(14)
    v_lshlrev_b32 v6, 16, v32
    v_and_b32 v7, 0xffff0000, v32
    v_add_f32 v96, v96, v6
    v_add_f32 v97, v97, v7
    v_lshlrev_b32 v6, 16, v33
    v_and_b32 v7, 0xffff0000, v33
    v_add_f32 v98, v98, v6
    v_add_f32 v99, v99, v7
    v_lshlrev_b32 v6, 16, v34
    v_and_b32 v7, 0xffff0000, v34
    v_add_f32 v100, v100, v6
    v_add_f32 v101, v101, v7
    v_lshlrev_b32 v6, 16, v35
    v_and_b32 v7, 0xffff0000, v35
    v_add_f32 v102, v102, v6
    v_add_f32 v103, v103, v7
    v_lshlrev_b32 v6, 16, v36
    v_and_b32 v7, 0xffff0000, v36
    v_add_f32 v104, v104, v6
    v_add_f32 v105, v105, v7
    v_lshlrev_b32 v6, 16, v37
    v_and_b32 v7, 0xffff0000, v37
    v_add_f32 v106, v106, v6
    v_add_f32 v107, v107, v7
    v_lshlrev_b32 v6, 16, v38
    v_and_b32 v7, 0xffff0000, v38
    v_add_f32 v108, v108, v6
    v_add_f32 v109, v109, v7
    v_lshlrev_b32 v6, 16, v39
    v_and_b32 v7, 0xffff0000, v39
    v_add_f32 v110, v110, v6
    v_add_f32 v111, v111, v7
    s_waitcnt vmcnt(12)
    v_lshlrev_b32 v6, 16, v40
    v_and_b32 v7, 0xffff0000, v40
    v_add_f32 v96, v96, v6
    v_add_f32 v97, v97, v7
    v_lshlrev_b32 v6, 16, v41
    v_and_b32 v7, 0xffff0000, v41
    v_add_f32 v98, v98, v6
    v_add_f32 v99, v99, v7
    v_lshlrev_b32 v6, 16, v42
    v_and_b32 v7, 0xffff0000, v42
    v_add_f32 v100, v100, v6
    v_add_f32 v101, v101, v7
    v_lshlrev_b32 v6, 16, v43
    v_and_b32 v7, 0xffff0000, v43
    v_add_f32 v102, v102, v6
    v_add_f32 v103, v103, v7
    v_lshlrev_b32 v6, 16, v44
    v_and_b32 v7, 0xffff0000, v44
    v_add_f32 v104, v104, v6
    v_add_f32 v105, v105, v7
    v_lshlrev_b32 v6, 16, v45
    v_and_b32 v7, 0xffff0000, v45
    v_add_f32 v106, v106, v6
    v_add_f32 v107, v107, v7
    v_lshlrev_b32 v6, 16, v46
    v_and_b32 v7, 0xffff0000, v46
    v_add_f32 v108, v108, v6
    v_add_f32 v109, v109, v7
    v_lshlrev_b32 v6, 16, v47
    v_and_b32 v7, 0xffff0000, v47
    v_add_f32 v110, v110, v6
    v_add_f32 v111, v111, v7
    s_waitcnt vmcnt(10)
    v_lshlrev_b32 v6, 16, v48
    v_and_b32 v7, 0xffff0000, v48
    v_add_f32 v96, v96, v6
    v_add_f32 v97, v97, v7
    v_lshlrev_b32 v6, 16, v49
    v_and_b32 v7, 0xffff0000, v49
    v_add_f32 v98, v98, v6
    v_add_f32 v99, v99, v7
    v_lshlrev_b32 v6, 16, v50
    v_and_b32 v7, 0xffff0000, v50
    v_add_f32 v100, v100, v6
    v_add_f32 v101, v101, v7
    v_lshlrev_b32 v6, 16, v51
    v_and_b32 v7, 0xffff0000, v51
    v_add_f32 v102, v102, v6
    v_add_f32 v103, v103, v7
    v_lshlrev_b32 v6, 16, v52
    v_and_b32 v7, 0xffff0000, v52
    v_add_f32 v104, v104, v6
    v_add_f32 v105, v105, v7
    v_lshlrev_b32 v6, 16, v53
    v_and_b32 v7, 0xffff0000, v53
    v_add_f32 v106, v106, v6
    v_add_f32 v107, v107, v7
    v_lshlrev_b32 v6, 16, v54
    v_and_b32 v7, 0xffff0000, v54
    v_add_f32 v108, v108, v6
    v_add_f32 v109, v109, v7
    v_lshlrev_b32 v6, 16, v55
    v_and_b32 v7, 0xffff0000, v55
    v_add_f32 v110, v110, v6
    v_add_f32 v111, v111, v7
    s_waitcnt vmcnt(8)
    v_lshlrev_b32 v6, 16, v56
    v_and_b32 v7, 0xffff0000, v56
    v_add_f32 v96, v96, v6
    v_add_f32 v97, v97, v7
    v_lshlrev_b32 v6, 16, v57
    v_and_b32 v7, 0xffff0000, v57
    v_add_f32 v98, v98, v6
    v_add_f32 v99, v99, v7
    v_lshlrev_b32 v6, 16, v58
    v_and_b32 v7, 0xffff0000, v58
    v_add_f32 v100, v100, v6
    v_add_f32 v101, v101, v7
    v_lshlrev_b32 v6, 16, v59
    v_and_b32 v7, 0xffff0000, v59
    v_add_f32 v102, v102, v6
    v_add_f32 v103, v103, v7
    v_lshlrev_b32 v6, 16, v60
    v_and_b32 v7, 0xffff0000, v60
    v_add_f32 v104, v104, v6
    v_add_f32 v105, v105, v7
    v_lshlrev_b32 v6, 16, v61
    v_and_b32 v7, 0xffff0000, v61
    v_add_f32 v106, v106, v6
    v_add_f32 v107, v107, v7
    v_lshlrev_b32 v6, 16, v62
    v_and_b32 v7, 0xffff0000, v62
    v_add_f32 v108, v108, v6
    v_add_f32 v109, v109, v7
    v_lshlrev_b32 v6, 16, v63
    v_and_b32 v7, 0xffff0000, v63
    v_add_f32 v110, v110, v6
    v_add_f32 v111, v111, v7
    s_waitcnt vmcnt(6)
    v_lshlrev_b32 v6, 16, v64
    v_and_b32 v7, 0xffff0000, v64
    v_add_f32 v96, v96, v6
    v_add_f32 v97, v97, v7
    v_lshlrev_b32 v6, 16, v65
    v_and_b32 v7, 0xffff0000, v65
    v_add_f32 v98, v98, v6
    v_add_f32 v99, v99, v7
    v_lshlrev_b32 v6, 16, v66
    v_and_b32 v7, 0xffff0000, v66
    v_add_f32 v100, v100, v6
    v_add_f32 v101, v101, v7
    v_lshlrev_b32 v6, 16, v67
    v_and_b32 v7, 0xffff0000, v67
    v_add_f32 v102, v102, v6
    v_add_f32 v103, v103, v7
    v_lshlrev_b32 v6, 16, v68
    v_and_b32 v7, 0xffff0000, v68
    v_add_f32 v104, v104, v6
    v_add_f32 v105, v105, v7
    v_lshlrev_b32 v6, 16, v69
    v_and_b32 v7, 0xffff0000, v69
    v_add_f32 v106, v106, v6
    v_add_f32 v107, v107, v7
    v_lshlrev_b32 v6, 16, v70
    v_and_b32 v7, 0xffff0000, v70
    v_add_f32 v108, v108, v6
    v_add_f32 v109, v109, v7
    v_lshlrev_b32 v6, 16, v71
    v_and_b32 v7, 0xffff0000, v71
    v_add_f32 v110, v110, v6
    v_add_f32 v111, v111, v7
    s_waitcnt vmcnt(4)
    v_lshlrev_b32 v6, 16, v72
    v_and_b32 v7, 0xffff0000, v72
    v_add_f32 v96, v96, v6
    v_add_f32 v97, v97, v7
    v_lshlrev_b32 v6, 16, v73
    v_and_b32 v7, 0xffff0000, v73
    v_add_f32 v98, v98, v6
    v_add_f32 v99, v99, v7
    v_lshlrev_b32 v6, 16, v74
    v_and_b32 v7, 0xffff0000, v74
    v_add_f32 v100, v100, v6
    v_add_f32 v101, v101, v7
    v_lshlrev_b32 v6, 16, v75
    v_and_b32 v7, 0xffff0000, v75
    v_add_f32 v102, v102, v6
    v_add_f32 v103, v103, v7
    v_lshlrev_b32 v6, 16, v76
    v_and_b32 v7, 0xffff0000, v76
    v_add_f32 v104, v104, v6
    v_add_f32 v105, v105, v7
    v_lshlrev_b32 v6, 16, v77
    v_and_b32 v7, 0xffff0000, v77
    v_add_f32 v106, v106, v6
    v_add_f32 v107, v107, v7
    v_lshlrev_b32 v6, 16, v78
    v_and_b32 v7, 0xffff0000, v78
    v_add_f32 v108, v108, v6
    v_add_f32 v109, v109, v7
    v_lshlrev_b32 v6, 16, v79
    v_and_b32 v7, 0xffff0000, v79
    v_add_f32 v110, v110, v6
    v_add_f32 v111, v111, v7
    s_waitcnt vmcnt(0)
    v_mul_f32 v88, 0x3f317218, v88
    v_mul_f32 v89, 0x3f317218, v89
    v_mul_f32 v90, 0x3f317218, v90
    v_mul_f32 v91, 0x3f317218, v91
    v_mul_f32 v92, 0x3f317218, v92
    v_mul_f32 v93, 0x3f317218, v93
    v_mul_f32 v94, 0x3f317218, v94
    v_mul_f32 v95, 0x3f317218, v95
    v_lshlrev_b32 v6, 16, v80
    v_fma_f32 v96, v96, v88, v6
    v_and_b32 v6, 0xffff0000, v80
    v_fma_f32 v97, v97, v89, v6
    v_lshlrev_b32 v6, 16, v81
    v_fma_f32 v98, v98, v90, v6
    v_and_b32 v6, 0xffff0000, v81
    v_fma_f32 v99, v99, v91, v6
    v_lshlrev_b32 v6, 16, v82
    v_fma_f32 v104, v104, v92, v6
    v_and_b32 v6, 0xffff0000, v82
    v_fma_f32 v105, v105, v93, v6
    v_lshlrev_b32 v6, 16, v83
    v_fma_f32 v106, v106, v94, v6
    v_and_b32 v6, 0xffff0000, v83
    v_fma_f32 v107, v107, v95, v6
    v_cvt_pk_bf16_f32 v112, v96, v97
    v_cvt_pk_bf16_f32 v113, v98, v99
    v_cvt_pk_bf16_f32 v114, v104, v105
    v_cvt_pk_bf16_f32 v115, v106, v107
    s_nop 0
    v_permlane16_swap_b32 v112, v114
    v_permlane16_swap_b32 v113, v115
    buffer_store_dwordx4 v[112:115], v5, s[24:27], s28 offen
    s_add_u32 s28, s28, 18432
    v_lshlrev_b32 v6, 16, v84
    v_fma_f32 v100, v100, v88, v6
    v_and_b32 v6, 0xffff0000, v84
    v_fma_f32 v101, v101, v89, v6
    v_lshlrev_b32 v6, 16, v85
    v_fma_f32 v102, v102, v90, v6
    v_and_b32 v6, 0xffff0000, v85
    v_fma_f32 v103, v103, v91, v6
    v_lshlrev_b32 v6, 16, v86
    v_fma_f32 v108, v108, v92, v6
    v_and_b32 v6, 0xffff0000, v86
    v_fma_f32 v109, v109, v93, v6
    v_lshlrev_b32 v6, 16, v87
    v_fma_f32 v110, v110, v94, v6
    v_and_b32 v6, 0xffff0000, v87
    v_fma_f32 v111, v111, v95, v6
    v_cvt_pk_bf16_f32 v116, v100, v101
    v_cvt_pk_bf16_f32 v117, v102, v103
    v_cvt_pk_bf16_f32 v118, v108, v109
    v_cvt_pk_bf16_f32 v119, v110, v111
    s_nop 0
    v_permlane16_swap_b32 v116, v118
    v_permlane16_swap_b32 v117, v119
    buffer_store_dwordx4 v[116:119], v5, s[24:27], s28 offen
K4_END:
    s_endpgm

.section .rodata,"a"
.p2align 6
.amdhsa_kernel k0_kernel
  .amdhsa_next_free_vgpr 96
  .amdhsa_next_free_sgpr 100
  .amdhsa_accum_offset 96
  .amdhsa_group_segment_fixed_size 0
  .amdhsa_kernarg_size 88
  .amdhsa_user_sgpr_count 2
  .amdhsa_user_sgpr_kernarg_segment_ptr 1
  .amdhsa_system_sgpr_workgroup_id_x 1
  .amdhsa_float_denorm_mode_32 3
  .amdhsa_float_denorm_mode_16_64 3
.end_amdhsa_kernel

.p2align 6
.amdhsa_kernel k1_kernel
  .amdhsa_next_free_vgpr 160
  .amdhsa_next_free_sgpr 100
  .amdhsa_accum_offset 160
  .amdhsa_group_segment_fixed_size 0
  .amdhsa_kernarg_size 88
  .amdhsa_user_sgpr_count 2
  .amdhsa_user_sgpr_kernarg_segment_ptr 1
  .amdhsa_system_sgpr_workgroup_id_x 1
  .amdhsa_float_denorm_mode_32 3
  .amdhsa_float_denorm_mode_16_64 3
.end_amdhsa_kernel

.p2align 6
.amdhsa_kernel k2_kernel
  .amdhsa_next_free_vgpr 128
  .amdhsa_next_free_sgpr 100
  .amdhsa_accum_offset 128
  .amdhsa_group_segment_fixed_size 0
  .amdhsa_kernarg_size 88
  .amdhsa_user_sgpr_count 2
  .amdhsa_user_sgpr_kernarg_segment_ptr 1
  .amdhsa_system_sgpr_workgroup_id_x 1
  .amdhsa_float_denorm_mode_32 3
  .amdhsa_float_denorm_mode_16_64 3
.end_amdhsa_kernel

.p2align 6
.amdhsa_kernel k34_kernel
  .amdhsa_next_free_vgpr 168
  .amdhsa_next_free_sgpr 100
  .amdhsa_accum_offset 168
  .amdhsa_group_segment_fixed_size 0
  .amdhsa_kernarg_size 88
  .amdhsa_user_sgpr_count 2
  .amdhsa_user_sgpr_kernarg_segment_ptr 1
  .amdhsa_system_sgpr_workgroup_id_x 1
  .amdhsa_float_denorm_mode_32 3
  .amdhsa_float_denorm_mode_16_64 3
.end_amdhsa_kernel
```
